```python
import torch

def _softmax(x, axis=-1):
    return torch.softmax(x, dim=axis)
def _gelu(x):
    return torch.nn.functional.gelu(x, approximate="tanh")
def _silu(x):
    return torch.nn.functional.silu(x)
def _sigmoid(x):
    return torch.sigmoid(x)
def _layernorm(x, axis=-1, eps=1e-5):
    m = x.mean(dim=axis, keepdim=True)
    v = x.var(dim=axis, keepdim=True, unbiased=False)
    return (x - m) / torch.sqrt(v + eps)
def _scatter_add(tgt, idx, src, axis=0):
    return tgt.clone().index_add_(axis, idx, src)
def _segment_sum(src, seg, n):
    out = torch.zeros((n,) + src.shape[1:], dtype=src.dtype)
    return out.index_add_(0, seg, src)
def _pad(x, pw):
    flat = tuple(v for pair in reversed(pw) for v in pair)
    return torch.nn.functional.pad(x, flat)

kernel_name = 'interleave_layers__gqa_block_cached__mixer_token_mlp__decode'

def setup_inputs():

    _w = (lambda a: (lambda t: t.to(torch.bfloat16) if t.is_floating_point() else t)(torch.as_tensor(a)))
    def _A_setup():
        B, Sq, D = 2, 1, 512
        Hq, Hkv, Sk, Dh = 32, 32, 8192, 128
        assert Hq % Hkv == 0, (Hq, Hkv)
        return {
            "x": _w((lambda *s: torch.randn(*s, dtype=torch.bfloat16) * 0.05)(B, Sq, D)),
            "k_cache": _w((lambda *s: torch.randn(*s, dtype=torch.bfloat16) * 0.8)(B, Hkv, Sk, Dh)),
            "v_cache": _w((lambda *s: torch.randn(*s, dtype=torch.bfloat16) * 1.6)(B, Hkv, Sk, Dh)),
            "wq": _w((lambda *s: torch.randn(*s, dtype=torch.bfloat16) * 0.8)(D, Hq * Dh) * (D ** -0.5)),
            "wo": _w((lambda *s: torch.randn(*s, dtype=torch.bfloat16) * 1.6)(Hq * Dh, D) * ((Hq * Dh) ** -0.5)),
        }
    _A_in = _A_setup()

    def _B_setup():
        B, S, D, F = 2, 1, 512, 1376
        return {
            "x": _w((lambda *s: torch.randn(*s, dtype=torch.bfloat16) * 0.05)(B, S, D)),
            "w1": _w((lambda *s: torch.randn(*s, dtype=torch.bfloat16) * 0.8)(S, F) * (S ** -0.5)),
            "b1": _w((lambda *s: torch.randn(*s, dtype=torch.bfloat16) * 0.8)(F) * 0.02),
            "w2": _w((lambda *s: torch.randn(*s, dtype=torch.bfloat16) * 0.2)(F, S) * (F ** -0.5)),
            "b2": _w((lambda *s: torch.randn(*s, dtype=torch.bfloat16) * 0.2)(S) * 0.02),
        }
    _B_in = _B_setup()

    return {
        "A_x": _A_in["x"],
        "A_k_cache": _A_in["k_cache"],
        "A_v_cache": _A_in["v_cache"],
        "A_wq": _A_in["wq"],
        "A_wo": _A_in["wo"],
        "B_x": _B_in["x"],
        "B_w1": _B_in["w1"],
        "B_b1": _B_in["b1"],
        "B_w2": _B_in["w2"],
        "B_b2": _B_in["b2"],
    }

def reference(A_x, A_k_cache, A_v_cache, A_wq, A_wo, B_x, B_w1, B_b1, B_w2, B_b2):
    def _A_ref(x, k_cache, v_cache, wq, wo):
        B, Sq, D = x.shape
        Hq, Dh = 32, 128
        Hkv = k_cache.shape[1]
        rep = Hq // Hkv
        q = (lambda x, *d: x.permute(*d))((x @ wq).reshape(B, Sq, Hq, Dh), 0, 2, 1, 3)
        k = (lambda x, n, axis: torch.repeat_interleave(x, n, dim=axis))(k_cache, rep, axis=1)
        v = (lambda x, n, axis: torch.repeat_interleave(x, n, dim=axis))(v_cache, rep, axis=1)
        scores = torch.einsum("bhqd,bhkd->bhqk", q, k) * (Dh ** -0.5)
        p = _softmax(scores, axis=-1)
        o = torch.einsum("bhqk,bhkd->bhqd", p, v)
        return (lambda x, *d: x.permute(*d))(o, 0, 2, 1, 3).reshape(B, Sq, Hq * Dh) @ wo

    def _B_ref(x, w1, b1, w2, b2):
        B, S, D = x.shape
        h = _layernorm(x, axis=-1)
        u = torch.einsum("bsd,sf->bdf", h, w1) + b1
        u = _gelu(u)
        y = torch.einsum("bdf,fs->bds", u, w2) + b2
        return (lambda x, *d: x.permute(*d))(y, 0, 2, 1)

    x = A_x
    x = x + _A_ref(_layernorm(x, axis=-1), A_k_cache, A_v_cache, A_wq, A_wo)
    x = x + _B_ref(_layernorm(x, axis=-1), B_w1, B_b1, B_w2, B_b2)
    x = x + _A_ref(_layernorm(x, axis=-1), A_k_cache, A_v_cache, A_wq, A_wo)
    x = x + _B_ref(_layernorm(x, axis=-1), B_w1, B_b1, B_w2, B_b2)
    return x
```

```asm
; @launch grid=(256,1,1) block=(256,1,1) lds=163840
.amdgcn_target "amdgcn-amd-amdhsa--gfx950"
.text
.globl interleave_layers__gqa_block_cached__mixer_token_mlp__decode_kernel
.p2align 8
.type interleave_layers__gqa_block_cached__mixer_token_mlp__decode_kernel,@function
interleave_layers__gqa_block_cached__mixer_token_mlp__decode_kernel:
    s_getpc_b64 s[64:65]
L_pc:
    s_load_dwordx16 s[68:83], s[0:1], 0
    s_lshr_b32 s7, s2, 3
    s_min_u32 s59, s7, 25
    v_and_b32 v19, 16, v0
    v_mul_u32_u24 v19, s59, v19
    v_and_b32 v18, 15, v0
    v_add_lshl_u32 v18, v18, v19, 7
    v_add_co_u32 v20, vcc, s64, v18
    v_mov_b32 v21, s65
    v_lshrrev_b32 v8, 6, v0
    v_addc_co_u32 v21, vcc, 0, v21, vcc
    global_load_dword v24, v[20:21], off
    s_load_dwordx8 s[84:91], s[0:1], 64
    s_load_dwordx2 s[92:93], s[0:1], 96
    s_cmp_ge_u32 s2, 256
    s_cbranch_scc1 L_end
    v_lshrrev_b32 v8, 6, v0
    v_and_b32 v0, 63, v0
    v_readfirstlane_b32 s3, v8
    s_and_b32 s6, s2, 7
    s_lshr_b32 s7, s2, 3
    s_lshl_b32 s52, s6, 5
    s_add_u32 s52, s52, s7
    s_and_b32 s4, s52, 7
    s_lshr_b32 s59, s52, 3
    s_mul_i32 s4, s4, 8
    s_mul_i32 s59, s59, 1
    s_add_u32 s4, s4, s59
    s_mul_i32 s59, s3, 0
    s_add_u32 s4, s4, s59
    s_lshl_b32 s59, s52, 18
    s_lshl_b32 s60, s3, 10
    s_add_u32 s59, s59, s60
    v_and_b32 v8, 3, v0
    v_bfe_u32 v9, v0, 2, 1
    v_bfe_u32 v12, v0, 3, 1
    v_lshrrev_b32 v10, 4, v0
    v_lshl_add_u32 v1, v8, 4, s59
    v_lshl_add_u32 v1, v9, 9, v1
    v_lshl_add_u32 v1, v12, 8, v1
    v_lshl_add_u32 v1, v10, 6, v1
    v_lshl_add_u32 v2, v0, 4, s59
    s_mul_i32 s54, s3, 39936
    s_add_u32 s54, s54, 4096
    v_lshl_add_u32 v3, v0, 4, s54
    s_waitcnt lgkmcnt(0)
    s_mov_b32 s8, s70
    s_mov_b32 s9, s71
    s_mov_b32 s10, 134217728
    s_mov_b32 s11, 0x20000
    s_add_u32 s5, s4, 0
    s_and_b32 s5, s5, 63
    s_lshl_b32 s5, s5, 12
    buffer_load_dwordx4 a[0:3], v1, s[8:11], s5 offen nt
    s_add_u32 s5, s4, 1
    s_and_b32 s5, s5, 63
    s_lshl_b32 s5, s5, 12
    buffer_load_dwordx4 a[4:7], v1, s[8:11], s5 offen nt
    s_add_u32 s5, s4, 2
    s_and_b32 s5, s5, 63
    s_lshl_b32 s5, s5, 12
    buffer_load_dwordx4 a[8:11], v1, s[8:11], s5 offen nt
    s_add_u32 s5, s4, 3
    s_and_b32 s5, s5, 63
    s_lshl_b32 s5, s5, 12
    buffer_load_dwordx4 a[12:15], v1, s[8:11], s5 offen nt
    s_add_u32 s5, s4, 4
    s_and_b32 s5, s5, 63
    s_lshl_b32 s5, s5, 12
    buffer_load_dwordx4 a[16:19], v1, s[8:11], s5 offen nt
    s_add_u32 s5, s4, 5
    s_and_b32 s5, s5, 63
    s_lshl_b32 s5, s5, 12
    buffer_load_dwordx4 a[20:23], v1, s[8:11], s5 offen nt
    s_add_u32 s5, s4, 6
    s_and_b32 s5, s5, 63
    s_lshl_b32 s5, s5, 12
    buffer_load_dwordx4 a[24:27], v1, s[8:11], s5 offen nt
    s_add_u32 s5, s4, 7
    s_and_b32 s5, s5, 63
    s_lshl_b32 s5, s5, 12
    buffer_load_dwordx4 a[28:31], v1, s[8:11], s5 offen nt
    s_load_dword s55, s[86:87], 0
    s_add_u32 s48, s92, 580608
    s_addc_u32 s49, s93, 0
    s_load_dword s57, s[48:49], 0
    s_and_b32 s1, s7, 1
    s_mov_b32 s16, s92
    s_mov_b32 s17, s93
    s_mov_b32 s18, 536870912
    s_mov_b32 s19, 0x20000
    s_mov_b32 s12, s72
    s_mov_b32 s13, s73
    s_mov_b32 s14, 134217728
    s_mov_b32 s15, 0x20000
    s_mov_b32 s20, s68
    s_mov_b32 s21, s69
    s_mov_b32 s22, 2048
    s_mov_b32 s23, 0x20000
    s_mov_b32 s32, s80
    s_mov_b32 s33, s81
    s_mov_b32 s34, 2752
    s_mov_b32 s35, 0x20000
    s_mov_b32 s36, s82
    s_mov_b32 s37, s83
    s_mov_b32 s38, 2752
    s_mov_b32 s39, 0x20000
    s_mov_b32 s40, s84
    s_mov_b32 s41, s85
    s_mov_b32 s42, 2752
    s_mov_b32 s43, 0x20000
    s_mov_b32 s44, s88
    s_mov_b32 s45, s89
    s_mov_b32 s46, 2048
    s_mov_b32 s47, 0x20000
    s_cmp_lg_u32 s1, 0
    s_cbranch_scc1 L_odd_1
    s_mov_b32 s24, s76
    s_mov_b32 s25, s77
    s_mov_b32 s26, 4194304
    s_mov_b32 s27, 0x20000
    s_lshl_b32 s63, s6, 2
    s_add_u32 s63, s63, s3
    s_lshl_b32 s63, s63, 17
    s_lshl_b32 s60, s7, 5
    s_add_u32 s63, s63, s60
    v_lshrrev_b32 v11, 2, v0
    v_lshlrev_b32 v11, 10, v11
    v_lshl_add_u32 v11, v8, 4, v11
    v_lshrrev_b32 v13, 5, v0
    v_mul_u32_u24 v14, 640, v13
    v_and_b32 v15, 31, v0
    v_lshl_add_u32 v45, v15, 4, v14
    v_and_b32 v46, 7, v0
    v_xor_b32 v46, v46, v13
    v_mul_u32_u24 v46, 640, v46
    v_lshlrev_b32 v47, 3, v15
    v_lshl_add_u32 v47, v13, 2, v47
    v_lshl_add_u32 v47, s3, 8, v47
    s_branch L_join_2
L_odd_1:
    s_mov_b32 s24, s74
    s_mov_b32 s25, s75
    s_mov_b32 s26, 4194304
    s_mov_b32 s27, 0x20000
    s_bfe_u32 s63, s7, 0x20001
    s_lshl_b32 s63, s63, 2
    s_add_u32 s63, s63, s3
    s_lshl_b32 s63, s63, 18
    s_lshr_b32 s60, s52, 3
    s_lshl_b32 s60, s60, 8
    s_add_u32 s63, s63, s60
    v_and_b32 v11, 15, v0
    v_lshlrev_b32 v11, 4, v11
    v_bfe_u32 v13, v0, 4, 1
    v_lshl_add_u32 v11, v13, 13, v11
    v_lshrrev_b32 v13, 5, v0
    v_lshl_add_u32 v11, v13, 16, v11
    v_and_b32 v15, 31, v0
    v_lshlrev_b32 v15, 4, v15
    v_lshl_add_u32 v15, s3, 9, v15
    v_lshl_add_u32 v45, v13, 11, v15
    v_lshl_add_u32 v46, v13, 3, v15
    v_lshlrev_b32 v47, 5, v10
    v_lshl_add_u32 v47, s3, 7, v47
L_join_2:
    s_waitcnt lgkmcnt(0)
    s_lshl_b32 s55, s55, 16
    s_add_u32 s86, s57, 1
    s_lshl_b32 s90, s86, 2
    s_mov_b32 s87, 0xff
    s_mov_b32 s64, 0
    s_mov_b32 s65, -1
    s_mov_b32 s66, 0
    s_mov_b32 s67, 0x55555555
    s_mov_b32 s68, 286331153
    s_mov_b32 s76, 983055
    s_mov_b32 s69, 286331153
    s_mov_b32 s77, 983055
    s_mov_b32 s70, 572662306
    s_mov_b32 s78, 15728880
    s_mov_b32 s71, 572662306
    s_mov_b32 s79, 15728880
    s_mov_b32 s72, 1145324612
    s_mov_b32 s80, 251662080
    s_mov_b32 s73, 1145324612
    s_mov_b32 s81, 251662080
    s_mov_b32 s74, 2290649224
    s_mov_b32 s82, 4026593280
    s_mov_b32 s75, 2290649224
    s_mov_b32 s83, 4026593280
    s_cmp_eq_u32 s3, 0
    s_cselect_b32 s56, -1, 0
    s_getreg_b32 s58, hwreg(HW_REG_XCC_ID, 0, 4)
    s_cmp_lg_u32 s3, 0
    s_cbranch_scc1 L_w0_3
    s_xor_b32 s59, s86, 0x9e3779b9
    v_mov_b32 v16, s59
    v_mov_b32 v17, s58
    s_lshl_b32 s59, s52, 3
    s_add_u32 s59, s59, 577536
    s_mov_b64 exec, 1
    buffer_store_dwordx2 v[16:17], off, s[16:19], s59
    s_mov_b64 exec, -1
L_w0_3:
    v_bfe_u32 v7, v0, 2, 1
    v_mul_u32_u24 v5, 0xffff, v7
    v_xor_b32 v4, 0xffff, v5
    v_mul_u32_u24 v6, 0x5555, v8
    v_mul_u32_u24 v43, 53, v8
    v_and_b32 v40, 15, v0
    v_lshlrev_b32 v40, 5, v40
    v_bfe_u32 v7, v0, 4, 1
    v_lshl_add_u32 v40, v7, 4, v40
    v_lshrrev_b32 v7, 5, v0
    v_lshl_add_u32 v40, v7, 3, v40
    v_lshl_add_u32 v40, s3, 9, v40
    v_and_b32 v41, 31, v0
    v_lshlrev_b32 v41, 2, v41
    v_lshl_add_u32 v41, s3, 7, v41
    v_lshlrev_b32 v7, 2, v0
    v_add_u32 v7, 384, v7
    v_cndmask_b32_e64 v42, v41, v7, s[64:65]
    v_bfe_u32 v7, v0, 2, 2
    v_lshlrev_b32 v44, 9, v7
    v_lshl_add_u32 v44, v10, 7, v44
    v_lshl_add_u32 v44, v8, 5, v44
    s_waitcnt vmcnt(7)
    s_add_u32 s5, s4, 8
    s_and_b32 s5, s5, 63
    s_lshl_b32 s5, s5, 12
    buffer_load_dwordx4 a[32:35], v1, s[8:11], s5 offen nt
    s_waitcnt vmcnt(7)
    s_add_u32 s5, s4, 9
    s_and_b32 s5, s5, 63
    s_lshl_b32 s5, s5, 12
    buffer_load_dwordx4 a[36:39], v1, s[8:11], s5 offen nt
    s_cmp_eq_u32 s1, 0
    s_cbranch_scc1 L_wo_4
    s_add_u32 s5, s63, 0
    buffer_load_dwordx4 v[48:51], v11, s[24:27], s5 offen nt
L_wj_5:
    s_waitcnt vmcnt(8)
    s_add_u32 s5, s4, 10
    s_and_b32 s5, s5, 63
    s_lshl_b32 s5, s5, 12
    buffer_load_dwordx4 a[40:43], v1, s[8:11], s5 offen nt
    s_waitcnt vmcnt(8)
    s_add_u32 s5, s4, 11
    s_and_b32 s5, s5, 63
    s_lshl_b32 s5, s5, 12
    buffer_load_dwordx4 a[44:47], v1, s[8:11], s5 offen nt
    s_cmp_eq_u32 s1, 0
    s_cbranch_scc1 L_wo_6
    s_add_u32 s5, s63, 131072
    buffer_load_dwordx4 v[52:55], v11, s[24:27], s5 offen nt
L_wj_7:
    s_waitcnt vmcnt(9)
    s_add_u32 s5, s4, 12
    s_and_b32 s5, s5, 63
    s_lshl_b32 s5, s5, 12
    buffer_load_dwordx4 a[48:51], v1, s[8:11], s5 offen nt
    s_waitcnt vmcnt(9)
    s_add_u32 s5, s4, 13
    s_and_b32 s5, s5, 63
    s_lshl_b32 s5, s5, 12
    buffer_load_dwordx4 a[52:55], v1, s[8:11], s5 offen nt
    s_cmp_eq_u32 s1, 0
    s_cbranch_scc1 L_wo_8
    s_add_u32 s5, s63, 16384
    buffer_load_dwordx4 v[56:59], v11, s[24:27], s5 offen nt
L_wj_9:
    s_waitcnt vmcnt(10)
    s_add_u32 s5, s4, 14
    s_and_b32 s5, s5, 63
    s_lshl_b32 s5, s5, 12
    buffer_load_dwordx4 a[56:59], v1, s[8:11], s5 offen nt
    s_waitcnt vmcnt(10)
    s_add_u32 s5, s4, 15
    s_and_b32 s5, s5, 63
    s_lshl_b32 s5, s5, 12
    buffer_load_dwordx4 a[60:63], v1, s[8:11], s5 offen nt
    s_cmp_eq_u32 s1, 0
    s_cbranch_scc1 L_wo_10
    s_add_u32 s5, s63, 147456
    buffer_load_dwordx4 v[60:63], v11, s[24:27], s5 offen nt
L_wj_11:
    s_waitcnt vmcnt(11)
    s_add_u32 s5, s4, 16
    s_and_b32 s5, s5, 63
    s_lshl_b32 s5, s5, 12
    buffer_load_dwordx4 a[64:67], v1, s[8:11], s5 offen nt
    s_waitcnt vmcnt(11)
    s_add_u32 s5, s4, 17
    s_and_b32 s5, s5, 63
    s_lshl_b32 s5, s5, 12
    buffer_load_dwordx4 a[68:71], v1, s[8:11], s5 offen nt
    s_cmp_eq_u32 s1, 0
    s_cbranch_scc1 L_wo_12
    s_add_u32 s5, s63, 32768
    buffer_load_dwordx4 v[64:67], v11, s[24:27], s5 offen nt
L_wj_13:
    s_waitcnt vmcnt(11)
    s_add_u32 s5, s4, 18
    s_and_b32 s5, s5, 63
    s_lshl_b32 s5, s5, 12
    buffer_load_dwordx4 a[72:75], v1, s[8:11], s5 offen nt
    s_waitcnt vmcnt(11)
    s_add_u32 s5, s4, 19
    s_and_b32 s5, s5, 63
    s_lshl_b32 s5, s5, 12
    buffer_load_dwordx4 a[76:79], v1, s[8:11], s5 offen nt
    s_cmp_eq_u32 s1, 0
    s_cbranch_scc1 L_wo_14
    s_add_u32 s5, s63, 163840
    buffer_load_dwordx4 v[68:71], v11, s[24:27], s5 offen nt
L_wj_15:
    s_waitcnt vmcnt(11)
    s_add_u32 s5, s4, 20
    s_and_b32 s5, s5, 63
    s_lshl_b32 s5, s5, 12
    buffer_load_dwordx4 a[80:83], v1, s[8:11], s5 offen nt
    s_waitcnt vmcnt(11)
    s_add_u32 s5, s4, 21
    s_and_b32 s5, s5, 63
    s_lshl_b32 s5, s5, 12
    buffer_load_dwordx4 a[84:87], v1, s[8:11], s5 offen nt
    s_cmp_eq_u32 s1, 0
    s_cbranch_scc1 L_wo_16
    s_add_u32 s5, s63, 49152
    buffer_load_dwordx4 v[72:75], v11, s[24:27], s5 offen nt
L_wj_17:
    s_waitcnt vmcnt(11)
    s_add_u32 s5, s4, 22
    s_and_b32 s5, s5, 63
    s_lshl_b32 s5, s5, 12
    buffer_load_dwordx4 a[88:91], v1, s[8:11], s5 offen nt
    s_waitcnt vmcnt(11)
    s_add_u32 s5, s4, 23
    s_and_b32 s5, s5, 63
    s_lshl_b32 s5, s5, 12
    buffer_load_dwordx4 a[92:95], v1, s[8:11], s5 offen nt
    s_cmp_eq_u32 s1, 0
    s_cbranch_scc1 L_wo_18
    s_add_u32 s5, s63, 180224
    buffer_load_dwordx4 v[76:79], v11, s[24:27], s5 offen nt
L_wj_19:
    s_mul_i32 s24, s52, 640
    s_lshl_b32 s25, s6, 2
    s_add_u32 s25, s25, s3
    s_mul_i32 s25, s25, 5120
    s_lshr_b32 s27, s52, 3
    s_lshl_b32 s27, s27, 11
    s_add_u32 s27, s27, 327680
    s_lshl_b32 s59, s52, 6
    s_add_u32 s59, s59, 458752
    s_lshr_b32 s60, s52, 1
    s_lshl_b32 s60, s60, 9
    s_add_u32 s60, s60, 327680
    s_cmp_eq_u32 s1, 0
    s_cselect_b32 s26, s59, s60
    s_lshr_b32 s63, s52, 1
    s_lshl_b32 s63, s63, 7
    s_add_u32 s63, s63, 561152
    s_and_b32 s0, s7, 29
    s_cmp_eq_u32 s0, 12
    s_cselect_b32 s0, 1, 0
    s_waitcnt vmcnt(11)
    s_add_u32 s5, s4, 24
    s_and_b32 s5, s5, 63
    s_lshl_b32 s5, s5, 12
    buffer_load_dwordx4 a[96:99], v1, s[8:11], s5 offen nt
    s_waitcnt vmcnt(11)
    s_add_u32 s5, s4, 25
    s_and_b32 s5, s5, 63
    s_lshl_b32 s5, s5, 12
    buffer_load_dwordx4 a[100:103], v1, s[8:11], s5 offen nt
    v_and_b32 v14, 31, v0
    v_lshlrev_b32 v14, 3, v14
    s_lshl_b32 s60, s6, 8
    s_add_u32 s60, s60, 577536
    s_xor_b32 s59, s86, 0x9e3779b9
    buffer_load_dwordx2 v[12:13], v14, s[16:19], s60 offen sc1
    s_waitcnt vmcnt(11)
    s_add_u32 s5, s4, 26
    s_and_b32 s5, s5, 63
    s_lshl_b32 s5, s5, 12
    buffer_load_dwordx4 a[104:107], v1, s[8:11], s5 offen nt
    s_waitcnt vmcnt(11)
    s_add_u32 s5, s4, 27
    s_and_b32 s5, s5, 63
    s_lshl_b32 s5, s5, 12
    buffer_load_dwordx4 a[108:111], v1, s[8:11], s5 offen nt
    s_waitcnt vmcnt(10)
    s_add_u32 s5, s4, 28
    s_and_b32 s5, s5, 63
    s_lshl_b32 s5, s5, 12
    buffer_load_dwordx4 a[112:115], v1, s[8:11], s5 offen nt
    s_waitcnt vmcnt(10)
    s_add_u32 s5, s4, 29
    s_and_b32 s5, s5, 63
    s_lshl_b32 s5, s5, 12
    buffer_load_dwordx4 a[116:119], v1, s[8:11], s5 offen nt
    s_waitcnt vmcnt(9)
    s_add_u32 s5, s4, 30
    s_and_b32 s5, s5, 63
    s_lshl_b32 s5, s5, 12
    buffer_load_dwordx4 a[120:123], v1, s[8:11], s5 offen nt
    s_waitcnt vmcnt(9)
    s_add_u32 s5, s4, 31
    s_and_b32 s5, s5, 63
    s_lshl_b32 s5, s5, 12
    buffer_load_dwordx4 a[124:127], v1, s[8:11], s5 offen nt
    s_waitcnt vmcnt(8)
    s_add_u32 s5, s4, 32
    s_and_b32 s5, s5, 63
    s_lshl_b32 s5, s5, 12
    buffer_load_dwordx4 a[128:131], v1, s[8:11], s5 offen nt
    s_waitcnt vmcnt(7)
    v_cmp_ne_u32 s[84:85], s59, v12
    v_cmp_ne_u32 vcc, s58, v13
    s_nop 0
    s_or_b64 vcc, vcc, s[84:85]
    s_cmp_eq_u64 vcc, 0
    s_cselect_b32 s53, 1, 0
    s_add_u32 s5, s4, 33
    s_and_b32 s5, s5, 63
    s_lshl_b32 s5, s5, 12
    buffer_load_dwordx4 a[132:135], v1, s[8:11], s5 offen nt
    s_add_u32 s5, s4, 34
    s_and_b32 s5, s5, 63
    s_lshl_b32 s5, s5, 12
    buffer_load_dwordx4 a[136:139], v1, s[8:11], s5 offen nt
    s_cmp_lg_u32 s1, 0
    s_cbranch_scc1 L_odd_22
    v_bfe_u32 v8, v0, 2, 2
    v_lshl_add_u32 v8, v8, 6, s54
    v_and_b32 v9, 3, v0
    v_lshl_add_u32 v8, v9, 3, v8
    v_lshrrev_b32 v9, 4, v0
    v_lshl_add_u32 v8, v9, 9, v8
    ds_read_b64_tr_b16 v[48:49], v8 offset:28672
    ds_read_b64_tr_b16 v[50:51], v8 offset:28928
    ds_read_b64_tr_b16 v[52:53], v8 offset:30720
    ds_read_b64_tr_b16 v[54:55], v8 offset:30976
    ds_read_b64_tr_b16 v[56:57], v8 offset:32768
    ds_read_b64_tr_b16 v[58:59], v8 offset:33024
    ds_read_b64_tr_b16 v[60:61], v8 offset:34816
    ds_read_b64_tr_b16 v[62:63], v8 offset:35072
    s_waitcnt lgkmcnt(0)
    ds_read_b64_tr_b16 v[64:65], v8 offset:28704
    ds_read_b64_tr_b16 v[66:67], v8 offset:28960
    ds_read_b64_tr_b16 v[68:69], v8 offset:30752
    ds_read_b64_tr_b16 v[70:71], v8 offset:31008
    ds_read_b64_tr_b16 v[72:73], v8 offset:32800
    ds_read_b64_tr_b16 v[74:75], v8 offset:33056
    ds_read_b64_tr_b16 v[76:77], v8 offset:34848
    ds_read_b64_tr_b16 v[78:79], v8 offset:35104
    s_waitcnt lgkmcnt(0)
    s_waitcnt vmcnt(7)
    s_add_u32 s5, s4, 35
    s_and_b32 s5, s5, 63
    s_lshl_b32 s5, s5, 12
    buffer_load_dwordx4 a[140:143], v1, s[8:11], s5 offen nt
    s_waitcnt vmcnt(7)
    s_add_u32 s5, s4, 36
    s_and_b32 s5, s5, 63
    s_lshl_b32 s5, s5, 12
    buffer_load_dwordx4 a[144:147], v1, s[8:11], s5 offen nt
    s_waitcnt vmcnt(7)
    s_add_u32 s5, s4, 37
    s_and_b32 s5, s5, 63
    s_lshl_b32 s5, s5, 12
    buffer_load_dwordx4 a[148:151], v1, s[8:11], s5 offen nt
    s_waitcnt vmcnt(7)
    s_add_u32 s5, s4, 38
    s_and_b32 s5, s5, 63
    s_lshl_b32 s5, s5, 12
    buffer_load_dwordx4 a[152:155], v1, s[8:11], s5 offen nt
    s_waitcnt vmcnt(7)
    s_add_u32 s5, s4, 39
    s_and_b32 s5, s5, 63
    s_lshl_b32 s5, s5, 12
    buffer_load_dwordx4 a[156:159], v1, s[8:11], s5 offen nt
    s_waitcnt vmcnt(5)
    s_add_u32 s5, s4, 40
    s_and_b32 s5, s5, 63
    s_lshl_b32 s5, s5, 12
    buffer_load_dwordx4 a[160:163], v1, s[8:11], s5 offen nt
    s_waitcnt vmcnt(5)
    s_add_u32 s5, s4, 41
    s_and_b32 s5, s5, 63
    s_lshl_b32 s5, s5, 12
    buffer_load_dwordx4 a[164:167], v1, s[8:11], s5 offen nt
    s_waitcnt vmcnt(5)
    s_add_u32 s5, s4, 42
    s_and_b32 s5, s5, 63
    s_lshl_b32 s5, s5, 12
    buffer_load_dwordx4 a[168:171], v1, s[8:11], s5 offen nt
    s_waitcnt vmcnt(5)
    s_add_u32 s5, s4, 43
    s_and_b32 s5, s5, 63
    s_lshl_b32 s5, s5, 12
    buffer_load_dwordx4 a[172:175], v1, s[8:11], s5 offen nt
    s_waitcnt vmcnt(5)
    s_add_u32 s5, s4, 44
    s_and_b32 s5, s5, 63
    s_lshl_b32 s5, s5, 12
    buffer_load_dwordx4 a[176:179], v1, s[8:11], s5 offen nt
    s_waitcnt vmcnt(5)
    s_add_u32 s5, s4, 45
    s_and_b32 s5, s5, 63
    s_lshl_b32 s5, s5, 12
    buffer_load_dwordx4 a[180:183], v1, s[8:11], s5 offen nt
    s_waitcnt vmcnt(5)
    s_add_u32 s5, s4, 46
    s_and_b32 s5, s5, 63
    s_lshl_b32 s5, s5, 12
    buffer_load_dwordx4 a[184:187], v1, s[8:11], s5 offen nt
    s_waitcnt vmcnt(5)
    s_add_u32 s5, s4, 47
    s_and_b32 s5, s5, 63
    s_lshl_b32 s5, s5, 12
    buffer_load_dwordx4 a[188:191], v1, s[8:11], s5 offen nt
    s_waitcnt vmcnt(5)
    s_add_u32 s5, s4, 48
    s_and_b32 s5, s5, 63
    s_lshl_b32 s5, s5, 12
    buffer_load_dwordx4 a[192:195], v1, s[8:11], s5 offen nt
    s_waitcnt vmcnt(5)
    s_add_u32 s5, s4, 49
    s_and_b32 s5, s5, 63
    s_lshl_b32 s5, s5, 12
    buffer_load_dwordx4 a[196:199], v1, s[8:11], s5 offen nt
    s_waitcnt vmcnt(5)
    s_add_u32 s5, s4, 50
    s_and_b32 s5, s5, 63
    s_lshl_b32 s5, s5, 12
    buffer_load_dwordx4 a[200:203], v1, s[8:11], s5 offen nt
    s_waitcnt vmcnt(5)
    s_add_u32 s5, s4, 51
    s_and_b32 s5, s5, 63
    s_lshl_b32 s5, s5, 12
    buffer_load_dwordx4 a[204:207], v1, s[8:11], s5 offen nt
    s_branch L_join_23
L_wo_4:
    s_add_u32 m0, s54, 28672
    s_add_u32 s5, s63, 0
    buffer_load_dwordx4 v11, s[24:27], s5 offen nt lds
    s_branch L_wj_5
L_wo_6:
    s_add_u32 m0, s54, 29696
    s_add_u32 s5, s63, 16384
    buffer_load_dwordx4 v11, s[24:27], s5 offen nt lds
    s_branch L_wj_7
L_wo_8:
    s_add_u32 m0, s54, 30720
    s_add_u32 s5, s63, 32768
    buffer_load_dwordx4 v11, s[24:27], s5 offen nt lds
    s_branch L_wj_9
L_wo_10:
    s_add_u32 m0, s54, 31744
    s_add_u32 s5, s63, 49152
    buffer_load_dwordx4 v11, s[24:27], s5 offen nt lds
    s_branch L_wj_11
L_wo_12:
    s_add_u32 m0, s54, 32768
    s_add_u32 s5, s63, 65536
    buffer_load_dwordx4 v11, s[24:27], s5 offen nt lds
    s_branch L_wj_13
L_wo_14:
    s_add_u32 m0, s54, 33792
    s_add_u32 s5, s63, 81920
    buffer_load_dwordx4 v11, s[24:27], s5 offen nt lds
    s_branch L_wj_15
L_wo_16:
    s_add_u32 m0, s54, 34816
    s_add_u32 s5, s63, 98304
    buffer_load_dwordx4 v11, s[24:27], s5 offen nt lds
    s_branch L_wj_17
L_wo_18:
    s_add_u32 m0, s54, 35840
    s_add_u32 s5, s63, 114688
    buffer_load_dwordx4 v11, s[24:27], s5 offen nt lds
    s_branch L_wj_19
L_slow_20:
    buffer_store_dword v12, v20, s[16:19], s26 offen sc1
    s_branch L_pub_21
L_odd_22:
    s_bfe_u32 s59, s7, 0x20001
    s_lshl_b32 s59, s59, 8
    v_lshrrev_b32 v37, 1, v47
    v_bfe_u32 v38, v0, 3, 1
    v_lshl_add_u32 v37, v38, 10, v37
    v_lshlrev_b32 v36, 4, v0
    buffer_load_dwordx4 v[8:11], v36, s[20:23], 0 offen
    buffer_load_dwordx4 v[12:15], v36, s[20:23], 0 offen offset:1024
    buffer_load_dwordx4 v[24:27], v37, s[20:23], s59 offen
    s_waitcnt vmcnt(10)
    s_add_u32 s5, s4, 35
    s_and_b32 s5, s5, 63
    s_lshl_b32 s5, s5, 12
    buffer_load_dwordx4 a[140:143], v1, s[8:11], s5 offen nt
    s_waitcnt vmcnt(10)
    s_add_u32 s5, s4, 36
    s_and_b32 s5, s5, 63
    s_lshl_b32 s5, s5, 12
    buffer_load_dwordx4 a[144:147], v1, s[8:11], s5 offen nt
    s_waitcnt vmcnt(10)
    s_add_u32 s5, s4, 37
    s_and_b32 s5, s5, 63
    s_lshl_b32 s5, s5, 12
    buffer_load_dwordx4 a[148:151], v1, s[8:11], s5 offen nt
    s_waitcnt vmcnt(10)
    s_add_u32 s5, s4, 38
    s_and_b32 s5, s5, 63
    s_lshl_b32 s5, s5, 12
    buffer_load_dwordx4 a[152:155], v1, s[8:11], s5 offen nt
    s_waitcnt vmcnt(10)
    s_add_u32 s5, s4, 39
    s_and_b32 s5, s5, 63
    s_lshl_b32 s5, s5, 12
    buffer_load_dwordx4 a[156:159], v1, s[8:11], s5 offen nt
    s_waitcnt vmcnt(8)
    s_add_u32 s5, s4, 40
    s_and_b32 s5, s5, 63
    s_lshl_b32 s5, s5, 12
    buffer_load_dwordx4 a[160:163], v1, s[8:11], s5 offen nt
    s_waitcnt vmcnt(5)
    s_add_u32 s5, s4, 41
    s_and_b32 s5, s5, 63
    s_lshl_b32 s5, s5, 12
    buffer_load_dwordx4 a[164:167], v1, s[8:11], s5 offen nt
    v_lshlrev_b32 v16, 16, v24
    v_and_b32 v17, 0xffff0000, v24
    v_lshlrev_b32 v18, 16, v25
    v_and_b32 v19, 0xffff0000, v25
    v_lshlrev_b32 v20, 16, v26
    v_and_b32 v21, 0xffff0000, v26
    v_lshlrev_b32 v22, 16, v27
    v_and_b32 v23, 0xffff0000, v27
    v_lshlrev_b32 v24, 16, v8
    v_and_b32 v25, 0xffff0000, v8
    v_add_f32 v36, v24, v25
    v_mul_f32 v37, v24, v24
    v_fmac_f32 v37, v25, v25
    v_lshlrev_b32 v24, 16, v9
    v_and_b32 v25, 0xffff0000, v9
    v_add_f32 v36, v36, v24
    v_add_f32 v36, v36, v25
    v_fmac_f32 v37, v24, v24
    v_fmac_f32 v37, v25, v25
    v_lshlrev_b32 v24, 16, v10
    v_and_b32 v25, 0xffff0000, v10
    v_add_f32 v36, v36, v24
    v_add_f32 v36, v36, v25
    v_fmac_f32 v37, v24, v24
    v_fmac_f32 v37, v25, v25
    v_lshlrev_b32 v24, 16, v11
    v_and_b32 v25, 0xffff0000, v11
    v_add_f32 v36, v36, v24
    v_add_f32 v36, v36, v25
    v_fmac_f32 v37, v24, v24
    v_fmac_f32 v37, v25, v25
    v_lshlrev_b32 v24, 16, v12
    v_and_b32 v25, 0xffff0000, v12
    v_add_f32 v38, v24, v25
    v_mul_f32 v39, v24, v24
    v_fmac_f32 v39, v25, v25
    v_lshlrev_b32 v24, 16, v13
    v_and_b32 v25, 0xffff0000, v13
    v_add_f32 v38, v38, v24
    v_add_f32 v38, v38, v25
    v_fmac_f32 v39, v24, v24
    v_fmac_f32 v39, v25, v25
    v_lshlrev_b32 v24, 16, v14
    v_and_b32 v25, 0xffff0000, v14
    v_add_f32 v38, v38, v24
    v_add_f32 v38, v38, v25
    v_fmac_f32 v39, v24, v24
    v_fmac_f32 v39, v25, v25
    v_lshlrev_b32 v24, 16, v15
    v_and_b32 v25, 0xffff0000, v15
    v_add_f32 v38, v38, v24
    v_add_f32 v38, v38, v25
    v_fmac_f32 v39, v24, v24
    v_fmac_f32 v39, v25, v25
    v_add_f32_dpp v36, v36, v36 quad_perm:[1,0,3,2] row_mask:0xf bank_mask:0xf
    v_add_f32_dpp v37, v37, v37 quad_perm:[1,0,3,2] row_mask:0xf bank_mask:0xf
    v_add_f32_dpp v38, v38, v38 quad_perm:[1,0,3,2] row_mask:0xf bank_mask:0xf
    v_add_f32_dpp v39, v39, v39 quad_perm:[1,0,3,2] row_mask:0xf bank_mask:0xf
    v_add_f32_dpp v36, v36, v36 quad_perm:[2,3,0,1] row_mask:0xf bank_mask:0xf
    v_add_f32_dpp v37, v37, v37 quad_perm:[2,3,0,1] row_mask:0xf bank_mask:0xf
    v_add_f32_dpp v38, v38, v38 quad_perm:[2,3,0,1] row_mask:0xf bank_mask:0xf
    v_add_f32_dpp v39, v39, v39 quad_perm:[2,3,0,1] row_mask:0xf bank_mask:0xf
    v_add_f32_dpp v36, v36, v36 row_half_mirror row_mask:0xf bank_mask:0xf
    v_add_f32_dpp v37, v37, v37 row_half_mirror row_mask:0xf bank_mask:0xf
    v_add_f32_dpp v38, v38, v38 row_half_mirror row_mask:0xf bank_mask:0xf
    v_add_f32_dpp v39, v39, v39 row_half_mirror row_mask:0xf bank_mask:0xf
    v_add_f32_dpp v36, v36, v36 row_mirror row_mask:0xf bank_mask:0xf
    v_add_f32_dpp v37, v37, v37 row_mirror row_mask:0xf bank_mask:0xf
    v_add_f32_dpp v38, v38, v38 row_mirror row_mask:0xf bank_mask:0xf
    v_add_f32_dpp v39, v39, v39 row_mirror row_mask:0xf bank_mask:0xf
    v_add_f32_dpp v36, v36, v36 row_bcast:15 row_mask:0xa bank_mask:0xf
    v_add_f32_dpp v37, v37, v37 row_bcast:15 row_mask:0xa bank_mask:0xf
    v_add_f32_dpp v38, v38, v38 row_bcast:15 row_mask:0xa bank_mask:0xf
    v_add_f32_dpp v39, v39, v39 row_bcast:15 row_mask:0xa bank_mask:0xf
    v_add_f32_dpp v36, v36, v36 row_bcast:31 row_mask:0xc bank_mask:0xf
    v_add_f32_dpp v37, v37, v37 row_bcast:31 row_mask:0xc bank_mask:0xf
    v_add_f32_dpp v38, v38, v38 row_bcast:31 row_mask:0xc bank_mask:0xf
    v_add_f32_dpp v39, v39, v39 row_bcast:31 row_mask:0xc bank_mask:0xf
    v_mul_f32 v36, 0x3b000000, v36
    v_mul_f32 v37, 0x3b000000, v37
    v_fma_f32 v37, -v36, v36, v37
    v_max_f32 v37, 0, v37
    v_add_f32 v37, 0x3727c5ac, v37
    v_rsq_f32 v37, v37
    v_mul_f32 v38, 0x3b000000, v38
    v_mul_f32 v39, 0x3b000000, v39
    v_fma_f32 v39, -v38, v38, v39
    v_max_f32 v39, 0, v39
    v_add_f32 v39, 0x3727c5ac, v39
    v_rsq_f32 v39, v39
    v_readlane_b32 s48, v36, 63
    v_readlane_b32 s49, v37, 63
    v_readlane_b32 s50, v38, 63
    v_readlane_b32 s51, v39, 63
    s_mov_b32 s84, 0xff00ff00
    s_mov_b32 s85, 0xff00ff00
    v_mov_b32 v36, s48
    v_mov_b32 v37, s49
    v_mov_b32 v38, s50
    v_mov_b32 v39, s51
    v_cndmask_b32_e64 v36, v36, v38, s[84:85]
    v_cndmask_b32_e64 v37, v37, v39, s[84:85]
    v_sub_f32 v16, v16, v36
    v_sub_f32 v17, v17, v36
    v_sub_f32 v18, v18, v36
    v_sub_f32 v19, v19, v36
    v_sub_f32 v20, v20, v36
    v_sub_f32 v21, v21, v36
    v_sub_f32 v22, v22, v36
    v_sub_f32 v23, v23, v36
    v_mul_f32 v16, v37, v16
    v_mul_f32 v17, v37, v17
    v_mul_f32 v18, v37, v18
    v_mul_f32 v19, v37, v19
    v_mul_f32 v20, v37, v20
    v_mul_f32 v21, v37, v21
    v_mul_f32 v22, v37, v22
    v_mul_f32 v23, v37, v23
    v_add3_u32 v35, v43, s90, 0
    v_mov_b32 v28, 0
    v_mov_b32 v29, 0
    v_mov_b32 v30, 0
    v_mov_b32 v31, 0
    v_lshlrev_b32 v32, 16, v4
    v_lshlrev_b32 v33, 16, v5
    s_waitcnt vmcnt(5)
    s_add_u32 s5, s4, 42
    s_and_b32 s5, s5, 63
    s_lshl_b32 s5, s5, 12
    buffer_load_dwordx4 a[168:171], v1, s[8:11], s5 offen nt
    v_cvt_pk_bf16_f32 v16, v16, v17
    v_and_b32 v8, v16, v4
    v_and_b32 v9, v16, v5
    v_and_b32 v10, v16, v32
    v_and_b32 v11, v16, v33
    v_cvt_pk_bf16_f32 v17, v18, v19
    v_and_b32 v12, v17, v4
    v_and_b32 v13, v17, v5
    v_and_b32 v14, v17, v32
    v_and_b32 v15, v17, v33
    v_smfmac_f32_16x16x64_bf16 v[28:31], v[8:11], v[48:55], v6
    v_cvt_pk_bf16_f32 v18, v20, v21
    v_and_b32 v24, v18, v4
    v_and_b32 v25, v18, v5
    v_and_b32 v26, v18, v32
    v_and_b32 v27, v18, v33
    v_smfmac_f32_16x16x64_bf16 v[28:31], v[12:15], v[56:63], v6
    v_cvt_pk_bf16_f32 v19, v22, v23
    v_and_b32 v36, v19, v4
    v_and_b32 v37, v19, v5
    v_and_b32 v38, v19, v32
    v_and_b32 v39, v19, v33
    v_smfmac_f32_16x16x64_bf16 v[28:31], v[24:27], v[64:71], v6
    s_nop 0
    v_smfmac_f32_16x16x64_bf16 v[28:31], v[36:39], v[72:79], v6
    v_lshrrev_b32 v19, 5, v0
    v_lshl_add_u32 v16, s3, 9, v40
    v_mul_u32_u24 v17, 504, v19
    v_add_u32 v16, v16, v17
    v_lshl_add_u32 v20, v19, 16, v41
    v_lshl_add_u32 v17, v19, 9, v41
    v_add_u32 v35, v35, v19
    s_nop 0
    ds_write_b128 v16, v[28:31] offset:24576
    s_waitcnt lgkmcnt(0)
    s_barrier
    ds_read_b32 v12, v17 offset:24576
    ds_read_b32 v13, v17 offset:25600
    ds_read_b32 v14, v17 offset:26624
    ds_read_b32 v15, v17 offset:27648
    s_waitcnt lgkmcnt(0)
    v_add_f32 v12, v12, v13
    v_add_f32 v14, v14, v15
    v_add_f32 v12, v12, v14
    v_bfi_b32 v12, s87, v35, v12
    s_cmp_eq_u32 s53, 0
    s_cbranch_scc1 L_slow_20
    buffer_store_dword v12, v20, s[16:19], s26 offen
L_pub_21:
    s_mov_b32 exec_hi, -1
    s_waitcnt vmcnt(6)
    s_add_u32 s5, s4, 43
    s_and_b32 s5, s5, 63
    s_lshl_b32 s5, s5, 12
    buffer_load_dwordx4 a[172:175], v1, s[8:11], s5 offen nt
    s_waitcnt lgkmcnt(0)
    s_barrier
    s_waitcnt vmcnt(6)
    s_add_u32 s5, s4, 44
    s_and_b32 s5, s5, 63
    s_lshl_b32 s5, s5, 12
    buffer_load_dwordx4 a[176:179], v1, s[8:11], s5 offen nt
    s_waitcnt vmcnt(6)
    s_add_u32 s5, s4, 45
    s_and_b32 s5, s5, 63
    s_lshl_b32 s5, s5, 12
    buffer_load_dwordx4 a[180:183], v1, s[8:11], s5 offen nt
    s_waitcnt vmcnt(6)
    s_add_u32 s5, s4, 46
    s_and_b32 s5, s5, 63
    s_lshl_b32 s5, s5, 12
    buffer_load_dwordx4 a[184:187], v1, s[8:11], s5 offen nt
    s_waitcnt vmcnt(6)
    s_add_u32 s5, s4, 47
    s_and_b32 s5, s5, 63
    s_lshl_b32 s5, s5, 12
    buffer_load_dwordx4 a[188:191], v1, s[8:11], s5 offen nt
    s_waitcnt vmcnt(6)
    s_add_u32 s5, s4, 48
    s_and_b32 s5, s5, 63
    s_lshl_b32 s5, s5, 12
    buffer_load_dwordx4 a[192:195], v1, s[8:11], s5 offen nt
    s_waitcnt vmcnt(5)
    s_add_u32 s5, s4, 49
    s_and_b32 s5, s5, 63
    s_lshl_b32 s5, s5, 12
    buffer_load_dwordx4 a[196:199], v1, s[8:11], s5 offen nt
    s_waitcnt vmcnt(5)
    s_add_u32 s5, s4, 50
    s_and_b32 s5, s5, 63
    s_lshl_b32 s5, s5, 12
    buffer_load_dwordx4 a[200:203], v1, s[8:11], s5 offen nt
    s_waitcnt vmcnt(5)
    s_add_u32 s5, s4, 51
    s_and_b32 s5, s5, 63
    s_lshl_b32 s5, s5, 12
    buffer_load_dwordx4 a[204:207], v1, s[8:11], s5 offen nt
L_join_23:
    s_mul_i32 s59, s3, 688
    v_lshlrev_b32 v36, 4, v0
    buffer_load_dwordx4 v[8:11], v36, s[32:35], s59 offen
    buffer_load_dwordx4 v[12:15], v36, s[36:39], s59 offen
    buffer_load_dwordx4 v[16:19], v36, s[40:43], s59 offen
    s_waitcnt vmcnt(8)
    s_add_u32 s5, s4, 52
    s_and_b32 s5, s5, 63
    s_lshl_b32 s5, s5, 12
    buffer_load_dwordx4 a[208:211], v1, s[8:11], s5 offen nt
    s_waitcnt vmcnt(8)
    s_add_u32 s5, s4, 53
    s_and_b32 s5, s5, 63
    s_lshl_b32 s5, s5, 12
    buffer_load_dwordx4 a[212:215], v1, s[8:11], s5 offen nt
    s_waitcnt vmcnt(8)
    s_add_u32 s5, s4, 54
    s_and_b32 s5, s5, 63
    s_lshl_b32 s5, s5, 12
    buffer_load_dwordx4 a[216:219], v1, s[8:11], s5 offen nt
    s_waitcnt vmcnt(8)
    s_add_u32 s5, s4, 55
    s_and_b32 s5, s5, 63
    s_lshl_b32 s5, s5, 12
    buffer_load_dwordx4 a[220:223], v1, s[8:11], s5 offen nt
    s_waitcnt vmcnt(8)
    s_add_u32 s5, s4, 56
    s_and_b32 s5, s5, 63
    s_lshl_b32 s5, s5, 12
    buffer_load_dwordx4 a[224:227], v1, s[8:11], s5 offen nt
    v_lshl_add_u32 v37, v0, 6, s54
    v_lshl_add_u32 v38, v0, 5, s54
    s_waitcnt vmcnt(5)
    s_mov_b32 exec_hi, 0x7ff
    v_lshlrev_b32 v20, 16, v8
    v_and_b32 v21, 0xffff0000, v8
    v_lshlrev_b32 v22, 16, v12
    v_and_b32 v23, 0xffff0000, v12
    v_lshlrev_b32 v24, 16, v16
    v_and_b32 v25, 0xffff0000, v16
    ds_write_b128 v37, v[20:23] offset:20480
    ds_write_b64 v38, v[24:25] offset:23232
    v_lshlrev_b32 v26, 16, v9
    v_and_b32 v27, 0xffff0000, v9
    v_lshlrev_b32 v28, 16, v13
    v_and_b32 v29, 0xffff0000, v13
    v_lshlrev_b32 v30, 16, v17
    v_and_b32 v31, 0xffff0000, v17
    ds_write_b128 v37, v[26:29] offset:20496
    ds_write_b64 v38, v[30:31] offset:23240
    s_waitcnt lgkmcnt(0)
    v_lshlrev_b32 v20, 16, v10
    v_and_b32 v21, 0xffff0000, v10
    v_lshlrev_b32 v22, 16, v14
    v_and_b32 v23, 0xffff0000, v14
    v_lshlrev_b32 v24, 16, v18
    v_and_b32 v25, 0xffff0000, v18
    ds_write_b128 v37, v[20:23] offset:20512
    ds_write_b64 v38, v[24:25] offset:23248
    v_lshlrev_b32 v26, 16, v11
    v_and_b32 v27, 0xffff0000, v11
    v_lshlrev_b32 v28, 16, v15
    v_and_b32 v29, 0xffff0000, v15
    v_lshlrev_b32 v30, 16, v19
    v_and_b32 v31, 0xffff0000, v19
    ds_write_b128 v37, v[26:29] offset:20528
    ds_write_b64 v38, v[30:31] offset:23256
    s_mov_b32 exec_hi, -1
    s_and_b32 s59, s2, 127
    s_lshl_b32 s59, s59, 5
    v_and_b32 v32, 31, v0
    v_add_u32 v32, s59, v32
    v_cmp_ne_u32 vcc, 0, v32
    s_lshr_b32 s59, s2, 7
    s_lshl_b32 s59, s59, 15
    s_add_u32 s59, s59, 12800
    v_add_u32 v32, s59, v32
    v_lshlrev_b32 v32, 16, v32
    v_cndmask_b32 v32, 0, v32, vcc
    v_lshrrev_b32 v35, 5, v0
    v_mul_u32_u24 v34, 1376, v35
    v_mul_u32_u24 v35, 688, v35
    v_add_u32 v34, s54, v34
    v_add_u32 v35, s54, v35
    s_mov_b32 s48, 0xbdd2d3e8
    s_mov_b32 s49, 0xc0135761
    v_mov_b32 v12, 0
    v_mov_b32 v13, 0
    s_waitcnt lgkmcnt(0)
    ds_read_b128 v[16:19], v34 offset:20480
    ds_read_b64 v[20:21], v35 offset:23232
    ds_read_b128 v[24:27], v34 offset:20496
    ds_read_b64 v[28:29], v35 offset:23240
    s_waitcnt lgkmcnt(2)
    v_pk_fma_f32 v[8:9], v[32:33], v[16:17], v[18:19] op_sel_hi:[0,1,1]
    v_pk_mul_f32 v[10:11], v[8:9], v[8:9]
    v_pk_fma_f32 v[10:11], v[10:11], s[48:49], s[48:49] op_sel:[0,0,1] op_sel_hi:[1,0,1]
    v_pk_mul_f32 v[10:11], v[8:9], v[10:11]
    v_exp_f32 v10, v10
    v_exp_f32 v11, v11
    v_pk_mul_f32 v[8:9], v[8:9], v[20:21]
    v_pk_add_f32 v[10:11], v[10:11], 1.0 op_sel_hi:[1,0]
    v_rcp_f32 v10, v10
    v_rcp_f32 v11, v11
    s_nop 0
    v_pk_fma_f32 v[12:13], v[8:9], v[10:11], v[12:13]
    s_add_u32 s5, s4, 57
    s_and_b32 s5, s5, 63
    s_lshl_b32 s5, s5, 12
    buffer_load_dwordx4 a[228:231], v1, s[8:11], s5 offen nt
    ds_read_b128 v[16:19], v34 offset:20512
    ds_read_b64 v[20:21], v35 offset:23248
    s_waitcnt lgkmcnt(2)
    v_pk_fma_f32 v[8:9], v[32:33], v[24:25], v[26:27] op_sel_hi:[0,1,1]
    v_pk_mul_f32 v[10:11], v[8:9], v[8:9]
    v_pk_fma_f32 v[10:11], v[10:11], s[48:49], s[48:49] op_sel:[0,0,1] op_sel_hi:[1,0,1]
    v_pk_mul_f32 v[10:11], v[8:9], v[10:11]
    v_exp_f32 v10, v10
    v_exp_f32 v11, v11
    v_pk_mul_f32 v[8:9], v[8:9], v[28:29]
    v_pk_add_f32 v[10:11], v[10:11], 1.0 op_sel_hi:[1,0]
    v_rcp_f32 v10, v10
    v_rcp_f32 v11, v11
    s_nop 0
    v_pk_fma_f32 v[12:13], v[8:9], v[10:11], v[12:13]
    ds_read_b128 v[24:27], v34 offset:20528
    ds_read_b64 v[28:29], v35 offset:23256
    s_waitcnt lgkmcnt(2)
    v_pk_fma_f32 v[8:9], v[32:33], v[16:17], v[18:19] op_sel_hi:[0,1,1]
    v_pk_mul_f32 v[10:11], v[8:9], v[8:9]
    v_pk_fma_f32 v[10:11], v[10:11], s[48:49], s[48:49] op_sel:[0,0,1] op_sel_hi:[1,0,1]
    v_pk_mul_f32 v[10:11], v[8:9], v[10:11]
    v_exp_f32 v10, v10
    v_exp_f32 v11, v11
    v_pk_mul_f32 v[8:9], v[8:9], v[20:21]
    v_pk_add_f32 v[10:11], v[10:11], 1.0 op_sel_hi:[1,0]
    v_rcp_f32 v10, v10
    v_rcp_f32 v11, v11
    s_nop 0
    v_pk_fma_f32 v[12:13], v[8:9], v[10:11], v[12:13]
    s_waitcnt vmcnt(5)
    s_add_u32 s5, s4, 58
    s_and_b32 s5, s5, 63
    s_lshl_b32 s5, s5, 12
    buffer_load_dwordx4 a[232:235], v1, s[8:11], s5 offen nt
    ds_read_b128 v[16:19], v34 offset:20544
    ds_read_b64 v[20:21], v35 offset:23264
    s_waitcnt lgkmcnt(2)
    v_pk_fma_f32 v[8:9], v[32:33], v[24:25], v[26:27] op_sel_hi:[0,1,1]
    v_pk_mul_f32 v[10:11], v[8:9], v[8:9]
    v_pk_fma_f32 v[10:11], v[10:11], s[48:49], s[48:49] op_sel:[0,0,1] op_sel_hi:[1,0,1]
    v_pk_mul_f32 v[10:11], v[8:9], v[10:11]
    v_exp_f32 v10, v10
    v_exp_f32 v11, v11
    v_pk_mul_f32 v[8:9], v[8:9], v[28:29]
    v_pk_add_f32 v[10:11], v[10:11], 1.0 op_sel_hi:[1,0]
    v_rcp_f32 v10, v10
    v_rcp_f32 v11, v11
    s_nop 0
    v_pk_fma_f32 v[12:13], v[8:9], v[10:11], v[12:13]
    ds_read_b128 v[24:27], v34 offset:20560
    ds_read_b64 v[28:29], v35 offset:23272
    s_waitcnt lgkmcnt(2)
    v_pk_fma_f32 v[8:9], v[32:33], v[16:17], v[18:19] op_sel_hi:[0,1,1]
    v_pk_mul_f32 v[10:11], v[8:9], v[8:9]
    v_pk_fma_f32 v[10:11], v[10:11], s[48:49], s[48:49] op_sel:[0,0,1] op_sel_hi:[1,0,1]
    v_pk_mul_f32 v[10:11], v[8:9], v[10:11]
    v_exp_f32 v10, v10
    v_exp_f32 v11, v11
    v_pk_mul_f32 v[8:9], v[8:9], v[20:21]
    v_pk_add_f32 v[10:11], v[10:11], 1.0 op_sel_hi:[1,0]
    v_rcp_f32 v10, v10
    v_rcp_f32 v11, v11
    s_nop 0
    v_pk_fma_f32 v[12:13], v[8:9], v[10:11], v[12:13]
    s_waitcnt vmcnt(5)
    s_add_u32 s5, s4, 59
    s_and_b32 s5, s5, 63
    s_lshl_b32 s5, s5, 12
    buffer_load_dwordx4 a[236:239], v1, s[8:11], s5 offen nt
    ds_read_b128 v[16:19], v34 offset:20576
    ds_read_b64 v[20:21], v35 offset:23280
    s_waitcnt lgkmcnt(2)
    v_pk_fma_f32 v[8:9], v[32:33], v[24:25], v[26:27] op_sel_hi:[0,1,1]
    v_pk_mul_f32 v[10:11], v[8:9], v[8:9]
    v_pk_fma_f32 v[10:11], v[10:11], s[48:49], s[48:49] op_sel:[0,0,1] op_sel_hi:[1,0,1]
    v_pk_mul_f32 v[10:11], v[8:9], v[10:11]
    v_exp_f32 v10, v10
    v_exp_f32 v11, v11
    v_pk_mul_f32 v[8:9], v[8:9], v[28:29]
    v_pk_add_f32 v[10:11], v[10:11], 1.0 op_sel_hi:[1,0]
    v_rcp_f32 v10, v10
    v_rcp_f32 v11, v11
    s_nop 0
    v_pk_fma_f32 v[12:13], v[8:9], v[10:11], v[12:13]
    ds_read_b128 v[24:27], v34 offset:20592
    ds_read_b64 v[28:29], v35 offset:23288
    s_waitcnt lgkmcnt(2)
    v_pk_fma_f32 v[8:9], v[32:33], v[16:17], v[18:19] op_sel_hi:[0,1,1]
    v_pk_mul_f32 v[10:11], v[8:9], v[8:9]
    v_pk_fma_f32 v[10:11], v[10:11], s[48:49], s[48:49] op_sel:[0,0,1] op_sel_hi:[1,0,1]
    v_pk_mul_f32 v[10:11], v[8:9], v[10:11]
    v_exp_f32 v10, v10
    v_exp_f32 v11, v11
    v_pk_mul_f32 v[8:9], v[8:9], v[20:21]
    v_pk_add_f32 v[10:11], v[10:11], 1.0 op_sel_hi:[1,0]
    v_rcp_f32 v10, v10
    v_rcp_f32 v11, v11
    s_nop 0
    v_pk_fma_f32 v[12:13], v[8:9], v[10:11], v[12:13]
    s_waitcnt vmcnt(5)
    s_add_u32 s5, s4, 60
    s_and_b32 s5, s5, 63
    s_lshl_b32 s5, s5, 12
    buffer_load_dwordx4 a[240:243], v1, s[8:11], s5 offen nt
    ds_read_b128 v[16:19], v34 offset:20608
    ds_read_b64 v[20:21], v35 offset:23296
    s_waitcnt lgkmcnt(2)
    v_pk_fma_f32 v[8:9], v[32:33], v[24:25], v[26:27] op_sel_hi:[0,1,1]
    v_pk_mul_f32 v[10:11], v[8:9], v[8:9]
    v_pk_fma_f32 v[10:11], v[10:11], s[48:49], s[48:49] op_sel:[0,0,1] op_sel_hi:[1,0,1]
    v_pk_mul_f32 v[10:11], v[8:9], v[10:11]
    v_exp_f32 v10, v10
    v_exp_f32 v11, v11
    v_pk_mul_f32 v[8:9], v[8:9], v[28:29]
    v_pk_add_f32 v[10:11], v[10:11], 1.0 op_sel_hi:[1,0]
    v_rcp_f32 v10, v10
    v_rcp_f32 v11, v11
    s_nop 0
    v_pk_fma_f32 v[12:13], v[8:9], v[10:11], v[12:13]
    ds_read_b128 v[24:27], v34 offset:20624
    ds_read_b64 v[28:29], v35 offset:23304
    s_waitcnt lgkmcnt(2)
    v_pk_fma_f32 v[8:9], v[32:33], v[16:17], v[18:19] op_sel_hi:[0,1,1]
    v_pk_mul_f32 v[10:11], v[8:9], v[8:9]
    v_pk_fma_f32 v[10:11], v[10:11], s[48:49], s[48:49] op_sel:[0,0,1] op_sel_hi:[1,0,1]
    v_pk_mul_f32 v[10:11], v[8:9], v[10:11]
    v_exp_f32 v10, v10
    v_exp_f32 v11, v11
    v_pk_mul_f32 v[8:9], v[8:9], v[20:21]
    v_pk_add_f32 v[10:11], v[10:11], 1.0 op_sel_hi:[1,0]
    v_rcp_f32 v10, v10
    v_rcp_f32 v11, v11
    s_nop 0
    v_pk_fma_f32 v[12:13], v[8:9], v[10:11], v[12:13]
    s_waitcnt vmcnt(5)
    s_add_u32 s5, s4, 61
    s_and_b32 s5, s5, 63
    s_lshl_b32 s5, s5, 12
    buffer_load_dwordx4 a[244:247], v1, s[8:11], s5 offen nt
    ds_read_b128 v[16:19], v34 offset:20640
    ds_read_b64 v[20:21], v35 offset:23312
    s_waitcnt lgkmcnt(2)
    v_pk_fma_f32 v[8:9], v[32:33], v[24:25], v[26:27] op_sel_hi:[0,1,1]
    v_pk_mul_f32 v[10:11], v[8:9], v[8:9]
    v_pk_fma_f32 v[10:11], v[10:11], s[48:49], s[48:49] op_sel:[0,0,1] op_sel_hi:[1,0,1]
    v_pk_mul_f32 v[10:11], v[8:9], v[10:11]
    v_exp_f32 v10, v10
    v_exp_f32 v11, v11
    v_pk_mul_f32 v[8:9], v[8:9], v[28:29]
    v_pk_add_f32 v[10:11], v[10:11], 1.0 op_sel_hi:[1,0]
    v_rcp_f32 v10, v10
    v_rcp_f32 v11, v11
    s_nop 0
    v_pk_fma_f32 v[12:13], v[8:9], v[10:11], v[12:13]
    ds_read_b128 v[24:27], v34 offset:20656
    ds_read_b64 v[28:29], v35 offset:23320
    s_waitcnt lgkmcnt(2)
    v_pk_fma_f32 v[8:9], v[32:33], v[16:17], v[18:19] op_sel_hi:[0,1,1]
    v_pk_mul_f32 v[10:11], v[8:9], v[8:9]
    v_pk_fma_f32 v[10:11], v[10:11], s[48:49], s[48:49] op_sel:[0,0,1] op_sel_hi:[1,0,1]
    v_pk_mul_f32 v[10:11], v[8:9], v[10:11]
    v_exp_f32 v10, v10
    v_exp_f32 v11, v11
    v_pk_mul_f32 v[8:9], v[8:9], v[20:21]
    v_pk_add_f32 v[10:11], v[10:11], 1.0 op_sel_hi:[1,0]
    v_rcp_f32 v10, v10
    v_rcp_f32 v11, v11
    s_nop 0
    v_pk_fma_f32 v[12:13], v[8:9], v[10:11], v[12:13]
    s_waitcnt vmcnt(5)
    s_add_u32 s5, s4, 62
    s_and_b32 s5, s5, 63
    s_lshl_b32 s5, s5, 12
    buffer_load_dwordx4 a[248:251], v1, s[8:11], s5 offen nt
    ds_read_b128 v[16:19], v34 offset:20672
    ds_read_b64 v[20:21], v35 offset:23328
    s_waitcnt lgkmcnt(2)
    v_pk_fma_f32 v[8:9], v[32:33], v[24:25], v[26:27] op_sel_hi:[0,1,1]
    v_pk_mul_f32 v[10:11], v[8:9], v[8:9]
    v_pk_fma_f32 v[10:11], v[10:11], s[48:49], s[48:49] op_sel:[0,0,1] op_sel_hi:[1,0,1]
    v_pk_mul_f32 v[10:11], v[8:9], v[10:11]
    v_exp_f32 v10, v10
    v_exp_f32 v11, v11
    v_pk_mul_f32 v[8:9], v[8:9], v[28:29]
    v_pk_add_f32 v[10:11], v[10:11], 1.0 op_sel_hi:[1,0]
    v_rcp_f32 v10, v10
    v_rcp_f32 v11, v11
    s_nop 0
    v_pk_fma_f32 v[12:13], v[8:9], v[10:11], v[12:13]
    ds_read_b128 v[24:27], v34 offset:20688
    ds_read_b64 v[28:29], v35 offset:23336
    s_waitcnt lgkmcnt(2)
    v_pk_fma_f32 v[8:9], v[32:33], v[16:17], v[18:19] op_sel_hi:[0,1,1]
    v_pk_mul_f32 v[10:11], v[8:9], v[8:9]
    v_pk_fma_f32 v[10:11], v[10:11], s[48:49], s[48:49] op_sel:[0,0,1] op_sel_hi:[1,0,1]
    v_pk_mul_f32 v[10:11], v[8:9], v[10:11]
    v_exp_f32 v10, v10
    v_exp_f32 v11, v11
    v_pk_mul_f32 v[8:9], v[8:9], v[20:21]
    v_pk_add_f32 v[10:11], v[10:11], 1.0 op_sel_hi:[1,0]
    v_rcp_f32 v10, v10
    v_rcp_f32 v11, v11
    s_nop 0
    v_pk_fma_f32 v[12:13], v[8:9], v[10:11], v[12:13]
    s_waitcnt vmcnt(5)
    s_add_u32 s5, s4, 63
    s_and_b32 s5, s5, 63
    s_lshl_b32 s5, s5, 12
    buffer_load_dwordx4 a[252:255], v1, s[8:11], s5 offen nt
    ds_read_b128 v[16:19], v34 offset:20704
    ds_read_b64 v[20:21], v35 offset:23344
    s_waitcnt lgkmcnt(2)
    v_pk_fma_f32 v[8:9], v[32:33], v[24:25], v[26:27] op_sel_hi:[0,1,1]
    v_pk_mul_f32 v[10:11], v[8:9], v[8:9]
    v_pk_fma_f32 v[10:11], v[10:11], s[48:49], s[48:49] op_sel:[0,0,1] op_sel_hi:[1,0,1]
    v_pk_mul_f32 v[10:11], v[8:9], v[10:11]
    v_exp_f32 v10, v10
    v_exp_f32 v11, v11
    v_pk_mul_f32 v[8:9], v[8:9], v[28:29]
    v_pk_add_f32 v[10:11], v[10:11], 1.0 op_sel_hi:[1,0]
    v_rcp_f32 v10, v10
    v_rcp_f32 v11, v11
    s_nop 0
    v_pk_fma_f32 v[12:13], v[8:9], v[10:11], v[12:13]
    ds_read_b128 v[24:27], v34 offset:20720
    ds_read_b64 v[28:29], v35 offset:23352
    s_waitcnt lgkmcnt(2)
    v_pk_fma_f32 v[8:9], v[32:33], v[16:17], v[18:19] op_sel_hi:[0,1,1]
    v_pk_mul_f32 v[10:11], v[8:9], v[8:9]
    v_pk_fma_f32 v[10:11], v[10:11], s[48:49], s[48:49] op_sel:[0,0,1] op_sel_hi:[1,0,1]
    v_pk_mul_f32 v[10:11], v[8:9], v[10:11]
    v_exp_f32 v10, v10
    v_exp_f32 v11, v11
    v_pk_mul_f32 v[8:9], v[8:9], v[20:21]
    v_pk_add_f32 v[10:11], v[10:11], 1.0 op_sel_hi:[1,0]
    v_rcp_f32 v10, v10
    v_rcp_f32 v11, v11
    s_nop 0
    v_pk_fma_f32 v[12:13], v[8:9], v[10:11], v[12:13]
    s_waitcnt vmcnt(5)
    s_add_u32 m0, s54, 0
    s_add_u32 s5, s4, 0
    s_and_b32 s5, s5, 63
    s_lshl_b32 s5, s5, 12
    buffer_load_dwordx4 v2, s[12:15], s5 offen nt lds
    ds_read_b128 v[16:19], v34 offset:20736
    ds_read_b64 v[20:21], v35 offset:23360
    s_waitcnt lgkmcnt(2)
    v_pk_fma_f32 v[8:9], v[32:33], v[24:25], v[26:27] op_sel_hi:[0,1,1]
    v_pk_mul_f32 v[10:11], v[8:9], v[8:9]
    v_pk_fma_f32 v[10:11], v[10:11], s[48:49], s[48:49] op_sel:[0,0,1] op_sel_hi:[1,0,1]
    v_pk_mul_f32 v[10:11], v[8:9], v[10:11]
    v_exp_f32 v10, v10
    v_exp_f32 v11, v11
    v_pk_mul_f32 v[8:9], v[8:9], v[28:29]
    v_pk_add_f32 v[10:11], v[10:11], 1.0 op_sel_hi:[1,0]
    v_rcp_f32 v10, v10
    v_rcp_f32 v11, v11
    s_nop 0
    v_pk_fma_f32 v[12:13], v[8:9], v[10:11], v[12:13]
    ds_read_b128 v[24:27], v34 offset:20752
    ds_read_b64 v[28:29], v35 offset:23368
    s_waitcnt lgkmcnt(2)
    v_pk_fma_f32 v[8:9], v[32:33], v[16:17], v[18:19] op_sel_hi:[0,1,1]
    v_pk_mul_f32 v[10:11], v[8:9], v[8:9]
    v_pk_fma_f32 v[10:11], v[10:11], s[48:49], s[48:49] op_sel:[0,0,1] op_sel_hi:[1,0,1]
    v_pk_mul_f32 v[10:11], v[8:9], v[10:11]
    v_exp_f32 v10, v10
    v_exp_f32 v11, v11
    v_pk_mul_f32 v[8:9], v[8:9], v[20:21]
    v_pk_add_f32 v[10:11], v[10:11], 1.0 op_sel_hi:[1,0]
    v_rcp_f32 v10, v10
    v_rcp_f32 v11, v11
    s_nop 0
    v_pk_fma_f32 v[12:13], v[8:9], v[10:11], v[12:13]
    s_waitcnt vmcnt(5)
    s_add_u32 m0, s54, 1024
    s_add_u32 s5, s4, 1
    s_and_b32 s5, s5, 63
    s_lshl_b32 s5, s5, 12
    buffer_load_dwordx4 v2, s[12:15], s5 offen nt lds
    ds_read_b128 v[16:19], v34 offset:20768
    ds_read_b64 v[20:21], v35 offset:23376
    s_waitcnt lgkmcnt(2)
    v_pk_fma_f32 v[8:9], v[32:33], v[24:25], v[26:27] op_sel_hi:[0,1,1]
    v_pk_mul_f32 v[10:11], v[8:9], v[8:9]
    v_pk_fma_f32 v[10:11], v[10:11], s[48:49], s[48:49] op_sel:[0,0,1] op_sel_hi:[1,0,1]
    v_pk_mul_f32 v[10:11], v[8:9], v[10:11]
    v_exp_f32 v10, v10
    v_exp_f32 v11, v11
    v_pk_mul_f32 v[8:9], v[8:9], v[28:29]
    v_pk_add_f32 v[10:11], v[10:11], 1.0 op_sel_hi:[1,0]
    v_rcp_f32 v10, v10
    v_rcp_f32 v11, v11
    s_nop 0
    v_pk_fma_f32 v[12:13], v[8:9], v[10:11], v[12:13]
    ds_read_b128 v[24:27], v34 offset:20784
    ds_read_b64 v[28:29], v35 offset:23384
    s_waitcnt lgkmcnt(2)
    v_pk_fma_f32 v[8:9], v[32:33], v[16:17], v[18:19] op_sel_hi:[0,1,1]
    v_pk_mul_f32 v[10:11], v[8:9], v[8:9]
    v_pk_fma_f32 v[10:11], v[10:11], s[48:49], s[48:49] op_sel:[0,0,1] op_sel_hi:[1,0,1]
    v_pk_mul_f32 v[10:11], v[8:9], v[10:11]
    v_exp_f32 v10, v10
    v_exp_f32 v11, v11
    v_pk_mul_f32 v[8:9], v[8:9], v[20:21]
    v_pk_add_f32 v[10:11], v[10:11], 1.0 op_sel_hi:[1,0]
    v_rcp_f32 v10, v10
    v_rcp_f32 v11, v11
    s_nop 0
    v_pk_fma_f32 v[12:13], v[8:9], v[10:11], v[12:13]
    s_add_u32 m0, s54, 2048
    s_add_u32 s5, s4, 2
    s_and_b32 s5, s5, 63
    s_lshl_b32 s5, s5, 12
    buffer_load_dwordx4 v2, s[12:15], s5 offen nt lds
    ds_read_b128 v[16:19], v34 offset:20800
    ds_read_b64 v[20:21], v35 offset:23392
    s_waitcnt lgkmcnt(2)
    v_pk_fma_f32 v[8:9], v[32:33], v[24:25], v[26:27] op_sel_hi:[0,1,1]
    v_pk_mul_f32 v[10:11], v[8:9], v[8:9]
    v_pk_fma_f32 v[10:11], v[10:11], s[48:49], s[48:49] op_sel:[0,0,1] op_sel_hi:[1,0,1]
    v_pk_mul_f32 v[10:11], v[8:9], v[10:11]
    v_exp_f32 v10, v10
    v_exp_f32 v11, v11
    v_pk_mul_f32 v[8:9], v[8:9], v[28:29]
    v_pk_add_f32 v[10:11], v[10:11], 1.0 op_sel_hi:[1,0]
    v_rcp_f32 v10, v10
    v_rcp_f32 v11, v11
    s_nop 0
    v_pk_fma_f32 v[12:13], v[8:9], v[10:11], v[12:13]
    ds_read_b128 v[24:27], v34 offset:20816
    ds_read_b64 v[28:29], v35 offset:23400
    s_waitcnt lgkmcnt(2)
    v_pk_fma_f32 v[8:9], v[32:33], v[16:17], v[18:19] op_sel_hi:[0,1,1]
    v_pk_mul_f32 v[10:11], v[8:9], v[8:9]
    v_pk_fma_f32 v[10:11], v[10:11], s[48:49], s[48:49] op_sel:[0,0,1] op_sel_hi:[1,0,1]
    v_pk_mul_f32 v[10:11], v[8:9], v[10:11]
    v_exp_f32 v10, v10
    v_exp_f32 v11, v11
    v_pk_mul_f32 v[8:9], v[8:9], v[20:21]
    v_pk_add_f32 v[10:11], v[10:11], 1.0 op_sel_hi:[1,0]
    v_rcp_f32 v10, v10
    v_rcp_f32 v11, v11
    s_nop 0
    v_pk_fma_f32 v[12:13], v[8:9], v[10:11], v[12:13]
    s_cmp_lg_u32 s0, 0
    s_cbranch_scc1 L_deep_24
    s_waitcnt vmcnt(5)
L_deep_24:
    s_add_u32 m0, s54, 3072
    s_add_u32 s5, s4, 3
    s_and_b32 s5, s5, 63
    s_lshl_b32 s5, s5, 12
    buffer_load_dwordx4 v2, s[12:15], s5 offen nt lds
    ds_read_b128 v[16:19], v34 offset:20832
    ds_read_b64 v[20:21], v35 offset:23408
    s_waitcnt lgkmcnt(2)
    v_pk_fma_f32 v[8:9], v[32:33], v[24:25], v[26:27] op_sel_hi:[0,1,1]
    v_pk_mul_f32 v[10:11], v[8:9], v[8:9]
    v_pk_fma_f32 v[10:11], v[10:11], s[48:49], s[48:49] op_sel:[0,0,1] op_sel_hi:[1,0,1]
    v_pk_mul_f32 v[10:11], v[8:9], v[10:11]
    v_exp_f32 v10, v10
    v_exp_f32 v11, v11
    v_pk_mul_f32 v[8:9], v[8:9], v[28:29]
    v_pk_add_f32 v[10:11], v[10:11], 1.0 op_sel_hi:[1,0]
    v_rcp_f32 v10, v10
    v_rcp_f32 v11, v11
    s_nop 0
    v_pk_fma_f32 v[12:13], v[8:9], v[10:11], v[12:13]
    ds_read_b128 v[24:27], v34 offset:20848
    ds_read_b64 v[28:29], v35 offset:23416
    s_waitcnt lgkmcnt(2)
    v_pk_fma_f32 v[8:9], v[32:33], v[16:17], v[18:19] op_sel_hi:[0,1,1]
    v_pk_mul_f32 v[10:11], v[8:9], v[8:9]
    v_pk_fma_f32 v[10:11], v[10:11], s[48:49], s[48:49] op_sel:[0,0,1] op_sel_hi:[1,0,1]
    v_pk_mul_f32 v[10:11], v[8:9], v[10:11]
    v_exp_f32 v10, v10
    v_exp_f32 v11, v11
    v_pk_mul_f32 v[8:9], v[8:9], v[20:21]
    v_pk_add_f32 v[10:11], v[10:11], 1.0 op_sel_hi:[1,0]
    v_rcp_f32 v10, v10
    v_rcp_f32 v11, v11
    s_nop 0
    v_pk_fma_f32 v[12:13], v[8:9], v[10:11], v[12:13]
    s_waitcnt vmcnt(7)
    s_cmp_lg_u32 s0, 0
    s_cbranch_scc1 L_deep_25
    s_waitcnt vmcnt(5)
L_deep_25:
    s_add_u32 m0, s54, 4096
    s_add_u32 s5, s4, 4
    s_and_b32 s5, s5, 63
    s_lshl_b32 s5, s5, 12
    buffer_load_dwordx4 v2, s[12:15], s5 offen nt lds
    ds_read_b128 v[16:19], v34 offset:20864
    ds_read_b64 v[20:21], v35 offset:23424
    s_waitcnt lgkmcnt(2)
    v_pk_fma_f32 v[8:9], v[32:33], v[24:25], v[26:27] op_sel_hi:[0,1,1]
    v_pk_mul_f32 v[10:11], v[8:9], v[8:9]
    v_pk_fma_f32 v[10:11], v[10:11], s[48:49], s[48:49] op_sel:[0,0,1] op_sel_hi:[1,0,1]
    v_pk_mul_f32 v[10:11], v[8:9], v[10:11]
    v_exp_f32 v10, v10
    v_exp_f32 v11, v11
    v_pk_mul_f32 v[8:9], v[8:9], v[28:29]
    v_pk_add_f32 v[10:11], v[10:11], 1.0 op_sel_hi:[1,0]
    v_rcp_f32 v10, v10
    v_rcp_f32 v11, v11
    s_nop 0
    v_pk_fma_f32 v[12:13], v[8:9], v[10:11], v[12:13]
    ds_read_b128 v[24:27], v34 offset:20880
    ds_read_b64 v[28:29], v35 offset:23432
    s_waitcnt lgkmcnt(2)
    v_pk_fma_f32 v[8:9], v[32:33], v[16:17], v[18:19] op_sel_hi:[0,1,1]
    v_pk_mul_f32 v[10:11], v[8:9], v[8:9]
    v_pk_fma_f32 v[10:11], v[10:11], s[48:49], s[48:49] op_sel:[0,0,1] op_sel_hi:[1,0,1]
    v_pk_mul_f32 v[10:11], v[8:9], v[10:11]
    v_exp_f32 v10, v10
    v_exp_f32 v11, v11
    v_pk_mul_f32 v[8:9], v[8:9], v[20:21]
    v_pk_add_f32 v[10:11], v[10:11], 1.0 op_sel_hi:[1,0]
    v_rcp_f32 v10, v10
    v_rcp_f32 v11, v11
    s_nop 0
    v_pk_fma_f32 v[12:13], v[8:9], v[10:11], v[12:13]
    s_waitcnt vmcnt(7)
    s_cmp_lg_u32 s0, 0
    s_cbranch_scc1 L_deep_26
    s_waitcnt vmcnt(5)
L_deep_26:
    s_add_u32 m0, s54, 5120
    s_add_u32 s5, s4, 5
    s_and_b32 s5, s5, 63
    s_lshl_b32 s5, s5, 12
    buffer_load_dwordx4 v2, s[12:15], s5 offen nt lds
    ds_read_b128 v[16:19], v34 offset:20896
    ds_read_b64 v[20:21], v35 offset:23440
    s_waitcnt lgkmcnt(2)
    v_pk_fma_f32 v[8:9], v[32:33], v[24:25], v[26:27] op_sel_hi:[0,1,1]
    v_pk_mul_f32 v[10:11], v[8:9], v[8:9]
    v_pk_fma_f32 v[10:11], v[10:11], s[48:49], s[48:49] op_sel:[0,0,1] op_sel_hi:[1,0,1]
    v_pk_mul_f32 v[10:11], v[8:9], v[10:11]
    v_exp_f32 v10, v10
    v_exp_f32 v11, v11
    v_pk_mul_f32 v[8:9], v[8:9], v[28:29]
    v_pk_add_f32 v[10:11], v[10:11], 1.0 op_sel_hi:[1,0]
    v_rcp_f32 v10, v10
    v_rcp_f32 v11, v11
    s_nop 0
    v_pk_fma_f32 v[12:13], v[8:9], v[10:11], v[12:13]
    ds_read_b128 v[24:27], v34 offset:20912
    ds_read_b64 v[28:29], v35 offset:23448
    s_waitcnt lgkmcnt(2)
    v_pk_fma_f32 v[8:9], v[32:33], v[16:17], v[18:19] op_sel_hi:[0,1,1]
    v_pk_mul_f32 v[10:11], v[8:9], v[8:9]
    v_pk_fma_f32 v[10:11], v[10:11], s[48:49], s[48:49] op_sel:[0,0,1] op_sel_hi:[1,0,1]
    v_pk_mul_f32 v[10:11], v[8:9], v[10:11]
    v_exp_f32 v10, v10
    v_exp_f32 v11, v11
    v_pk_mul_f32 v[8:9], v[8:9], v[20:21]
    v_pk_add_f32 v[10:11], v[10:11], 1.0 op_sel_hi:[1,0]
    v_rcp_f32 v10, v10
    v_rcp_f32 v11, v11
    s_nop 0
    v_pk_fma_f32 v[12:13], v[8:9], v[10:11], v[12:13]
    s_waitcnt vmcnt(7)
    s_cmp_lg_u32 s0, 0
    s_cbranch_scc1 L_deep_27
    s_waitcnt vmcnt(5)
L_deep_27:
    s_add_u32 m0, s54, 6144
    s_add_u32 s5, s4, 6
    s_and_b32 s5, s5, 63
    s_lshl_b32 s5, s5, 12
    buffer_load_dwordx4 v2, s[12:15], s5 offen nt lds
    ds_read_b128 v[16:19], v34 offset:20928
    ds_read_b64 v[20:21], v35 offset:23456
    s_waitcnt lgkmcnt(2)
    v_pk_fma_f32 v[8:9], v[32:33], v[24:25], v[26:27] op_sel_hi:[0,1,1]
    v_pk_mul_f32 v[10:11], v[8:9], v[8:9]
    v_pk_fma_f32 v[10:11], v[10:11], s[48:49], s[48:49] op_sel:[0,0,1] op_sel_hi:[1,0,1]
    v_pk_mul_f32 v[10:11], v[8:9], v[10:11]
    v_exp_f32 v10, v10
    v_exp_f32 v11, v11
    v_pk_mul_f32 v[8:9], v[8:9], v[28:29]
    v_pk_add_f32 v[10:11], v[10:11], 1.0 op_sel_hi:[1,0]
    v_rcp_f32 v10, v10
    v_rcp_f32 v11, v11
    s_nop 0
    v_pk_fma_f32 v[12:13], v[8:9], v[10:11], v[12:13]
    ds_read_b128 v[24:27], v34 offset:20944
    ds_read_b64 v[28:29], v35 offset:23464
    s_waitcnt lgkmcnt(2)
    v_pk_fma_f32 v[8:9], v[32:33], v[16:17], v[18:19] op_sel_hi:[0,1,1]
    v_pk_mul_f32 v[10:11], v[8:9], v[8:9]
    v_pk_fma_f32 v[10:11], v[10:11], s[48:49], s[48:49] op_sel:[0,0,1] op_sel_hi:[1,0,1]
    v_pk_mul_f32 v[10:11], v[8:9], v[10:11]
    v_exp_f32 v10, v10
    v_exp_f32 v11, v11
    v_pk_mul_f32 v[8:9], v[8:9], v[20:21]
    v_pk_add_f32 v[10:11], v[10:11], 1.0 op_sel_hi:[1,0]
    v_rcp_f32 v10, v10
    v_rcp_f32 v11, v11
    s_nop 0
    v_pk_fma_f32 v[12:13], v[8:9], v[10:11], v[12:13]
    s_waitcnt vmcnt(7)
    s_cmp_lg_u32 s0, 0
    s_cbranch_scc1 L_deep_28
    s_waitcnt vmcnt(5)
L_deep_28:
    s_add_u32 m0, s54, 7168
    s_add_u32 s5, s4, 7
    s_and_b32 s5, s5, 63
    s_lshl_b32 s5, s5, 12
    buffer_load_dwordx4 v2, s[12:15], s5 offen nt lds
    ds_read_b128 v[16:19], v34 offset:20960
    ds_read_b64 v[20:21], v35 offset:23472
    s_waitcnt lgkmcnt(2)
    v_pk_fma_f32 v[8:9], v[32:33], v[24:25], v[26:27] op_sel_hi:[0,1,1]
    v_pk_mul_f32 v[10:11], v[8:9], v[8:9]
    v_pk_fma_f32 v[10:11], v[10:11], s[48:49], s[48:49] op_sel:[0,0,1] op_sel_hi:[1,0,1]
    v_pk_mul_f32 v[10:11], v[8:9], v[10:11]
    v_exp_f32 v10, v10
    v_exp_f32 v11, v11
    v_pk_mul_f32 v[8:9], v[8:9], v[28:29]
    v_pk_add_f32 v[10:11], v[10:11], 1.0 op_sel_hi:[1,0]
    v_rcp_f32 v10, v10
    v_rcp_f32 v11, v11
    s_nop 0
    v_pk_fma_f32 v[12:13], v[8:9], v[10:11], v[12:13]
    ds_read_b128 v[24:27], v34 offset:20976
    ds_read_b64 v[28:29], v35 offset:23480
    s_waitcnt lgkmcnt(2)
    v_pk_fma_f32 v[8:9], v[32:33], v[16:17], v[18:19] op_sel_hi:[0,1,1]
    v_pk_mul_f32 v[10:11], v[8:9], v[8:9]
    v_pk_fma_f32 v[10:11], v[10:11], s[48:49], s[48:49] op_sel:[0,0,1] op_sel_hi:[1,0,1]
    v_pk_mul_f32 v[10:11], v[8:9], v[10:11]
    v_exp_f32 v10, v10
    v_exp_f32 v11, v11
    v_pk_mul_f32 v[8:9], v[8:9], v[20:21]
    v_pk_add_f32 v[10:11], v[10:11], 1.0 op_sel_hi:[1,0]
    v_rcp_f32 v10, v10
    v_rcp_f32 v11, v11
    s_nop 0
    v_pk_fma_f32 v[12:13], v[8:9], v[10:11], v[12:13]
    s_waitcnt vmcnt(7)
    s_cmp_lg_u32 s0, 0
    s_cbranch_scc1 L_deep_29
    s_waitcnt vmcnt(5)
L_deep_29:
    s_add_u32 m0, s54, 8192
    s_add_u32 s5, s4, 8
    s_and_b32 s5, s5, 63
    s_lshl_b32 s5, s5, 12
    buffer_load_dwordx4 v2, s[12:15], s5 offen nt lds
    ds_read_b128 v[16:19], v34 offset:20992
    ds_read_b64 v[20:21], v35 offset:23488
    s_waitcnt lgkmcnt(2)
    v_pk_fma_f32 v[8:9], v[32:33], v[24:25], v[26:27] op_sel_hi:[0,1,1]
    v_pk_mul_f32 v[10:11], v[8:9], v[8:9]
    v_pk_fma_f32 v[10:11], v[10:11], s[48:49], s[48:49] op_sel:[0,0,1] op_sel_hi:[1,0,1]
    v_pk_mul_f32 v[10:11], v[8:9], v[10:11]
    v_exp_f32 v10, v10
    v_exp_f32 v11, v11
    v_pk_mul_f32 v[8:9], v[8:9], v[28:29]
    v_pk_add_f32 v[10:11], v[10:11], 1.0 op_sel_hi:[1,0]
    v_rcp_f32 v10, v10
    v_rcp_f32 v11, v11
    s_nop 0
    v_pk_fma_f32 v[12:13], v[8:9], v[10:11], v[12:13]
    ds_read_b128 v[24:27], v34 offset:21008
    ds_read_b64 v[28:29], v35 offset:23496
    s_waitcnt lgkmcnt(2)
    v_pk_fma_f32 v[8:9], v[32:33], v[16:17], v[18:19] op_sel_hi:[0,1,1]
    v_pk_mul_f32 v[10:11], v[8:9], v[8:9]
    v_pk_fma_f32 v[10:11], v[10:11], s[48:49], s[48:49] op_sel:[0,0,1] op_sel_hi:[1,0,1]
    v_pk_mul_f32 v[10:11], v[8:9], v[10:11]
    v_exp_f32 v10, v10
    v_exp_f32 v11, v11
    v_pk_mul_f32 v[8:9], v[8:9], v[20:21]
    v_pk_add_f32 v[10:11], v[10:11], 1.0 op_sel_hi:[1,0]
    v_rcp_f32 v10, v10
    v_rcp_f32 v11, v11
    s_nop 0
    v_pk_fma_f32 v[12:13], v[8:9], v[10:11], v[12:13]
    s_waitcnt vmcnt(7)
    s_cmp_lg_u32 s0, 0
    s_cbranch_scc1 L_deep_30
    s_waitcnt vmcnt(5)
L_deep_30:
    s_add_u32 m0, s54, 9216
    s_add_u32 s5, s4, 9
    s_and_b32 s5, s5, 63
    s_lshl_b32 s5, s5, 12
    buffer_load_dwordx4 v2, s[12:15], s5 offen nt lds
    ds_read_b128 v[16:19], v34 offset:21024
    ds_read_b64 v[20:21], v35 offset:23504
    s_waitcnt lgkmcnt(2)
    v_pk_fma_f32 v[8:9], v[32:33], v[24:25], v[26:27] op_sel_hi:[0,1,1]
    v_pk_mul_f32 v[10:11], v[8:9], v[8:9]
    v_pk_fma_f32 v[10:11], v[10:11], s[48:49], s[48:49] op_sel:[0,0,1] op_sel_hi:[1,0,1]
    v_pk_mul_f32 v[10:11], v[8:9], v[10:11]
    v_exp_f32 v10, v10
    v_exp_f32 v11, v11
    v_pk_mul_f32 v[8:9], v[8:9], v[28:29]
    v_pk_add_f32 v[10:11], v[10:11], 1.0 op_sel_hi:[1,0]
    v_rcp_f32 v10, v10
    v_rcp_f32 v11, v11
    s_nop 0
    v_pk_fma_f32 v[12:13], v[8:9], v[10:11], v[12:13]
    ds_read_b128 v[24:27], v34 offset:21040
    ds_read_b64 v[28:29], v35 offset:23512
    s_waitcnt lgkmcnt(2)
    v_pk_fma_f32 v[8:9], v[32:33], v[16:17], v[18:19] op_sel_hi:[0,1,1]
    v_pk_mul_f32 v[10:11], v[8:9], v[8:9]
    v_pk_fma_f32 v[10:11], v[10:11], s[48:49], s[48:49] op_sel:[0,0,1] op_sel_hi:[1,0,1]
    v_pk_mul_f32 v[10:11], v[8:9], v[10:11]
    v_exp_f32 v10, v10
    v_exp_f32 v11, v11
    v_pk_mul_f32 v[8:9], v[8:9], v[20:21]
    v_pk_add_f32 v[10:11], v[10:11], 1.0 op_sel_hi:[1,0]
    v_rcp_f32 v10, v10
    v_rcp_f32 v11, v11
    s_nop 0
    v_pk_fma_f32 v[12:13], v[8:9], v[10:11], v[12:13]
    s_waitcnt vmcnt(7)
    s_cmp_lg_u32 s0, 0
    s_cbranch_scc1 L_deep_31
    s_waitcnt vmcnt(5)
L_deep_31:
    s_add_u32 m0, s54, 10240
    s_add_u32 s5, s4, 10
    s_and_b32 s5, s5, 63
    s_lshl_b32 s5, s5, 12
    buffer_load_dwordx4 v2, s[12:15], s5 offen nt lds
    ds_read_b128 v[16:19], v34 offset:21056
    ds_read_b64 v[20:21], v35 offset:23520
    s_waitcnt lgkmcnt(2)
    v_pk_fma_f32 v[8:9], v[32:33], v[24:25], v[26:27] op_sel_hi:[0,1,1]
    v_pk_mul_f32 v[10:11], v[8:9], v[8:9]
    v_pk_fma_f32 v[10:11], v[10:11], s[48:49], s[48:49] op_sel:[0,0,1] op_sel_hi:[1,0,1]
    v_pk_mul_f32 v[10:11], v[8:9], v[10:11]
    v_exp_f32 v10, v10
    v_exp_f32 v11, v11
    v_pk_mul_f32 v[8:9], v[8:9], v[28:29]
    v_pk_add_f32 v[10:11], v[10:11], 1.0 op_sel_hi:[1,0]
    v_rcp_f32 v10, v10
    v_rcp_f32 v11, v11
    s_nop 0
    v_pk_fma_f32 v[12:13], v[8:9], v[10:11], v[12:13]
    ds_read_b128 v[24:27], v34 offset:21072
    ds_read_b64 v[28:29], v35 offset:23528
    s_waitcnt lgkmcnt(2)
    v_pk_fma_f32 v[8:9], v[32:33], v[16:17], v[18:19] op_sel_hi:[0,1,1]
    v_pk_mul_f32 v[10:11], v[8:9], v[8:9]
    v_pk_fma_f32 v[10:11], v[10:11], s[48:49], s[48:49] op_sel:[0,0,1] op_sel_hi:[1,0,1]
    v_pk_mul_f32 v[10:11], v[8:9], v[10:11]
    v_exp_f32 v10, v10
    v_exp_f32 v11, v11
    v_pk_mul_f32 v[8:9], v[8:9], v[20:21]
    v_pk_add_f32 v[10:11], v[10:11], 1.0 op_sel_hi:[1,0]
    v_rcp_f32 v10, v10
    v_rcp_f32 v11, v11
    s_nop 0
    v_pk_fma_f32 v[12:13], v[8:9], v[10:11], v[12:13]
    s_waitcnt vmcnt(7)
    s_cmp_lg_u32 s0, 0
    s_cbranch_scc1 L_deep_32
    s_waitcnt vmcnt(5)
L_deep_32:
    s_add_u32 m0, s54, 11264
    s_add_u32 s5, s4, 11
    s_and_b32 s5, s5, 63
    s_lshl_b32 s5, s5, 12
    buffer_load_dwordx4 v2, s[12:15], s5 offen nt lds
    ds_read_b128 v[16:19], v34 offset:21088
    ds_read_b64 v[20:21], v35 offset:23536
    s_waitcnt lgkmcnt(2)
    v_pk_fma_f32 v[8:9], v[32:33], v[24:25], v[26:27] op_sel_hi:[0,1,1]
    v_pk_mul_f32 v[10:11], v[8:9], v[8:9]
    v_pk_fma_f32 v[10:11], v[10:11], s[48:49], s[48:49] op_sel:[0,0,1] op_sel_hi:[1,0,1]
    v_pk_mul_f32 v[10:11], v[8:9], v[10:11]
    v_exp_f32 v10, v10
    v_exp_f32 v11, v11
    v_pk_mul_f32 v[8:9], v[8:9], v[28:29]
    v_pk_add_f32 v[10:11], v[10:11], 1.0 op_sel_hi:[1,0]
    v_rcp_f32 v10, v10
    v_rcp_f32 v11, v11
    s_nop 0
    v_pk_fma_f32 v[12:13], v[8:9], v[10:11], v[12:13]
    ds_read_b128 v[24:27], v34 offset:21104
    ds_read_b64 v[28:29], v35 offset:23544
    s_waitcnt lgkmcnt(2)
    v_pk_fma_f32 v[8:9], v[32:33], v[16:17], v[18:19] op_sel_hi:[0,1,1]
    v_pk_mul_f32 v[10:11], v[8:9], v[8:9]
    v_pk_fma_f32 v[10:11], v[10:11], s[48:49], s[48:49] op_sel:[0,0,1] op_sel_hi:[1,0,1]
    v_pk_mul_f32 v[10:11], v[8:9], v[10:11]
    v_exp_f32 v10, v10
    v_exp_f32 v11, v11
    v_pk_mul_f32 v[8:9], v[8:9], v[20:21]
    v_pk_add_f32 v[10:11], v[10:11], 1.0 op_sel_hi:[1,0]
    v_rcp_f32 v10, v10
    v_rcp_f32 v11, v11
    s_nop 0
    v_pk_fma_f32 v[12:13], v[8:9], v[10:11], v[12:13]
    s_waitcnt vmcnt(7)
    s_cmp_lg_u32 s0, 0
    s_cbranch_scc1 L_deep_33
    s_waitcnt vmcnt(5)
L_deep_33:
    s_add_u32 m0, s54, 12288
    s_add_u32 s5, s4, 12
    s_and_b32 s5, s5, 63
    s_lshl_b32 s5, s5, 12
    buffer_load_dwordx4 v2, s[12:15], s5 offen nt lds
    ds_read_b128 v[16:19], v34 offset:21120
    ds_read_b64 v[20:21], v35 offset:23552
    s_waitcnt lgkmcnt(2)
    v_pk_fma_f32 v[8:9], v[32:33], v[24:25], v[26:27] op_sel_hi:[0,1,1]
    v_pk_mul_f32 v[10:11], v[8:9], v[8:9]
    v_pk_fma_f32 v[10:11], v[10:11], s[48:49], s[48:49] op_sel:[0,0,1] op_sel_hi:[1,0,1]
    v_pk_mul_f32 v[10:11], v[8:9], v[10:11]
    v_exp_f32 v10, v10
    v_exp_f32 v11, v11
    v_pk_mul_f32 v[8:9], v[8:9], v[28:29]
    v_pk_add_f32 v[10:11], v[10:11], 1.0 op_sel_hi:[1,0]
    v_rcp_f32 v10, v10
    v_rcp_f32 v11, v11
    s_nop 0
    v_pk_fma_f32 v[12:13], v[8:9], v[10:11], v[12:13]
    ds_read_b128 v[24:27], v34 offset:21136
    ds_read_b64 v[28:29], v35 offset:23560
    s_waitcnt lgkmcnt(2)
    v_pk_fma_f32 v[8:9], v[32:33], v[16:17], v[18:19] op_sel_hi:[0,1,1]
    v_pk_mul_f32 v[10:11], v[8:9], v[8:9]
    v_pk_fma_f32 v[10:11], v[10:11], s[48:49], s[48:49] op_sel:[0,0,1] op_sel_hi:[1,0,1]
    v_pk_mul_f32 v[10:11], v[8:9], v[10:11]
    v_exp_f32 v10, v10
    v_exp_f32 v11, v11
    v_pk_mul_f32 v[8:9], v[8:9], v[20:21]
    v_pk_add_f32 v[10:11], v[10:11], 1.0 op_sel_hi:[1,0]
    v_rcp_f32 v10, v10
    v_rcp_f32 v11, v11
    s_nop 0
    v_pk_fma_f32 v[12:13], v[8:9], v[10:11], v[12:13]
    s_waitcnt vmcnt(7)
    s_cmp_lg_u32 s0, 0
    s_cbranch_scc1 L_deep_34
    s_waitcnt vmcnt(5)
L_deep_34:
    s_add_u32 m0, s54, 13312
    s_add_u32 s5, s4, 13
    s_and_b32 s5, s5, 63
    s_lshl_b32 s5, s5, 12
    buffer_load_dwordx4 v2, s[12:15], s5 offen nt lds
    ds_read_b128 v[16:19], v34 offset:21152
    ds_read_b64 v[20:21], v35 offset:23568
    s_waitcnt lgkmcnt(2)
    v_pk_fma_f32 v[8:9], v[32:33], v[24:25], v[26:27] op_sel_hi:[0,1,1]
    v_pk_mul_f32 v[10:11], v[8:9], v[8:9]
    v_pk_fma_f32 v[10:11], v[10:11], s[48:49], s[48:49] op_sel:[0,0,1] op_sel_hi:[1,0,1]
    v_pk_mul_f32 v[10:11], v[8:9], v[10:11]
    v_exp_f32 v10, v10
    v_exp_f32 v11, v11
    v_pk_mul_f32 v[8:9], v[8:9], v[28:29]
    v_pk_add_f32 v[10:11], v[10:11], 1.0 op_sel_hi:[1,0]
    v_rcp_f32 v10, v10
    v_rcp_f32 v11, v11
    s_nop 0
    v_pk_fma_f32 v[12:13], v[8:9], v[10:11], v[12:13]
    ds_read_b128 v[24:27], v34 offset:21168
    ds_read_b64 v[28:29], v35 offset:23576
    s_waitcnt lgkmcnt(2)
    v_pk_fma_f32 v[8:9], v[32:33], v[16:17], v[18:19] op_sel_hi:[0,1,1]
    v_pk_mul_f32 v[10:11], v[8:9], v[8:9]
    v_pk_fma_f32 v[10:11], v[10:11], s[48:49], s[48:49] op_sel:[0,0,1] op_sel_hi:[1,0,1]
    v_pk_mul_f32 v[10:11], v[8:9], v[10:11]
    v_exp_f32 v10, v10
    v_exp_f32 v11, v11
    v_pk_mul_f32 v[8:9], v[8:9], v[20:21]
    v_pk_add_f32 v[10:11], v[10:11], 1.0 op_sel_hi:[1,0]
    v_rcp_f32 v10, v10
    v_rcp_f32 v11, v11
    s_nop 0
    v_pk_fma_f32 v[12:13], v[8:9], v[10:11], v[12:13]
    s_waitcnt vmcnt(7)
    s_cmp_lg_u32 s0, 0
    s_cbranch_scc1 L_deep_35
    s_waitcnt vmcnt(5)
L_deep_35:
    s_add_u32 m0, s54, 14336
    s_add_u32 s5, s4, 14
    s_and_b32 s5, s5, 63
    s_lshl_b32 s5, s5, 12
    buffer_load_dwordx4 v2, s[12:15], s5 offen nt lds
    ds_read_b128 v[16:19], v34 offset:21184
    ds_read_b64 v[20:21], v35 offset:23584
    s_waitcnt lgkmcnt(2)
    v_pk_fma_f32 v[8:9], v[32:33], v[24:25], v[26:27] op_sel_hi:[0,1,1]
    v_pk_mul_f32 v[10:11], v[8:9], v[8:9]
    v_pk_fma_f32 v[10:11], v[10:11], s[48:49], s[48:49] op_sel:[0,0,1] op_sel_hi:[1,0,1]
    v_pk_mul_f32 v[10:11], v[8:9], v[10:11]
    v_exp_f32 v10, v10
    v_exp_f32 v11, v11
    v_pk_mul_f32 v[8:9], v[8:9], v[28:29]
    v_pk_add_f32 v[10:11], v[10:11], 1.0 op_sel_hi:[1,0]
    v_rcp_f32 v10, v10
    v_rcp_f32 v11, v11
    s_nop 0
    v_pk_fma_f32 v[12:13], v[8:9], v[10:11], v[12:13]
    ds_read_b128 v[24:27], v34 offset:21200
    ds_read_b64 v[28:29], v35 offset:23592
    s_waitcnt lgkmcnt(2)
    v_pk_fma_f32 v[8:9], v[32:33], v[16:17], v[18:19] op_sel_hi:[0,1,1]
    v_pk_mul_f32 v[10:11], v[8:9], v[8:9]
    v_pk_fma_f32 v[10:11], v[10:11], s[48:49], s[48:49] op_sel:[0,0,1] op_sel_hi:[1,0,1]
    v_pk_mul_f32 v[10:11], v[8:9], v[10:11]
    v_exp_f32 v10, v10
    v_exp_f32 v11, v11
    v_pk_mul_f32 v[8:9], v[8:9], v[20:21]
    v_pk_add_f32 v[10:11], v[10:11], 1.0 op_sel_hi:[1,0]
    v_rcp_f32 v10, v10
    v_rcp_f32 v11, v11
    s_nop 0
    v_pk_fma_f32 v[12:13], v[8:9], v[10:11], v[12:13]
    s_waitcnt vmcnt(7)
    s_cmp_lg_u32 s0, 0
    s_cbranch_scc1 L_deep_36
    s_waitcnt vmcnt(5)
L_deep_36:
    s_add_u32 m0, s54, 15360
    s_add_u32 s5, s4, 15
    s_and_b32 s5, s5, 63
    s_lshl_b32 s5, s5, 12
    buffer_load_dwordx4 v2, s[12:15], s5 offen nt lds
    ds_read_b128 v[16:19], v34 offset:21216
    ds_read_b64 v[20:21], v35 offset:23600
    s_waitcnt lgkmcnt(2)
    v_pk_fma_f32 v[8:9], v[32:33], v[24:25], v[26:27] op_sel_hi:[0,1,1]
    v_pk_mul_f32 v[10:11], v[8:9], v[8:9]
    v_pk_fma_f32 v[10:11], v[10:11], s[48:49], s[48:49] op_sel:[0,0,1] op_sel_hi:[1,0,1]
    v_pk_mul_f32 v[10:11], v[8:9], v[10:11]
    v_exp_f32 v10, v10
    v_exp_f32 v11, v11
    v_pk_mul_f32 v[8:9], v[8:9], v[28:29]
    v_pk_add_f32 v[10:11], v[10:11], 1.0 op_sel_hi:[1,0]
    v_rcp_f32 v10, v10
    v_rcp_f32 v11, v11
    s_nop 0
    v_pk_fma_f32 v[12:13], v[8:9], v[10:11], v[12:13]
    ds_read_b128 v[24:27], v34 offset:21232
    ds_read_b64 v[28:29], v35 offset:23608
    s_waitcnt lgkmcnt(2)
    v_pk_fma_f32 v[8:9], v[32:33], v[16:17], v[18:19] op_sel_hi:[0,1,1]
    v_pk_mul_f32 v[10:11], v[8:9], v[8:9]
    v_pk_fma_f32 v[10:11], v[10:11], s[48:49], s[48:49] op_sel:[0,0,1] op_sel_hi:[1,0,1]
    v_pk_mul_f32 v[10:11], v[8:9], v[10:11]
    v_exp_f32 v10, v10
    v_exp_f32 v11, v11
    v_pk_mul_f32 v[8:9], v[8:9], v[20:21]
    v_pk_add_f32 v[10:11], v[10:11], 1.0 op_sel_hi:[1,0]
    v_rcp_f32 v10, v10
    v_rcp_f32 v11, v11
    s_nop 0
    v_pk_fma_f32 v[12:13], v[8:9], v[10:11], v[12:13]
    s_waitcnt vmcnt(7)
    s_cmp_lg_u32 s0, 0
    s_cbranch_scc1 L_deep_37
    s_waitcnt vmcnt(5)
L_deep_37:
    s_add_u32 m0, s54, 16384
    s_add_u32 s5, s4, 16
    s_and_b32 s5, s5, 63
    s_lshl_b32 s5, s5, 12
    buffer_load_dwordx4 v2, s[12:15], s5 offen nt lds
    ds_read_b128 v[16:19], v34 offset:21248
    ds_read_b64 v[20:21], v35 offset:23616
    s_waitcnt lgkmcnt(2)
    v_pk_fma_f32 v[8:9], v[32:33], v[24:25], v[26:27] op_sel_hi:[0,1,1]
    v_pk_mul_f32 v[10:11], v[8:9], v[8:9]
    v_pk_fma_f32 v[10:11], v[10:11], s[48:49], s[48:49] op_sel:[0,0,1] op_sel_hi:[1,0,1]
    v_pk_mul_f32 v[10:11], v[8:9], v[10:11]
    v_exp_f32 v10, v10
    v_exp_f32 v11, v11
    v_pk_mul_f32 v[8:9], v[8:9], v[28:29]
    v_pk_add_f32 v[10:11], v[10:11], 1.0 op_sel_hi:[1,0]
    v_rcp_f32 v10, v10
    v_rcp_f32 v11, v11
    s_nop 0
    v_pk_fma_f32 v[12:13], v[8:9], v[10:11], v[12:13]
    ds_read_b128 v[24:27], v34 offset:21264
    ds_read_b64 v[28:29], v35 offset:23624
    s_waitcnt lgkmcnt(2)
    v_pk_fma_f32 v[8:9], v[32:33], v[16:17], v[18:19] op_sel_hi:[0,1,1]
    v_pk_mul_f32 v[10:11], v[8:9], v[8:9]
    v_pk_fma_f32 v[10:11], v[10:11], s[48:49], s[48:49] op_sel:[0,0,1] op_sel_hi:[1,0,1]
    v_pk_mul_f32 v[10:11], v[8:9], v[10:11]
    v_exp_f32 v10, v10
    v_exp_f32 v11, v11
    v_pk_mul_f32 v[8:9], v[8:9], v[20:21]
    v_pk_add_f32 v[10:11], v[10:11], 1.0 op_sel_hi:[1,0]
    v_rcp_f32 v10, v10
    v_rcp_f32 v11, v11
    s_nop 0
    v_pk_fma_f32 v[12:13], v[8:9], v[10:11], v[12:13]
    s_waitcnt vmcnt(7)
    s_cmp_lg_u32 s0, 0
    s_cbranch_scc1 L_deep_38
    s_waitcnt vmcnt(5)
L_deep_38:
    s_add_u32 m0, s54, 17408
    s_add_u32 s5, s4, 17
    s_and_b32 s5, s5, 63
    s_lshl_b32 s5, s5, 12
    buffer_load_dwordx4 v2, s[12:15], s5 offen nt lds
    ds_read_b128 v[16:19], v34 offset:21280
    ds_read_b64 v[20:21], v35 offset:23632
    s_waitcnt lgkmcnt(2)
    v_pk_fma_f32 v[8:9], v[32:33], v[24:25], v[26:27] op_sel_hi:[0,1,1]
    v_pk_mul_f32 v[10:11], v[8:9], v[8:9]
    v_pk_fma_f32 v[10:11], v[10:11], s[48:49], s[48:49] op_sel:[0,0,1] op_sel_hi:[1,0,1]
    v_pk_mul_f32 v[10:11], v[8:9], v[10:11]
    v_exp_f32 v10, v10
    v_exp_f32 v11, v11
    v_pk_mul_f32 v[8:9], v[8:9], v[28:29]
    v_pk_add_f32 v[10:11], v[10:11], 1.0 op_sel_hi:[1,0]
    v_rcp_f32 v10, v10
    v_rcp_f32 v11, v11
    s_nop 0
    v_pk_fma_f32 v[12:13], v[8:9], v[10:11], v[12:13]
    ds_read_b128 v[24:27], v34 offset:21296
    ds_read_b64 v[28:29], v35 offset:23640
    s_waitcnt lgkmcnt(2)
    v_pk_fma_f32 v[8:9], v[32:33], v[16:17], v[18:19] op_sel_hi:[0,1,1]
    v_pk_mul_f32 v[10:11], v[8:9], v[8:9]
    v_pk_fma_f32 v[10:11], v[10:11], s[48:49], s[48:49] op_sel:[0,0,1] op_sel_hi:[1,0,1]
    v_pk_mul_f32 v[10:11], v[8:9], v[10:11]
    v_exp_f32 v10, v10
    v_exp_f32 v11, v11
    v_pk_mul_f32 v[8:9], v[8:9], v[20:21]
    v_pk_add_f32 v[10:11], v[10:11], 1.0 op_sel_hi:[1,0]
    v_rcp_f32 v10, v10
    v_rcp_f32 v11, v11
    s_nop 0
    v_pk_fma_f32 v[12:13], v[8:9], v[10:11], v[12:13]
    s_waitcnt vmcnt(7)
    s_cmp_lg_u32 s0, 0
    s_cbranch_scc1 L_deep_39
    s_waitcnt vmcnt(5)
L_deep_39:
    s_add_u32 m0, s54, 18432
    s_add_u32 s5, s4, 18
    s_and_b32 s5, s5, 63
    s_lshl_b32 s5, s5, 12
    buffer_load_dwordx4 v2, s[12:15], s5 offen nt lds
    ds_read_b128 v[16:19], v34 offset:21312
    ds_read_b64 v[20:21], v35 offset:23648
    s_waitcnt lgkmcnt(2)
    v_pk_fma_f32 v[8:9], v[32:33], v[24:25], v[26:27] op_sel_hi:[0,1,1]
    v_pk_mul_f32 v[10:11], v[8:9], v[8:9]
    v_pk_fma_f32 v[10:11], v[10:11], s[48:49], s[48:49] op_sel:[0,0,1] op_sel_hi:[1,0,1]
    v_pk_mul_f32 v[10:11], v[8:9], v[10:11]
    v_exp_f32 v10, v10
    v_exp_f32 v11, v11
    v_pk_mul_f32 v[8:9], v[8:9], v[28:29]
    v_pk_add_f32 v[10:11], v[10:11], 1.0 op_sel_hi:[1,0]
    v_rcp_f32 v10, v10
    v_rcp_f32 v11, v11
    s_nop 0
    v_pk_fma_f32 v[12:13], v[8:9], v[10:11], v[12:13]
    ds_read_b128 v[24:27], v34 offset:21328
    ds_read_b64 v[28:29], v35 offset:23656
    s_waitcnt lgkmcnt(2)
    v_pk_fma_f32 v[8:9], v[32:33], v[16:17], v[18:19] op_sel_hi:[0,1,1]
    v_pk_mul_f32 v[10:11], v[8:9], v[8:9]
    v_pk_fma_f32 v[10:11], v[10:11], s[48:49], s[48:49] op_sel:[0,0,1] op_sel_hi:[1,0,1]
    v_pk_mul_f32 v[10:11], v[8:9], v[10:11]
    v_exp_f32 v10, v10
    v_exp_f32 v11, v11
    v_pk_mul_f32 v[8:9], v[8:9], v[20:21]
    v_pk_add_f32 v[10:11], v[10:11], 1.0 op_sel_hi:[1,0]
    v_rcp_f32 v10, v10
    v_rcp_f32 v11, v11
    s_nop 0
    v_pk_fma_f32 v[12:13], v[8:9], v[10:11], v[12:13]
    s_waitcnt vmcnt(7)
    s_cmp_lg_u32 s0, 0
    s_cbranch_scc1 L_deep_40
    s_waitcnt vmcnt(5)
L_deep_40:
    s_add_u32 m0, s54, 19456
    s_add_u32 s5, s4, 19
    s_and_b32 s5, s5, 63
    s_lshl_b32 s5, s5, 12
    buffer_load_dwordx4 v2, s[12:15], s5 offen nt lds
    ds_read_b128 v[16:19], v34 offset:21344
    ds_read_b64 v[20:21], v35 offset:23664
    s_waitcnt lgkmcnt(2)
    v_pk_fma_f32 v[8:9], v[32:33], v[24:25], v[26:27] op_sel_hi:[0,1,1]
    v_pk_mul_f32 v[10:11], v[8:9], v[8:9]
    v_pk_fma_f32 v[10:11], v[10:11], s[48:49], s[48:49] op_sel:[0,0,1] op_sel_hi:[1,0,1]
    v_pk_mul_f32 v[10:11], v[8:9], v[10:11]
    v_exp_f32 v10, v10
    v_exp_f32 v11, v11
    v_pk_mul_f32 v[8:9], v[8:9], v[28:29]
    v_pk_add_f32 v[10:11], v[10:11], 1.0 op_sel_hi:[1,0]
    v_rcp_f32 v10, v10
    v_rcp_f32 v11, v11
    s_nop 0
    v_pk_fma_f32 v[12:13], v[8:9], v[10:11], v[12:13]
    ds_read_b128 v[24:27], v34 offset:21360
    ds_read_b64 v[28:29], v35 offset:23672
    s_waitcnt lgkmcnt(2)
    v_pk_fma_f32 v[8:9], v[32:33], v[16:17], v[18:19] op_sel_hi:[0,1,1]
    v_pk_mul_f32 v[10:11], v[8:9], v[8:9]
    v_pk_fma_f32 v[10:11], v[10:11], s[48:49], s[48:49] op_sel:[0,0,1] op_sel_hi:[1,0,1]
    v_pk_mul_f32 v[10:11], v[8:9], v[10:11]
    v_exp_f32 v10, v10
    v_exp_f32 v11, v11
    v_pk_mul_f32 v[8:9], v[8:9], v[20:21]
    v_pk_add_f32 v[10:11], v[10:11], 1.0 op_sel_hi:[1,0]
    v_rcp_f32 v10, v10
    v_rcp_f32 v11, v11
    s_nop 0
    v_pk_fma_f32 v[12:13], v[8:9], v[10:11], v[12:13]
    s_waitcnt vmcnt(7)
    s_cmp_lg_u32 s0, 0
    s_cbranch_scc1 L_deep_41
    s_waitcnt vmcnt(5)
L_deep_41:
    s_add_u32 s5, s4, 20
    s_and_b32 s5, s5, 63
    s_lshl_b32 s5, s5, 12
    buffer_load_dwordx4 v[80:83], v2, s[12:15], s5 offen nt
    ds_read_b128 v[16:19], v34 offset:21376
    ds_read_b64 v[20:21], v35 offset:23680
    s_waitcnt lgkmcnt(2)
    v_pk_fma_f32 v[8:9], v[32:33], v[24:25], v[26:27] op_sel_hi:[0,1,1]
    v_pk_mul_f32 v[10:11], v[8:9], v[8:9]
    v_pk_fma_f32 v[10:11], v[10:11], s[48:49], s[48:49] op_sel:[0,0,1] op_sel_hi:[1,0,1]
    v_pk_mul_f32 v[10:11], v[8:9], v[10:11]
    v_exp_f32 v10, v10
    v_exp_f32 v11, v11
    v_pk_mul_f32 v[8:9], v[8:9], v[28:29]
    v_pk_add_f32 v[10:11], v[10:11], 1.0 op_sel_hi:[1,0]
    v_rcp_f32 v10, v10
    v_rcp_f32 v11, v11
    s_nop 0
    v_pk_fma_f32 v[12:13], v[8:9], v[10:11], v[12:13]
    ds_read_b128 v[24:27], v34 offset:21392
    ds_read_b64 v[28:29], v35 offset:23688
    s_waitcnt lgkmcnt(2)
    v_pk_fma_f32 v[8:9], v[32:33], v[16:17], v[18:19] op_sel_hi:[0,1,1]
    v_pk_mul_f32 v[10:11], v[8:9], v[8:9]
    v_pk_fma_f32 v[10:11], v[10:11], s[48:49], s[48:49] op_sel:[0,0,1] op_sel_hi:[1,0,1]
    v_pk_mul_f32 v[10:11], v[8:9], v[10:11]
    v_exp_f32 v10, v10
    v_exp_f32 v11, v11
    v_pk_mul_f32 v[8:9], v[8:9], v[20:21]
    v_pk_add_f32 v[10:11], v[10:11], 1.0 op_sel_hi:[1,0]
    v_rcp_f32 v10, v10
    v_rcp_f32 v11, v11
    s_nop 0
    v_pk_fma_f32 v[12:13], v[8:9], v[10:11], v[12:13]
    s_waitcnt vmcnt(7)
    s_cmp_lg_u32 s0, 0
    s_cbranch_scc1 L_deep_42
    s_waitcnt vmcnt(5)
L_deep_42:
    s_add_u32 s5, s4, 21
    s_and_b32 s5, s5, 63
    s_lshl_b32 s5, s5, 12
    buffer_load_dwordx4 v[84:87], v2, s[12:15], s5 offen nt
    ds_read_b128 v[16:19], v34 offset:21408
    ds_read_b64 v[20:21], v35 offset:23696
    s_waitcnt lgkmcnt(2)
    v_pk_fma_f32 v[8:9], v[32:33], v[24:25], v[26:27] op_sel_hi:[0,1,1]
    v_pk_mul_f32 v[10:11], v[8:9], v[8:9]
    v_pk_fma_f32 v[10:11], v[10:11], s[48:49], s[48:49] op_sel:[0,0,1] op_sel_hi:[1,0,1]
    v_pk_mul_f32 v[10:11], v[8:9], v[10:11]
    v_exp_f32 v10, v10
    v_exp_f32 v11, v11
    v_pk_mul_f32 v[8:9], v[8:9], v[28:29]
    v_pk_add_f32 v[10:11], v[10:11], 1.0 op_sel_hi:[1,0]
    v_rcp_f32 v10, v10
    v_rcp_f32 v11, v11
    s_nop 0
    v_pk_fma_f32 v[12:13], v[8:9], v[10:11], v[12:13]
    ds_read_b128 v[24:27], v34 offset:21424
    ds_read_b64 v[28:29], v35 offset:23704
    s_waitcnt lgkmcnt(2)
    v_pk_fma_f32 v[8:9], v[32:33], v[16:17], v[18:19] op_sel_hi:[0,1,1]
    v_pk_mul_f32 v[10:11], v[8:9], v[8:9]
    v_pk_fma_f32 v[10:11], v[10:11], s[48:49], s[48:49] op_sel:[0,0,1] op_sel_hi:[1,0,1]
    v_pk_mul_f32 v[10:11], v[8:9], v[10:11]
    v_exp_f32 v10, v10
    v_exp_f32 v11, v11
    v_pk_mul_f32 v[8:9], v[8:9], v[20:21]
    v_pk_add_f32 v[10:11], v[10:11], 1.0 op_sel_hi:[1,0]
    v_rcp_f32 v10, v10
    v_rcp_f32 v11, v11
    s_nop 0
    v_pk_fma_f32 v[12:13], v[8:9], v[10:11], v[12:13]
    s_waitcnt vmcnt(7)
    s_cmp_lg_u32 s0, 0
    s_cbranch_scc1 L_deep_43
    s_waitcnt vmcnt(5)
L_deep_43:
    s_add_u32 s5, s4, 22
    s_and_b32 s5, s5, 63
    s_lshl_b32 s5, s5, 12
    buffer_load_dwordx4 v[88:91], v2, s[12:15], s5 offen nt
    ds_read_b128 v[16:19], v34 offset:21440
    ds_read_b64 v[20:21], v35 offset:23712
    s_waitcnt lgkmcnt(2)
    v_pk_fma_f32 v[8:9], v[32:33], v[24:25], v[26:27] op_sel_hi:[0,1,1]
    v_pk_mul_f32 v[10:11], v[8:9], v[8:9]
    v_pk_fma_f32 v[10:11], v[10:11], s[48:49], s[48:49] op_sel:[0,0,1] op_sel_hi:[1,0,1]
    v_pk_mul_f32 v[10:11], v[8:9], v[10:11]
    v_exp_f32 v10, v10
    v_exp_f32 v11, v11
    v_pk_mul_f32 v[8:9], v[8:9], v[28:29]
    v_pk_add_f32 v[10:11], v[10:11], 1.0 op_sel_hi:[1,0]
    v_rcp_f32 v10, v10
    v_rcp_f32 v11, v11
    s_nop 0
    v_pk_fma_f32 v[12:13], v[8:9], v[10:11], v[12:13]
    ds_read_b128 v[24:27], v34 offset:21456
    ds_read_b64 v[28:29], v35 offset:23720
    s_waitcnt lgkmcnt(2)
    v_pk_fma_f32 v[8:9], v[32:33], v[16:17], v[18:19] op_sel_hi:[0,1,1]
    v_pk_mul_f32 v[10:11], v[8:9], v[8:9]
    v_pk_fma_f32 v[10:11], v[10:11], s[48:49], s[48:49] op_sel:[0,0,1] op_sel_hi:[1,0,1]
    v_pk_mul_f32 v[10:11], v[8:9], v[10:11]
    v_exp_f32 v10, v10
    v_exp_f32 v11, v11
    v_pk_mul_f32 v[8:9], v[8:9], v[20:21]
    v_pk_add_f32 v[10:11], v[10:11], 1.0 op_sel_hi:[1,0]
    v_rcp_f32 v10, v10
    v_rcp_f32 v11, v11
    s_nop 0
    v_pk_fma_f32 v[12:13], v[8:9], v[10:11], v[12:13]
    s_waitcnt vmcnt(7)
    s_cmp_lg_u32 s0, 0
    s_cbranch_scc1 L_deep_44
    s_waitcnt vmcnt(5)
L_deep_44:
    s_add_u32 s5, s4, 23
    s_and_b32 s5, s5, 63
    s_lshl_b32 s5, s5, 12
    buffer_load_dwordx4 v[92:95], v2, s[12:15], s5 offen nt
    ds_read_b128 v[16:19], v34 offset:21472
    ds_read_b64 v[20:21], v35 offset:23728
    s_waitcnt lgkmcnt(2)
    v_pk_fma_f32 v[8:9], v[32:33], v[24:25], v[26:27] op_sel_hi:[0,1,1]
    v_pk_mul_f32 v[10:11], v[8:9], v[8:9]
    v_pk_fma_f32 v[10:11], v[10:11], s[48:49], s[48:49] op_sel:[0,0,1] op_sel_hi:[1,0,1]
    v_pk_mul_f32 v[10:11], v[8:9], v[10:11]
    v_exp_f32 v10, v10
    v_exp_f32 v11, v11
    v_pk_mul_f32 v[8:9], v[8:9], v[28:29]
    v_pk_add_f32 v[10:11], v[10:11], 1.0 op_sel_hi:[1,0]
    v_rcp_f32 v10, v10
    v_rcp_f32 v11, v11
    s_nop 0
    v_pk_fma_f32 v[12:13], v[8:9], v[10:11], v[12:13]
    ds_read_b128 v[24:27], v34 offset:21488
    ds_read_b64 v[28:29], v35 offset:23736
    s_waitcnt lgkmcnt(2)
    v_pk_fma_f32 v[8:9], v[32:33], v[16:17], v[18:19] op_sel_hi:[0,1,1]
    v_pk_mul_f32 v[10:11], v[8:9], v[8:9]
    v_pk_fma_f32 v[10:11], v[10:11], s[48:49], s[48:49] op_sel:[0,0,1] op_sel_hi:[1,0,1]
    v_pk_mul_f32 v[10:11], v[8:9], v[10:11]
    v_exp_f32 v10, v10
    v_exp_f32 v11, v11
    v_pk_mul_f32 v[8:9], v[8:9], v[20:21]
    v_pk_add_f32 v[10:11], v[10:11], 1.0 op_sel_hi:[1,0]
    v_rcp_f32 v10, v10
    v_rcp_f32 v11, v11
    s_nop 0
    v_pk_fma_f32 v[12:13], v[8:9], v[10:11], v[12:13]
    s_waitcnt vmcnt(7)
    s_cmp_lg_u32 s0, 0
    s_cbranch_scc1 L_deep_45
    s_waitcnt vmcnt(5)
L_deep_45:
    s_add_u32 s5, s4, 24
    s_and_b32 s5, s5, 63
    s_lshl_b32 s5, s5, 12
    buffer_load_dwordx4 v[96:99], v2, s[12:15], s5 offen nt
    ds_read_b128 v[16:19], v34 offset:21504
    ds_read_b64 v[20:21], v35 offset:23744
    s_waitcnt lgkmcnt(2)
    v_pk_fma_f32 v[8:9], v[32:33], v[24:25], v[26:27] op_sel_hi:[0,1,1]
    v_pk_mul_f32 v[10:11], v[8:9], v[8:9]
    v_pk_fma_f32 v[10:11], v[10:11], s[48:49], s[48:49] op_sel:[0,0,1] op_sel_hi:[1,0,1]
    v_pk_mul_f32 v[10:11], v[8:9], v[10:11]
    v_exp_f32 v10, v10
    v_exp_f32 v11, v11
    v_pk_mul_f32 v[8:9], v[8:9], v[28:29]
    v_pk_add_f32 v[10:11], v[10:11], 1.0 op_sel_hi:[1,0]
    v_rcp_f32 v10, v10
    v_rcp_f32 v11, v11
    s_nop 0
    v_pk_fma_f32 v[12:13], v[8:9], v[10:11], v[12:13]
    ds_read_b128 v[24:27], v34 offset:21520
    ds_read_b64 v[28:29], v35 offset:23752
    s_waitcnt lgkmcnt(2)
    v_pk_fma_f32 v[8:9], v[32:33], v[16:17], v[18:19] op_sel_hi:[0,1,1]
    v_pk_mul_f32 v[10:11], v[8:9], v[8:9]
    v_pk_fma_f32 v[10:11], v[10:11], s[48:49], s[48:49] op_sel:[0,0,1] op_sel_hi:[1,0,1]
    v_pk_mul_f32 v[10:11], v[8:9], v[10:11]
    v_exp_f32 v10, v10
    v_exp_f32 v11, v11
    v_pk_mul_f32 v[8:9], v[8:9], v[20:21]
    v_pk_add_f32 v[10:11], v[10:11], 1.0 op_sel_hi:[1,0]
    v_rcp_f32 v10, v10
    v_rcp_f32 v11, v11
    s_nop 0
    v_pk_fma_f32 v[12:13], v[8:9], v[10:11], v[12:13]
    s_waitcnt vmcnt(7)
    s_cmp_lg_u32 s0, 0
    s_cbranch_scc1 L_deep_46
    s_waitcnt vmcnt(5)
L_deep_46:
    s_add_u32 s5, s4, 25
    s_and_b32 s5, s5, 63
    s_lshl_b32 s5, s5, 12
    buffer_load_dwordx4 v[100:103], v2, s[12:15], s5 offen nt
    ds_read_b128 v[16:19], v34 offset:21536
    ds_read_b64 v[20:21], v35 offset:23760
    s_waitcnt lgkmcnt(2)
    v_pk_fma_f32 v[8:9], v[32:33], v[24:25], v[26:27] op_sel_hi:[0,1,1]
    v_pk_mul_f32 v[10:11], v[8:9], v[8:9]
    v_pk_fma_f32 v[10:11], v[10:11], s[48:49], s[48:49] op_sel:[0,0,1] op_sel_hi:[1,0,1]
    v_pk_mul_f32 v[10:11], v[8:9], v[10:11]
    v_exp_f32 v10, v10
    v_exp_f32 v11, v11
    v_pk_mul_f32 v[8:9], v[8:9], v[28:29]
    v_pk_add_f32 v[10:11], v[10:11], 1.0 op_sel_hi:[1,0]
    v_rcp_f32 v10, v10
    v_rcp_f32 v11, v11
    s_nop 0
    v_pk_fma_f32 v[12:13], v[8:9], v[10:11], v[12:13]
    ds_read_b128 v[24:27], v34 offset:21552
    ds_read_b64 v[28:29], v35 offset:23768
    s_waitcnt lgkmcnt(2)
    v_pk_fma_f32 v[8:9], v[32:33], v[16:17], v[18:19] op_sel_hi:[0,1,1]
    v_pk_mul_f32 v[10:11], v[8:9], v[8:9]
    v_pk_fma_f32 v[10:11], v[10:11], s[48:49], s[48:49] op_sel:[0,0,1] op_sel_hi:[1,0,1]
    v_pk_mul_f32 v[10:11], v[8:9], v[10:11]
    v_exp_f32 v10, v10
    v_exp_f32 v11, v11
    v_pk_mul_f32 v[8:9], v[8:9], v[20:21]
    v_pk_add_f32 v[10:11], v[10:11], 1.0 op_sel_hi:[1,0]
    v_rcp_f32 v10, v10
    v_rcp_f32 v11, v11
    s_nop 0
    v_pk_fma_f32 v[12:13], v[8:9], v[10:11], v[12:13]
    s_waitcnt vmcnt(7)
    s_cmp_lg_u32 s0, 0
    s_cbranch_scc1 L_deep_47
    s_waitcnt vmcnt(5)
L_deep_47:
    s_add_u32 s5, s4, 26
    s_and_b32 s5, s5, 63
    s_lshl_b32 s5, s5, 12
    buffer_load_dwordx4 v[104:107], v2, s[12:15], s5 offen nt
    ds_read_b128 v[16:19], v34 offset:21568
    ds_read_b64 v[20:21], v35 offset:23776
    s_waitcnt lgkmcnt(2)
    v_pk_fma_f32 v[8:9], v[32:33], v[24:25], v[26:27] op_sel_hi:[0,1,1]
    v_pk_mul_f32 v[10:11], v[8:9], v[8:9]
    v_pk_fma_f32 v[10:11], v[10:11], s[48:49], s[48:49] op_sel:[0,0,1] op_sel_hi:[1,0,1]
    v_pk_mul_f32 v[10:11], v[8:9], v[10:11]
    v_exp_f32 v10, v10
    v_exp_f32 v11, v11
    v_pk_mul_f32 v[8:9], v[8:9], v[28:29]
    v_pk_add_f32 v[10:11], v[10:11], 1.0 op_sel_hi:[1,0]
    v_rcp_f32 v10, v10
    v_rcp_f32 v11, v11
    s_nop 0
    v_pk_fma_f32 v[12:13], v[8:9], v[10:11], v[12:13]
    ds_read_b128 v[24:27], v34 offset:21584
    ds_read_b64 v[28:29], v35 offset:23784
    s_waitcnt lgkmcnt(2)
    v_pk_fma_f32 v[8:9], v[32:33], v[16:17], v[18:19] op_sel_hi:[0,1,1]
    v_pk_mul_f32 v[10:11], v[8:9], v[8:9]
    v_pk_fma_f32 v[10:11], v[10:11], s[48:49], s[48:49] op_sel:[0,0,1] op_sel_hi:[1,0,1]
    v_pk_mul_f32 v[10:11], v[8:9], v[10:11]
    v_exp_f32 v10, v10
    v_exp_f32 v11, v11
    v_pk_mul_f32 v[8:9], v[8:9], v[20:21]
    v_pk_add_f32 v[10:11], v[10:11], 1.0 op_sel_hi:[1,0]
    v_rcp_f32 v10, v10
    v_rcp_f32 v11, v11
    s_nop 0
    v_pk_fma_f32 v[12:13], v[8:9], v[10:11], v[12:13]
    s_waitcnt vmcnt(7)
    s_cmp_lg_u32 s0, 0
    s_cbranch_scc1 L_deep_48
    s_waitcnt vmcnt(5)
L_deep_48:
    s_add_u32 s5, s4, 27
    s_and_b32 s5, s5, 63
    s_lshl_b32 s5, s5, 12
    buffer_load_dwordx4 v[108:111], v2, s[12:15], s5 offen nt
    ds_read_b128 v[16:19], v34 offset:21600
    ds_read_b64 v[20:21], v35 offset:23792
    s_waitcnt lgkmcnt(2)
    v_pk_fma_f32 v[8:9], v[32:33], v[24:25], v[26:27] op_sel_hi:[0,1,1]
    v_pk_mul_f32 v[10:11], v[8:9], v[8:9]
    v_pk_fma_f32 v[10:11], v[10:11], s[48:49], s[48:49] op_sel:[0,0,1] op_sel_hi:[1,0,1]
    v_pk_mul_f32 v[10:11], v[8:9], v[10:11]
    v_exp_f32 v10, v10
    v_exp_f32 v11, v11
    v_pk_mul_f32 v[8:9], v[8:9], v[28:29]
    v_pk_add_f32 v[10:11], v[10:11], 1.0 op_sel_hi:[1,0]
    v_rcp_f32 v10, v10
    v_rcp_f32 v11, v11
    s_nop 0
    v_pk_fma_f32 v[12:13], v[8:9], v[10:11], v[12:13]
    ds_read_b128 v[24:27], v34 offset:21616
    ds_read_b64 v[28:29], v35 offset:23800
    s_waitcnt lgkmcnt(2)
    v_pk_fma_f32 v[8:9], v[32:33], v[16:17], v[18:19] op_sel_hi:[0,1,1]
    v_pk_mul_f32 v[10:11], v[8:9], v[8:9]
    v_pk_fma_f32 v[10:11], v[10:11], s[48:49], s[48:49] op_sel:[0,0,1] op_sel_hi:[1,0,1]
    v_pk_mul_f32 v[10:11], v[8:9], v[10:11]
    v_exp_f32 v10, v10
    v_exp_f32 v11, v11
    v_pk_mul_f32 v[8:9], v[8:9], v[20:21]
    v_pk_add_f32 v[10:11], v[10:11], 1.0 op_sel_hi:[1,0]
    v_rcp_f32 v10, v10
    v_rcp_f32 v11, v11
    s_nop 0
    v_pk_fma_f32 v[12:13], v[8:9], v[10:11], v[12:13]
    s_waitcnt vmcnt(7)
    s_cmp_lg_u32 s0, 0
    s_cbranch_scc1 L_deep_49
    s_waitcnt vmcnt(5)
L_deep_49:
    s_add_u32 s5, s4, 28
    s_and_b32 s5, s5, 63
    s_lshl_b32 s5, s5, 12
    buffer_load_dwordx4 v[112:115], v2, s[12:15], s5 offen nt
    ds_read_b128 v[16:19], v34 offset:21632
    ds_read_b64 v[20:21], v35 offset:23808
    s_waitcnt lgkmcnt(2)
    v_pk_fma_f32 v[8:9], v[32:33], v[24:25], v[26:27] op_sel_hi:[0,1,1]
    v_pk_mul_f32 v[10:11], v[8:9], v[8:9]
    v_pk_fma_f32 v[10:11], v[10:11], s[48:49], s[48:49] op_sel:[0,0,1] op_sel_hi:[1,0,1]
    v_pk_mul_f32 v[10:11], v[8:9], v[10:11]
    v_exp_f32 v10, v10
    v_exp_f32 v11, v11
    v_pk_mul_f32 v[8:9], v[8:9], v[28:29]
    v_pk_add_f32 v[10:11], v[10:11], 1.0 op_sel_hi:[1,0]
    v_rcp_f32 v10, v10
    v_rcp_f32 v11, v11
    s_nop 0
    v_pk_fma_f32 v[12:13], v[8:9], v[10:11], v[12:13]
    ds_read_b128 v[24:27], v34 offset:21648
    ds_read_b64 v[28:29], v35 offset:23816
    s_waitcnt lgkmcnt(2)
    v_pk_fma_f32 v[8:9], v[32:33], v[16:17], v[18:19] op_sel_hi:[0,1,1]
    v_pk_mul_f32 v[10:11], v[8:9], v[8:9]
    v_pk_fma_f32 v[10:11], v[10:11], s[48:49], s[48:49] op_sel:[0,0,1] op_sel_hi:[1,0,1]
    v_pk_mul_f32 v[10:11], v[8:9], v[10:11]
    v_exp_f32 v10, v10
    v_exp_f32 v11, v11
    v_pk_mul_f32 v[8:9], v[8:9], v[20:21]
    v_pk_add_f32 v[10:11], v[10:11], 1.0 op_sel_hi:[1,0]
    v_rcp_f32 v10, v10
    v_rcp_f32 v11, v11
    s_nop 0
    v_pk_fma_f32 v[12:13], v[8:9], v[10:11], v[12:13]
    s_waitcnt vmcnt(7)
    s_cmp_lg_u32 s0, 0
    s_cbranch_scc1 L_deep_50
    s_waitcnt vmcnt(5)
L_deep_50:
    s_add_u32 s5, s4, 29
    s_and_b32 s5, s5, 63
    s_lshl_b32 s5, s5, 12
    buffer_load_dwordx4 v[116:119], v2, s[12:15], s5 offen nt
    ds_read_b128 v[16:19], v34 offset:21664
    ds_read_b64 v[20:21], v35 offset:23824
    s_waitcnt lgkmcnt(2)
    v_pk_fma_f32 v[8:9], v[32:33], v[24:25], v[26:27] op_sel_hi:[0,1,1]
    v_pk_mul_f32 v[10:11], v[8:9], v[8:9]
    v_pk_fma_f32 v[10:11], v[10:11], s[48:49], s[48:49] op_sel:[0,0,1] op_sel_hi:[1,0,1]
    v_pk_mul_f32 v[10:11], v[8:9], v[10:11]
    v_exp_f32 v10, v10
    v_exp_f32 v11, v11
    v_pk_mul_f32 v[8:9], v[8:9], v[28:29]
    v_pk_add_f32 v[10:11], v[10:11], 1.0 op_sel_hi:[1,0]
    v_rcp_f32 v10, v10
    v_rcp_f32 v11, v11
    s_nop 0
    v_pk_fma_f32 v[12:13], v[8:9], v[10:11], v[12:13]
    ds_read_b128 v[24:27], v34 offset:21680
    ds_read_b64 v[28:29], v35 offset:23832
    s_waitcnt lgkmcnt(2)
    v_pk_fma_f32 v[8:9], v[32:33], v[16:17], v[18:19] op_sel_hi:[0,1,1]
    v_pk_mul_f32 v[10:11], v[8:9], v[8:9]
    v_pk_fma_f32 v[10:11], v[10:11], s[48:49], s[48:49] op_sel:[0,0,1] op_sel_hi:[1,0,1]
    v_pk_mul_f32 v[10:11], v[8:9], v[10:11]
    v_exp_f32 v10, v10
    v_exp_f32 v11, v11
    v_pk_mul_f32 v[8:9], v[8:9], v[20:21]
    v_pk_add_f32 v[10:11], v[10:11], 1.0 op_sel_hi:[1,0]
    v_rcp_f32 v10, v10
    v_rcp_f32 v11, v11
    s_nop 0
    v_pk_fma_f32 v[12:13], v[8:9], v[10:11], v[12:13]
    s_waitcnt vmcnt(7)
    s_cmp_lg_u32 s0, 0
    s_cbranch_scc1 L_deep_51
    s_waitcnt vmcnt(5)
L_deep_51:
    s_add_u32 s5, s4, 30
    s_and_b32 s5, s5, 63
    s_lshl_b32 s5, s5, 12
    buffer_load_dwordx4 v[120:123], v2, s[12:15], s5 offen nt
    ds_read_b128 v[16:19], v34 offset:21696
    ds_read_b64 v[20:21], v35 offset:23840
    s_waitcnt lgkmcnt(2)
    v_pk_fma_f32 v[8:9], v[32:33], v[24:25], v[26:27] op_sel_hi:[0,1,1]
    v_pk_mul_f32 v[10:11], v[8:9], v[8:9]
    v_pk_fma_f32 v[10:11], v[10:11], s[48:49], s[48:49] op_sel:[0,0,1] op_sel_hi:[1,0,1]
    v_pk_mul_f32 v[10:11], v[8:9], v[10:11]
    v_exp_f32 v10, v10
    v_exp_f32 v11, v11
    v_pk_mul_f32 v[8:9], v[8:9], v[28:29]
    v_pk_add_f32 v[10:11], v[10:11], 1.0 op_sel_hi:[1,0]
    v_rcp_f32 v10, v10
    v_rcp_f32 v11, v11
    s_nop 0
    v_pk_fma_f32 v[12:13], v[8:9], v[10:11], v[12:13]
    ds_read_b128 v[24:27], v34 offset:21712
    ds_read_b64 v[28:29], v35 offset:23848
    s_waitcnt lgkmcnt(2)
    v_pk_fma_f32 v[8:9], v[32:33], v[16:17], v[18:19] op_sel_hi:[0,1,1]
    v_pk_mul_f32 v[10:11], v[8:9], v[8:9]
    v_pk_fma_f32 v[10:11], v[10:11], s[48:49], s[48:49] op_sel:[0,0,1] op_sel_hi:[1,0,1]
    v_pk_mul_f32 v[10:11], v[8:9], v[10:11]
    v_exp_f32 v10, v10
    v_exp_f32 v11, v11
    v_pk_mul_f32 v[8:9], v[8:9], v[20:21]
    v_pk_add_f32 v[10:11], v[10:11], 1.0 op_sel_hi:[1,0]
    v_rcp_f32 v10, v10
    v_rcp_f32 v11, v11
    s_nop 0
    v_pk_fma_f32 v[12:13], v[8:9], v[10:11], v[12:13]
    s_waitcnt vmcnt(7)
    s_cmp_lg_u32 s0, 0
    s_cbranch_scc1 L_deep_52
    s_waitcnt vmcnt(5)
L_deep_52:
    s_add_u32 s5, s4, 31
    s_and_b32 s5, s5, 63
    s_lshl_b32 s5, s5, 12
    buffer_load_dwordx4 v[124:127], v2, s[12:15], s5 offen nt
    ds_read_b128 v[16:19], v34 offset:21728
    ds_read_b64 v[20:21], v35 offset:23856
    s_waitcnt lgkmcnt(2)
    v_pk_fma_f32 v[8:9], v[32:33], v[24:25], v[26:27] op_sel_hi:[0,1,1]
    v_pk_mul_f32 v[10:11], v[8:9], v[8:9]
    v_pk_fma_f32 v[10:11], v[10:11], s[48:49], s[48:49] op_sel:[0,0,1] op_sel_hi:[1,0,1]
    v_pk_mul_f32 v[10:11], v[8:9], v[10:11]
    v_exp_f32 v10, v10
    v_exp_f32 v11, v11
    v_pk_mul_f32 v[8:9], v[8:9], v[28:29]
    v_pk_add_f32 v[10:11], v[10:11], 1.0 op_sel_hi:[1,0]
    v_rcp_f32 v10, v10
    v_rcp_f32 v11, v11
    s_nop 0
    v_pk_fma_f32 v[12:13], v[8:9], v[10:11], v[12:13]
    ds_read_b128 v[24:27], v34 offset:21744
    ds_read_b64 v[28:29], v35 offset:23864
    s_waitcnt lgkmcnt(2)
    v_pk_fma_f32 v[8:9], v[32:33], v[16:17], v[18:19] op_sel_hi:[0,1,1]
    v_pk_mul_f32 v[10:11], v[8:9], v[8:9]
    v_pk_fma_f32 v[10:11], v[10:11], s[48:49], s[48:49] op_sel:[0,0,1] op_sel_hi:[1,0,1]
    v_pk_mul_f32 v[10:11], v[8:9], v[10:11]
    v_exp_f32 v10, v10
    v_exp_f32 v11, v11
    v_pk_mul_f32 v[8:9], v[8:9], v[20:21]
    v_pk_add_f32 v[10:11], v[10:11], 1.0 op_sel_hi:[1,0]
    v_rcp_f32 v10, v10
    v_rcp_f32 v11, v11
    s_nop 0
    v_pk_fma_f32 v[12:13], v[8:9], v[10:11], v[12:13]
    s_waitcnt vmcnt(7)
    s_cmp_lg_u32 s0, 0
    s_cbranch_scc1 L_deep_53
    s_waitcnt vmcnt(5)
L_deep_53:
    s_add_u32 s5, s4, 32
    s_and_b32 s5, s5, 63
    s_lshl_b32 s5, s5, 12
    buffer_load_dwordx4 v[128:131], v2, s[12:15], s5 offen nt
    ds_read_b128 v[16:19], v34 offset:21760
    ds_read_b64 v[20:21], v35 offset:23872
    s_waitcnt lgkmcnt(2)
    v_pk_fma_f32 v[8:9], v[32:33], v[24:25], v[26:27] op_sel_hi:[0,1,1]
    v_pk_mul_f32 v[10:11], v[8:9], v[8:9]
    v_pk_fma_f32 v[10:11], v[10:11], s[48:49], s[48:49] op_sel:[0,0,1] op_sel_hi:[1,0,1]
    v_pk_mul_f32 v[10:11], v[8:9], v[10:11]
    v_exp_f32 v10, v10
    v_exp_f32 v11, v11
    v_pk_mul_f32 v[8:9], v[8:9], v[28:29]
    v_pk_add_f32 v[10:11], v[10:11], 1.0 op_sel_hi:[1,0]
    v_rcp_f32 v10, v10
    v_rcp_f32 v11, v11
    s_nop 0
    v_pk_fma_f32 v[12:13], v[8:9], v[10:11], v[12:13]
    ds_read_b128 v[24:27], v34 offset:21776
    ds_read_b64 v[28:29], v35 offset:23880
    s_waitcnt lgkmcnt(2)
    v_pk_fma_f32 v[8:9], v[32:33], v[16:17], v[18:19] op_sel_hi:[0,1,1]
    v_pk_mul_f32 v[10:11], v[8:9], v[8:9]
    v_pk_fma_f32 v[10:11], v[10:11], s[48:49], s[48:49] op_sel:[0,0,1] op_sel_hi:[1,0,1]
    v_pk_mul_f32 v[10:11], v[8:9], v[10:11]
    v_exp_f32 v10, v10
    v_exp_f32 v11, v11
    v_pk_mul_f32 v[8:9], v[8:9], v[20:21]
    v_pk_add_f32 v[10:11], v[10:11], 1.0 op_sel_hi:[1,0]
    v_rcp_f32 v10, v10
    v_rcp_f32 v11, v11
    s_nop 0
    v_pk_fma_f32 v[12:13], v[8:9], v[10:11], v[12:13]
    s_waitcnt vmcnt(7)
    s_cmp_lg_u32 s0, 0
    s_cbranch_scc1 L_deep_54
    s_waitcnt vmcnt(5)
L_deep_54:
    s_add_u32 s5, s4, 33
    s_and_b32 s5, s5, 63
    s_lshl_b32 s5, s5, 12
    buffer_load_dwordx4 v[132:135], v2, s[12:15], s5 offen nt
    ds_read_b128 v[16:19], v34 offset:21792
    ds_read_b64 v[20:21], v35 offset:23888
    s_waitcnt lgkmcnt(2)
    v_pk_fma_f32 v[8:9], v[32:33], v[24:25], v[26:27] op_sel_hi:[0,1,1]
    v_pk_mul_f32 v[10:11], v[8:9], v[8:9]
    v_pk_fma_f32 v[10:11], v[10:11], s[48:49], s[48:49] op_sel:[0,0,1] op_sel_hi:[1,0,1]
    v_pk_mul_f32 v[10:11], v[8:9], v[10:11]
    v_exp_f32 v10, v10
    v_exp_f32 v11, v11
    v_pk_mul_f32 v[8:9], v[8:9], v[28:29]
    v_pk_add_f32 v[10:11], v[10:11], 1.0 op_sel_hi:[1,0]
    v_rcp_f32 v10, v10
    v_rcp_f32 v11, v11
    s_nop 0
    v_pk_fma_f32 v[12:13], v[8:9], v[10:11], v[12:13]
    ds_read_b128 v[24:27], v34 offset:21808
    ds_read_b64 v[28:29], v35 offset:23896
    s_waitcnt lgkmcnt(2)
    v_pk_fma_f32 v[8:9], v[32:33], v[16:17], v[18:19] op_sel_hi:[0,1,1]
    v_pk_mul_f32 v[10:11], v[8:9], v[8:9]
    v_pk_fma_f32 v[10:11], v[10:11], s[48:49], s[48:49] op_sel:[0,0,1] op_sel_hi:[1,0,1]
    v_pk_mul_f32 v[10:11], v[8:9], v[10:11]
    v_exp_f32 v10, v10
    v_exp_f32 v11, v11
    v_pk_mul_f32 v[8:9], v[8:9], v[20:21]
    v_pk_add_f32 v[10:11], v[10:11], 1.0 op_sel_hi:[1,0]
    v_rcp_f32 v10, v10
    v_rcp_f32 v11, v11
    s_nop 0
    v_pk_fma_f32 v[12:13], v[8:9], v[10:11], v[12:13]
    s_waitcnt vmcnt(7)
    s_cmp_lg_u32 s0, 0
    s_cbranch_scc1 L_deep_55
    s_waitcnt vmcnt(5)
L_deep_55:
    s_add_u32 s5, s4, 34
    s_and_b32 s5, s5, 63
    s_lshl_b32 s5, s5, 12
    buffer_load_dwordx4 v[136:139], v2, s[12:15], s5 offen nt
    ds_read_b128 v[16:19], v34 offset:21824
    ds_read_b64 v[20:21], v35 offset:23904
    s_waitcnt lgkmcnt(2)
    v_pk_fma_f32 v[8:9], v[32:33], v[24:25], v[26:27] op_sel_hi:[0,1,1]
    v_pk_mul_f32 v[10:11], v[8:9], v[8:9]
    v_pk_fma_f32 v[10:11], v[10:11], s[48:49], s[48:49] op_sel:[0,0,1] op_sel_hi:[1,0,1]
    v_pk_mul_f32 v[10:11], v[8:9], v[10:11]
    v_exp_f32 v10, v10
    v_exp_f32 v11, v11
    v_pk_mul_f32 v[8:9], v[8:9], v[28:29]
    v_pk_add_f32 v[10:11], v[10:11], 1.0 op_sel_hi:[1,0]
    v_rcp_f32 v10, v10
    v_rcp_f32 v11, v11
    s_nop 0
    v_pk_fma_f32 v[12:13], v[8:9], v[10:11], v[12:13]
    ds_read_b128 v[24:27], v34 offset:21840
    ds_read_b64 v[28:29], v35 offset:23912
    s_waitcnt lgkmcnt(2)
    v_pk_fma_f32 v[8:9], v[32:33], v[16:17], v[18:19] op_sel_hi:[0,1,1]
    v_pk_mul_f32 v[10:11], v[8:9], v[8:9]
    v_pk_fma_f32 v[10:11], v[10:11], s[48:49], s[48:49] op_sel:[0,0,1] op_sel_hi:[1,0,1]
    v_pk_mul_f32 v[10:11], v[8:9], v[10:11]
    v_exp_f32 v10, v10
    v_exp_f32 v11, v11
    v_pk_mul_f32 v[8:9], v[8:9], v[20:21]
    v_pk_add_f32 v[10:11], v[10:11], 1.0 op_sel_hi:[1,0]
    v_rcp_f32 v10, v10
    v_rcp_f32 v11, v11
    s_nop 0
    v_pk_fma_f32 v[12:13], v[8:9], v[10:11], v[12:13]
    s_waitcnt vmcnt(7)
    s_cmp_lg_u32 s0, 0
    s_cbranch_scc1 L_deep_56
    s_waitcnt vmcnt(5)
L_deep_56:
    s_add_u32 s5, s4, 35
    s_and_b32 s5, s5, 63
    s_lshl_b32 s5, s5, 12
    buffer_load_dwordx4 v[140:143], v2, s[12:15], s5 offen nt
    s_waitcnt lgkmcnt(0)
    v_pk_fma_f32 v[8:9], v[32:33], v[24:25], v[26:27] op_sel_hi:[0,1,1]
    v_pk_mul_f32 v[10:11], v[8:9], v[8:9]
    v_pk_fma_f32 v[10:11], v[10:11], s[48:49], s[48:49] op_sel:[0,0,1] op_sel_hi:[1,0,1]
    v_pk_mul_f32 v[10:11], v[8:9], v[10:11]
    v_exp_f32 v10, v10
    v_exp_f32 v11, v11
    v_pk_mul_f32 v[8:9], v[8:9], v[28:29]
    v_pk_add_f32 v[10:11], v[10:11], 1.0 op_sel_hi:[1,0]
    v_rcp_f32 v10, v10
    v_rcp_f32 v11, v11
    s_nop 0
    v_pk_fma_f32 v[12:13], v[8:9], v[10:11], v[12:13]
    v_add_f32 v12, v12, v13
    v_mov_b32 v13, v12
    v_lshlrev_b32 v15, 2, v0
    s_nop 0
    v_permlane32_swap_b32 v12, v13
    v_add_f32 v12, v12, v13
    s_mov_b32 exec_hi, 0
    ds_write_b32 v41, v12 offset:2624
    s_mov_b32 exec_hi, -1
    s_waitcnt vmcnt(7)
    s_cmp_lg_u32 s0, 0
    s_cbranch_scc1 L_deep_57
    s_waitcnt vmcnt(5)
L_deep_57:
    s_add_u32 s5, s4, 36
    s_and_b32 s5, s5, 63
    s_lshl_b32 s5, s5, 12
    buffer_load_dwordx4 v[144:147], v2, s[12:15], s5 offen nt
    s_waitcnt lgkmcnt(0)
    s_barrier
    s_cmp_lg_u32 s3, 0
    s_cbranch_scc1 L_w0_58
    s_mov_b32 exec_hi, 0
    ds_read_b32 v8, v15 offset:2624
    ds_read_b32 v9, v15 offset:2752
    ds_read_b32 v10, v15 offset:2880
    ds_read_b32 v11, v15 offset:3008
    s_lshl_b32 s59, s2, 7
    s_add_u32 s59, s59, 528384
    s_waitcnt lgkmcnt(0)
    v_add_f32 v8, v8, v9
    v_add_f32 v10, v10, v11
    v_add_f32 v8, v8, v10
    v_add_f32 v8, s55, v8
    buffer_store_dword v8, v15, s[16:19], s59 offen sc1
    s_mov_b32 exec_hi, -1
L_w0_58:
    v_and_b32 v14, 31, v0
    v_lshlrev_b32 v14, 3, v14
    s_lshl_b32 s60, s6, 8
    s_add_u32 s60, s60, 577536
    s_xor_b32 s59, s86, 0x9e3779b9
    buffer_load_dwordx2 v[12:13], v14, s[16:19], s60 offen sc1
    s_waitcnt vmcnt(8)
    s_cmp_lg_u32 s0, 0
    s_cbranch_scc1 L_deep_59
    s_waitcnt vmcnt(6)
L_deep_59:
    s_add_u32 s5, s4, 37
    s_and_b32 s5, s5, 63
    s_lshl_b32 s5, s5, 12
    buffer_load_dwordx4 v[148:151], v2, s[12:15], s5 offen nt
    s_waitcnt vmcnt(8)
    s_cmp_lg_u32 s0, 0
    s_cbranch_scc1 L_deep_60
    s_waitcnt vmcnt(6)
L_deep_60:
    s_add_u32 s5, s4, 38
    s_and_b32 s5, s5, 63
    s_lshl_b32 s5, s5, 12
    buffer_load_dwordx4 v[152:155], v2, s[12:15], s5 offen nt
    s_waitcnt vmcnt(8)
    s_cmp_lg_u32 s0, 0
    s_cbranch_scc1 L_deep_61
    s_waitcnt vmcnt(6)
L_deep_61:
    s_add_u32 s5, s4, 39
    s_and_b32 s5, s5, 63
    s_lshl_b32 s5, s5, 12
    buffer_load_dwordx4 v[156:159], v2, s[12:15], s5 offen nt
    s_waitcnt vmcnt(8)
    s_cmp_lg_u32 s0, 0
    s_cbranch_scc1 L_deep_62
    s_waitcnt vmcnt(6)
L_deep_62:
    s_add_u32 s5, s4, 40
    s_and_b32 s5, s5, 63
    s_lshl_b32 s5, s5, 12
    buffer_load_dwordx4 v[160:163], v2, s[12:15], s5 offen nt
    s_waitcnt vmcnt(8)
    s_cmp_lg_u32 s0, 0
    s_cbranch_scc1 L_deep_63
    s_waitcnt vmcnt(6)
L_deep_63:
    s_add_u32 s5, s4, 41
    s_and_b32 s5, s5, 63
    s_lshl_b32 s5, s5, 12
    buffer_load_dwordx4 v[164:167], v2, s[12:15], s5 offen nt
    s_waitcnt vmcnt(5)
    v_cmp_ne_u32 s[84:85], s59, v12
    v_cmp_ne_u32 vcc, s58, v13
    s_nop 0
    s_or_b64 vcc, vcc, s[84:85]
    s_cmp_eq_u64 vcc, 0
    s_cselect_b32 s53, 1, 0
    s_add_u32 s28, s90, 0
    s_and_b32 s28, s28, 0xff
    s_add_u32 s29, s90, 53
    s_and_b32 s29, s29, 0xff
    s_add_u32 s30, s90, 106
    s_and_b32 s30, s30, 0xff
    s_add_u32 s31, s90, 159
    s_and_b32 s31, s31, 0xff
    buffer_load_dwordx4 v[8:11], v44, s[16:19], s27 offen offset:0 sc1
    buffer_load_dwordx4 v[12:15], v44, s[16:19], s27 offen offset:16 sc1
    s_add_u32 s5, s4, 42
    s_and_b32 s5, s5, 63
    s_lshl_b32 s5, s5, 12
    buffer_load_dwordx4 v[168:171], v2, s[12:15], s5 offen nt
    s_add_u32 s5, s4, 43
    s_and_b32 s5, s5, 63
    s_lshl_b32 s5, s5, 12
    buffer_load_dwordx4 v[172:175], v2, s[12:15], s5 offen nt
    s_cmp_lg_u32 s0, 0
    s_cbranch_scc1 L_deep_64
    s_waitcnt vmcnt(7)
L_deep_64:
    s_add_u32 s5, s4, 44
    s_and_b32 s5, s5, 63
    s_lshl_b32 s5, s5, 12
    buffer_load_dwordx4 v[176:179], v2, s[12:15], s5 offen nt
    s_waitcnt vmcnt(9)
    s_cmp_lg_u32 s0, 0
    s_cbranch_scc1 L_deep_65
    s_waitcnt vmcnt(7)
L_deep_65:
    s_add_u32 s5, s4, 45
    s_and_b32 s5, s5, 63
    s_lshl_b32 s5, s5, 12
    buffer_load_dwordx4 v[180:183], v2, s[12:15], s5 offen nt
    s_waitcnt vmcnt(9)
    s_cmp_lg_u32 s0, 0
    s_cbranch_scc1 L_deep_66
    s_waitcnt vmcnt(7)
L_deep_66:
    s_add_u32 s5, s4, 46
    s_and_b32 s5, s5, 63
    s_lshl_b32 s5, s5, 12
    buffer_load_dwordx4 v[184:187], v2, s[12:15], s5 offen nt
    s_waitcnt vmcnt(6)
    v_xor_b32 v8, s28, v8
    v_xor_b32 v9, s29, v9
    v_xor_b32 v10, s30, v10
    v_xor_b32 v11, s31, v11
    v_or3_b32 v25, v8, v9, v10
    v_or_b32 v25, v25, v11
    s_waitcnt vmcnt(5)
    v_xor_b32 v12, s28, v12
    v_xor_b32 v13, s29, v13
    v_xor_b32 v14, s30, v14
    v_xor_b32 v15, s31, v15
    v_or3_b32 v25, v25, v12, v13
    v_or3_b32 v25, v25, v14, v15
    v_and_b32 v25, 0xff, v25
    v_cmp_ne_u32 vcc, 0, v25
    s_cbranch_vccnz L_retry_67
L_ok_70:
    v_add_f32_dpp v8, v8, v8 row_ror:4 row_mask:0xf bank_mask:0xf
    v_add_f32_dpp v9, v9, v9 row_ror:4 row_mask:0xf bank_mask:0xf
    v_add_f32_dpp v10, v10, v10 row_ror:4 row_mask:0xf bank_mask:0xf
    v_add_f32_dpp v11, v11, v11 row_ror:4 row_mask:0xf bank_mask:0xf
    v_add_f32_dpp v12, v12, v12 row_ror:4 row_mask:0xf bank_mask:0xf
    v_add_f32_dpp v13, v13, v13 row_ror:4 row_mask:0xf bank_mask:0xf
    v_add_f32_dpp v14, v14, v14 row_ror:4 row_mask:0xf bank_mask:0xf
    v_add_f32_dpp v15, v15, v15 row_ror:4 row_mask:0xf bank_mask:0xf
    v_add_f32_dpp v8, v8, v8 row_ror:8 row_mask:0xf bank_mask:0xf
    v_add_f32_dpp v9, v9, v9 row_ror:8 row_mask:0xf bank_mask:0xf
    v_add_f32_dpp v10, v10, v10 row_ror:8 row_mask:0xf bank_mask:0xf
    v_add_f32_dpp v11, v11, v11 row_ror:8 row_mask:0xf bank_mask:0xf
    v_add_f32_dpp v12, v12, v12 row_ror:8 row_mask:0xf bank_mask:0xf
    v_add_f32_dpp v13, v13, v13 row_ror:8 row_mask:0xf bank_mask:0xf
    v_add_f32_dpp v14, v14, v14 row_ror:8 row_mask:0xf bank_mask:0xf
    v_add_f32_dpp v15, v15, v15 row_ror:8 row_mask:0xf bank_mask:0xf
    v_cvt_pk_bf16_f32 v36, v8, v9
    v_cvt_pk_bf16_f32 v37, v10, v11
    v_cvt_pk_bf16_f32 v38, v12, v13
    v_cvt_pk_bf16_f32 v39, v14, v15
    s_add_u32 s5, s4, 47
    s_and_b32 s5, s5, 63
    s_lshl_b32 s5, s5, 12
    buffer_load_dwordx4 v[188:191], v2, s[12:15], s5 offen nt
    s_add_u32 s5, s4, 48
    s_and_b32 s5, s5, 63
    s_lshl_b32 s5, s5, 12
    buffer_load_dwordx4 v[192:195], v2, s[12:15], s5 offen nt
    v_cndmask_b32_e64 v8, 0, v36, s[76:77]
    v_cndmask_b32_e64 v9, 0, v37, s[76:77]
    v_cndmask_b32_e64 v10, 0, v38, s[76:77]
    v_cndmask_b32_e64 v11, 0, v39, s[76:77]
    v_cndmask_b32_e64 v12, 0, v36, s[78:79]
    v_cndmask_b32_e64 v13, 0, v37, s[78:79]
    v_cndmask_b32_e64 v14, 0, v38, s[78:79]
    v_cndmask_b32_e64 v15, 0, v39, s[78:79]
    v_mfma_f32_16x16x32_bf16 v[24:27], a[0:3], v[8:11], 0
    v_cndmask_b32_e64 v16, 0, v36, s[80:81]
    v_cndmask_b32_e64 v17, 0, v37, s[80:81]
    v_cndmask_b32_e64 v18, 0, v38, s[80:81]
    v_cndmask_b32_e64 v19, 0, v39, s[80:81]
    v_mfma_f32_16x16x32_bf16 v[24:27], a[4:7], v[12:15], v[24:27]
    v_cndmask_b32_e64 v20, 0, v36, s[82:83]
    v_cndmask_b32_e64 v21, 0, v37, s[82:83]
    v_cndmask_b32_e64 v22, 0, v38, s[82:83]
    v_cndmask_b32_e64 v23, 0, v39, s[82:83]
    v_mfma_f32_16x16x32_bf16 v[24:27], a[8:11], v[16:19], v[24:27]
    s_nop 0
    v_mfma_f32_16x16x32_bf16 v[24:27], a[12:15], v[20:23], v[24:27]
    s_cmp_lg_u32 s0, 0
    s_cbranch_scc1 L_deep_71
    s_waitcnt vmcnt(5)
L_deep_71:
    s_add_u32 s5, s4, 49
    s_and_b32 s5, s5, 63
    s_lshl_b32 s5, s5, 12
    buffer_load_dwordx4 v[196:199], v2, s[12:15], s5 offen nt
    v_mfma_f32_16x16x32_bf16 v[28:31], a[16:19], v[8:11], 0
    v_mfma_f32_16x16x32_bf16 v[28:31], a[20:23], v[12:15], v[28:31]
    v_mfma_f32_16x16x32_bf16 v[28:31], a[24:27], v[16:19], v[28:31]
    v_mfma_f32_16x16x32_bf16 v[28:31], a[28:31], v[20:23], v[28:31]
    v_mfma_f32_16x16x32_bf16 v[32:35], a[32:35], v[8:11], 0
    v_mov_b32_dpp v24, v24 quad_perm:[0,0,0,0] row_mask:0xf bank_mask:0xf
    v_mov_b32_dpp v26, v26 quad_perm:[2,2,2,2] row_mask:0xf bank_mask:0xf
    v_mfma_f32_16x16x32_bf16 v[32:35], a[36:39], v[12:15], v[32:35]
    v_add_f32_dpp v24, v25, v24 quad_perm:[1,1,1,1] row_mask:0xf bank_mask:0xf
    v_add_f32_dpp v26, v27, v26 quad_perm:[3,3,3,3] row_mask:0xf bank_mask:0xf
    v_mfma_f32_16x16x32_bf16 v[32:35], a[40:43], v[16:19], v[32:35]
    v_add_f32 v24, v24, v26
    v_mfma_f32_16x16x32_bf16 v[32:35], a[44:47], v[20:23], v[32:35]
    v_cndmask_b32_e64 v36, v36, v24, s[68:69]
    s_waitcnt vmcnt(7)
    s_cmp_lg_u32 s0, 0
    s_cbranch_scc1 L_deep_72
    s_waitcnt vmcnt(5)
L_deep_72:
    s_add_u32 s5, s4, 50
    s_and_b32 s5, s5, 63
    s_lshl_b32 s5, s5, 12
    buffer_load_dwordx4 v[200:203], v2, s[12:15], s5 offen nt
    v_mfma_f32_16x16x32_bf16 v[24:27], a[48:51], v[8:11], 0
    v_mov_b32_dpp v28, v28 quad_perm:[0,0,0,0] row_mask:0xf bank_mask:0xf
    v_mov_b32_dpp v30, v30 quad_perm:[2,2,2,2] row_mask:0xf bank_mask:0xf
    v_mfma_f32_16x16x32_bf16 v[24:27], a[52:55], v[12:15], v[24:27]
    v_add_f32_dpp v28, v29, v28 quad_perm:[1,1,1,1] row_mask:0xf bank_mask:0xf
    v_add_f32_dpp v30, v31, v30 quad_perm:[3,3,3,3] row_mask:0xf bank_mask:0xf
    v_mfma_f32_16x16x32_bf16 v[24:27], a[56:59], v[16:19], v[24:27]
    v_add_f32 v28, v28, v30
    v_mfma_f32_16x16x32_bf16 v[24:27], a[60:63], v[20:23], v[24:27]
    v_cndmask_b32_e64 v36, v36, v28, s[70:71]
    v_mfma_f32_16x16x32_bf16 v[28:31], a[64:67], v[8:11], 0
    v_mov_b32_dpp v32, v32 quad_perm:[0,0,0,0] row_mask:0xf bank_mask:0xf
    v_mov_b32_dpp v34, v34 quad_perm:[2,2,2,2] row_mask:0xf bank_mask:0xf
    v_mfma_f32_16x16x32_bf16 v[28:31], a[68:71], v[12:15], v[28:31]
    v_add_f32_dpp v32, v33, v32 quad_perm:[1,1,1,1] row_mask:0xf bank_mask:0xf
    v_add_f32_dpp v34, v35, v34 quad_perm:[3,3,3,3] row_mask:0xf bank_mask:0xf
    v_mfma_f32_16x16x32_bf16 v[28:31], a[72:75], v[16:19], v[28:31]
    v_add_f32 v32, v32, v34
    v_mfma_f32_16x16x32_bf16 v[28:31], a[76:79], v[20:23], v[28:31]
    v_cndmask_b32_e64 v36, v36, v32, s[72:73]
    s_waitcnt vmcnt(7)
    s_cmp_lg_u32 s0, 0
    s_cbranch_scc1 L_deep_73
    s_waitcnt vmcnt(5)
L_deep_73:
    s_add_u32 s5, s4, 51
    s_and_b32 s5, s5, 63
    s_lshl_b32 s5, s5, 12
    buffer_load_dwordx4 v[204:207], v2, s[12:15], s5 offen nt
    v_mfma_f32_16x16x32_bf16 v[32:35], a[80:83], v[8:11], 0
    v_mov_b32_dpp v24, v24 quad_perm:[0,0,0,0] row_mask:0xf bank_mask:0xf
    v_mov_b32_dpp v26, v26 quad_perm:[2,2,2,2] row_mask:0xf bank_mask:0xf
    v_mfma_f32_16x16x32_bf16 v[32:35], a[84:87], v[12:15], v[32:35]
    v_add_f32_dpp v24, v25, v24 quad_perm:[1,1,1,1] row_mask:0xf bank_mask:0xf
    v_add_f32_dpp v26, v27, v26 quad_perm:[3,3,3,3] row_mask:0xf bank_mask:0xf
    v_mfma_f32_16x16x32_bf16 v[32:35], a[88:91], v[16:19], v[32:35]
    v_add_f32 v24, v24, v26
    v_mfma_f32_16x16x32_bf16 v[32:35], a[92:95], v[20:23], v[32:35]
    v_cndmask_b32_e64 v36, v36, v24, s[74:75]
    v_mfma_f32_16x16x32_bf16 v[24:27], a[96:99], v[8:11], 0
    v_mov_b32_dpp v28, v28 quad_perm:[0,0,0,0] row_mask:0xf bank_mask:0xf
    v_mov_b32_dpp v30, v30 quad_perm:[2,2,2,2] row_mask:0xf bank_mask:0xf
    v_mfma_f32_16x16x32_bf16 v[24:27], a[100:103], v[12:15], v[24:27]
    v_add_f32_dpp v28, v29, v28 quad_perm:[1,1,1,1] row_mask:0xf bank_mask:0xf
    v_add_f32_dpp v30, v31, v30 quad_perm:[3,3,3,3] row_mask:0xf bank_mask:0xf
    v_mfma_f32_16x16x32_bf16 v[24:27], a[104:107], v[16:19], v[24:27]
    v_add_f32 v28, v28, v30
    v_mfma_f32_16x16x32_bf16 v[24:27], a[108:111], v[20:23], v[24:27]
    v_cndmask_b32_e64 v37, v37, v28, s[68:69]
    s_waitcnt vmcnt(7)
    s_cmp_lg_u32 s0, 0
    s_cbranch_scc1 L_deep_74
    s_waitcnt vmcnt(5)
L_deep_74:
    s_add_u32 s5, s4, 52
    s_and_b32 s5, s5, 63
    s_lshl_b32 s5, s5, 12
    buffer_load_dwordx4 v[208:211], v2, s[12:15], s5 offen nt
    v_mfma_f32_16x16x32_bf16 v[28:31], a[112:115], v[8:11], 0
    v_mov_b32_dpp v32, v32 quad_perm:[0,0,0,0] row_mask:0xf bank_mask:0xf
    v_mov_b32_dpp v34, v34 quad_perm:[2,2,2,2] row_mask:0xf bank_mask:0xf
    v_mfma_f32_16x16x32_bf16 v[28:31], a[116:119], v[12:15], v[28:31]
    v_add_f32_dpp v32, v33, v32 quad_perm:[1,1,1,1] row_mask:0xf bank_mask:0xf
    v_add_f32_dpp v34, v35, v34 quad_perm:[3,3,3,3] row_mask:0xf bank_mask:0xf
    v_mfma_f32_16x16x32_bf16 v[28:31], a[120:123], v[16:19], v[28:31]
    v_add_f32 v32, v32, v34
    v_mfma_f32_16x16x32_bf16 v[28:31], a[124:127], v[20:23], v[28:31]
    v_cndmask_b32_e64 v37, v37, v32, s[70:71]
    v_mfma_f32_16x16x32_bf16 v[32:35], a[128:131], v[8:11], 0
    v_mov_b32_dpp v24, v24 quad_perm:[0,0,0,0] row_mask:0xf bank_mask:0xf
    v_mov_b32_dpp v26, v26 quad_perm:[2,2,2,2] row_mask:0xf bank_mask:0xf
    v_mfma_f32_16x16x32_bf16 v[32:35], a[132:135], v[12:15], v[32:35]
    v_add_f32_dpp v24, v25, v24 quad_perm:[1,1,1,1] row_mask:0xf bank_mask:0xf
    v_add_f32_dpp v26, v27, v26 quad_perm:[3,3,3,3] row_mask:0xf bank_mask:0xf
    v_mfma_f32_16x16x32_bf16 v[32:35], a[136:139], v[16:19], v[32:35]
    v_add_f32 v24, v24, v26
    v_mfma_f32_16x16x32_bf16 v[32:35], a[140:143], v[20:23], v[32:35]
    v_cndmask_b32_e64 v37, v37, v24, s[72:73]
    s_waitcnt vmcnt(7)
    s_cmp_lg_u32 s0, 0
    s_cbranch_scc1 L_deep_75
    s_waitcnt vmcnt(5)
L_deep_75:
    s_add_u32 s5, s4, 53
    s_and_b32 s5, s5, 63
    s_lshl_b32 s5, s5, 12
    buffer_load_dwordx4 v[212:215], v2, s[12:15], s5 offen nt
    v_mfma_f32_16x16x32_bf16 v[24:27], a[144:147], v[8:11], 0
    v_mov_b32_dpp v28, v28 quad_perm:[0,0,0,0] row_mask:0xf bank_mask:0xf
    v_mov_b32_dpp v30, v30 quad_perm:[2,2,2,2] row_mask:0xf bank_mask:0xf
    v_mfma_f32_16x16x32_bf16 v[24:27], a[148:151], v[12:15], v[24:27]
    v_add_f32_dpp v28, v29, v28 quad_perm:[1,1,1,1] row_mask:0xf bank_mask:0xf
    v_add_f32_dpp v30, v31, v30 quad_perm:[3,3,3,3] row_mask:0xf bank_mask:0xf
    v_mfma_f32_16x16x32_bf16 v[24:27], a[152:155], v[16:19], v[24:27]
    v_add_f32 v28, v28, v30
    v_mfma_f32_16x16x32_bf16 v[24:27], a[156:159], v[20:23], v[24:27]
    v_cndmask_b32_e64 v37, v37, v28, s[74:75]
    v_mfma_f32_16x16x32_bf16 v[28:31], a[160:163], v[8:11], 0
    v_mov_b32_dpp v32, v32 quad_perm:[0,0,0,0] row_mask:0xf bank_mask:0xf
    v_mov_b32_dpp v34, v34 quad_perm:[2,2,2,2] row_mask:0xf bank_mask:0xf
    v_mfma_f32_16x16x32_bf16 v[28:31], a[164:167], v[12:15], v[28:31]
    v_add_f32_dpp v32, v33, v32 quad_perm:[1,1,1,1] row_mask:0xf bank_mask:0xf
    v_add_f32_dpp v34, v35, v34 quad_perm:[3,3,3,3] row_mask:0xf bank_mask:0xf
    v_mfma_f32_16x16x32_bf16 v[28:31], a[168:171], v[16:19], v[28:31]
    v_add_f32 v32, v32, v34
    v_mfma_f32_16x16x32_bf16 v[28:31], a[172:175], v[20:23], v[28:31]
    v_cndmask_b32_e64 v38, v38, v32, s[68:69]
    s_waitcnt vmcnt(7)
    s_cmp_lg_u32 s0, 0
    s_cbranch_scc1 L_deep_76
    s_waitcnt vmcnt(5)
L_deep_76:
    s_add_u32 s5, s4, 54
    s_and_b32 s5, s5, 63
    s_lshl_b32 s5, s5, 12
    buffer_load_dwordx4 v[216:219], v2, s[12:15], s5 offen nt
    v_mfma_f32_16x16x32_bf16 v[32:35], a[176:179], v[8:11], 0
    v_mov_b32_dpp v24, v24 quad_perm:[0,0,0,0] row_mask:0xf bank_mask:0xf
    v_mov_b32_dpp v26, v26 quad_perm:[2,2,2,2] row_mask:0xf bank_mask:0xf
    v_mfma_f32_16x16x32_bf16 v[32:35], a[180:183], v[12:15], v[32:35]
    v_add_f32_dpp v24, v25, v24 quad_perm:[1,1,1,1] row_mask:0xf bank_mask:0xf
    v_add_f32_dpp v26, v27, v26 quad_perm:[3,3,3,3] row_mask:0xf bank_mask:0xf
    v_mfma_f32_16x16x32_bf16 v[32:35], a[184:187], v[16:19], v[32:35]
    v_add_f32 v24, v24, v26
    v_mfma_f32_16x16x32_bf16 v[32:35], a[188:191], v[20:23], v[32:35]
    v_cndmask_b32_e64 v38, v38, v24, s[70:71]
    v_mfma_f32_16x16x32_bf16 v[24:27], a[192:195], v[8:11], 0
    v_mov_b32_dpp v28, v28 quad_perm:[0,0,0,0] row_mask:0xf bank_mask:0xf
    v_mov_b32_dpp v30, v30 quad_perm:[2,2,2,2] row_mask:0xf bank_mask:0xf
    v_mfma_f32_16x16x32_bf16 v[24:27], a[196:199], v[12:15], v[24:27]
    v_add_f32_dpp v28, v29, v28 quad_perm:[1,1,1,1] row_mask:0xf bank_mask:0xf
    v_add_f32_dpp v30, v31, v30 quad_perm:[3,3,3,3] row_mask:0xf bank_mask:0xf
    v_mfma_f32_16x16x32_bf16 v[24:27], a[200:203], v[16:19], v[24:27]
    v_add_f32 v28, v28, v30
    v_mfma_f32_16x16x32_bf16 v[24:27], a[204:207], v[20:23], v[24:27]
    v_cndmask_b32_e64 v38, v38, v28, s[72:73]
    s_waitcnt vmcnt(7)
    s_cmp_lg_u32 s0, 0
    s_cbranch_scc1 L_deep_77
    s_waitcnt vmcnt(5)
L_deep_77:
    s_add_u32 s5, s4, 55
    s_and_b32 s5, s5, 63
    s_lshl_b32 s5, s5, 12
    buffer_load_dwordx4 v[220:223], v2, s[12:15], s5 offen nt
    v_mfma_f32_16x16x32_bf16 v[28:31], a[208:211], v[8:11], 0
    v_mov_b32_dpp v32, v32 quad_perm:[0,0,0,0] row_mask:0xf bank_mask:0xf
    v_mov_b32_dpp v34, v34 quad_perm:[2,2,2,2] row_mask:0xf bank_mask:0xf
    v_mfma_f32_16x16x32_bf16 v[28:31], a[212:215], v[12:15], v[28:31]
    v_add_f32_dpp v32, v33, v32 quad_perm:[1,1,1,1] row_mask:0xf bank_mask:0xf
    v_add_f32_dpp v34, v35, v34 quad_perm:[3,3,3,3] row_mask:0xf bank_mask:0xf
    v_mfma_f32_16x16x32_bf16 v[28:31], a[216:219], v[16:19], v[28:31]
    v_add_f32 v32, v32, v34
    v_mfma_f32_16x16x32_bf16 v[28:31], a[220:223], v[20:23], v[28:31]
    v_cndmask_b32_e64 v38, v38, v32, s[74:75]
    v_mfma_f32_16x16x32_bf16 v[32:35], a[224:227], v[8:11], 0
    v_mov_b32_dpp v24, v24 quad_perm:[0,0,0,0] row_mask:0xf bank_mask:0xf
    v_mov_b32_dpp v26, v26 quad_perm:[2,2,2,2] row_mask:0xf bank_mask:0xf
    v_mfma_f32_16x16x32_bf16 v[32:35], a[228:231], v[12:15], v[32:35]
    v_add_f32_dpp v24, v25, v24 quad_perm:[1,1,1,1] row_mask:0xf bank_mask:0xf
    v_add_f32_dpp v26, v27, v26 quad_perm:[3,3,3,3] row_mask:0xf bank_mask:0xf
    v_mfma_f32_16x16x32_bf16 v[32:35], a[232:235], v[16:19], v[32:35]
    v_add_f32 v24, v24, v26
    v_mfma_f32_16x16x32_bf16 v[32:35], a[236:239], v[20:23], v[32:35]
    v_cndmask_b32_e64 v39, v39, v24, s[68:69]
    s_waitcnt vmcnt(7)
    s_cmp_lg_u32 s0, 0
    s_cbranch_scc1 L_deep_78
    s_waitcnt vmcnt(5)
L_deep_78:
    s_add_u32 s5, s4, 56
    s_and_b32 s5, s5, 63
    s_lshl_b32 s5, s5, 12
    buffer_load_dwordx4 v[224:227], v2, s[12:15], s5 offen nt
    v_mfma_f32_16x16x32_bf16 v[24:27], a[240:243], v[8:11], 0
    v_mov_b32_dpp v28, v28 quad_perm:[0,0,0,0] row_mask:0xf bank_mask:0xf
    v_mov_b32_dpp v30, v30 quad_perm:[2,2,2,2] row_mask:0xf bank_mask:0xf
    v_mfma_f32_16x16x32_bf16 v[24:27], a[244:247], v[12:15], v[24:27]
    v_add_f32_dpp v28, v29, v28 quad_perm:[1,1,1,1] row_mask:0xf bank_mask:0xf
    v_add_f32_dpp v30, v31, v30 quad_perm:[3,3,3,3] row_mask:0xf bank_mask:0xf
    v_mfma_f32_16x16x32_bf16 v[24:27], a[248:251], v[16:19], v[24:27]
    v_add_f32 v28, v28, v30
    v_mfma_f32_16x16x32_bf16 v[24:27], a[252:255], v[20:23], v[24:27]
    v_cndmask_b32_e64 v39, v39, v28, s[70:71]
    v_mov_b32_dpp v32, v32 quad_perm:[0,0,0,0] row_mask:0xf bank_mask:0xf
    v_mov_b32_dpp v34, v34 quad_perm:[2,2,2,2] row_mask:0xf bank_mask:0xf
    s_nop 0
    v_add_f32_dpp v32, v33, v32 quad_perm:[1,1,1,1] row_mask:0xf bank_mask:0xf
    v_add_f32_dpp v34, v35, v34 quad_perm:[3,3,3,3] row_mask:0xf bank_mask:0xf
    v_add_f32 v32, v32, v34
    v_cndmask_b32_e64 v39, v39, v32, s[72:73]
    v_mov_b32_dpp v24, v24 quad_perm:[0,0,0,0] row_mask:0xf bank_mask:0xf
    v_mov_b32_dpp v26, v26 quad_perm:[2,2,2,2] row_mask:0xf bank_mask:0xf
    s_nop 0
    v_add_f32_dpp v24, v25, v24 quad_perm:[1,1,1,1] row_mask:0xf bank_mask:0xf
    v_add_f32_dpp v26, v27, v26 quad_perm:[3,3,3,3] row_mask:0xf bank_mask:0xf
    v_add_f32 v24, v24, v26
    v_cndmask_b32_e64 v39, v39, v24, s[74:75]
    s_lshl_b32 s5, s7, 2
    s_add_u32 s5, s5, s3
    s_lshl_b32 s5, s5, 8
    s_add_u32 s5, s5, 528384
    s_mov_b32 m0, 3648
    v_lshlrev_b32 v7, 2, v0
    buffer_load_dword v7, s[16:19], s5 offen sc1 lds
    s_add_u32 s5, s4, 57
    s_and_b32 s5, s5, 63
    s_lshl_b32 s5, s5, 12
    buffer_load_dwordx4 v[228:231], v2, s[12:15], s5 offen nt
    s_add_u32 s5, s4, 58
    s_and_b32 s5, s5, 63
    s_lshl_b32 s5, s5, 12
    buffer_load_dwordx4 v[232:235], v2, s[12:15], s5 offen nt
    v_max3_f32 v16, v36, v37, v38
    v_max_f32 v16, v16, v39
    v_mov_b32 v24, 0
    v_mov_b32 v25, 0
    v_max_f32_dpp v16, v16, v16 quad_perm:[1,0,3,2] row_mask:0xf bank_mask:0xf
    v_mov_b32 v26, 0
    v_mov_b32 v27, 0
    v_max_f32_dpp v16, v16, v16 quad_perm:[2,3,0,1] row_mask:0xf bank_mask:0xf
    v_mov_b32 v28, 0
    v_mov_b32 v29, 0
    v_max_f32_dpp v16, v16, v16 row_half_mirror row_mask:0xf bank_mask:0xf
    v_mov_b32 v30, 0
    v_mov_b32 v31, 0
    v_max_f32_dpp v16, v16, v16 row_mirror row_mask:0xf bank_mask:0xf
    v_mov_b32 v17, 0x3e0293ee
    s_nop 0
    v_max_f32_dpp v16, v16, v16 row_bcast:15 row_mask:0xa bank_mask:0xf
    s_nop 1
    v_max_f32_dpp v16, v16, v16 row_bcast:31 row_mask:0xc bank_mask:0xf
    v_mul_f32 v16, 0x3e0293ee, v16
    s_nop 0
    v_readlane_b32 s61, v16, 63
    s_nop 1
    v_fma_f32 v36, v36, v17, -s61
    v_fma_f32 v37, v37, v17, -s61
    v_fma_f32 v38, v38, v17, -s61
    v_fma_f32 v39, v39, v17, -s61
    v_exp_f32 v36, v36
    v_exp_f32 v37, v37
    v_exp_f32 v38, v38
    v_exp_f32 v39, v39
    v_cvt_pk_bf16_f32 v8, v36, v36
    v_cvt_pk_bf16_f32 v9, v36, v36
    v_cvt_pk_bf16_f32 v10, v37, v37
    v_cvt_pk_bf16_f32 v11, v37, v37
    v_cvt_pk_bf16_f32 v12, v38, v38
    v_cvt_pk_bf16_f32 v13, v38, v38
    v_cvt_pk_bf16_f32 v14, v39, v39
    v_cvt_pk_bf16_f32 v15, v39, v39
    v_mov_b32_dpp v8, v8 row_shr:4 row_mask:0xf bank_mask:0xa
    v_mov_b32_dpp v9, v9 row_shl:4 row_mask:0xf bank_mask:0x5
    v_mov_b32_dpp v10, v10 row_shr:4 row_mask:0xf bank_mask:0xa
    v_mov_b32_dpp v11, v11 row_shl:4 row_mask:0xf bank_mask:0x5
    v_mov_b32_dpp v12, v12 row_shr:4 row_mask:0xf bank_mask:0xa
    v_mov_b32_dpp v13, v13 row_shl:4 row_mask:0xf bank_mask:0x5
    v_mov_b32_dpp v14, v14 row_shr:4 row_mask:0xf bank_mask:0xa
    v_mov_b32_dpp v15, v15 row_shl:4 row_mask:0xf bank_mask:0x5
    v_add_f32 v7, v36, v37
    v_add_f32 v38, v38, v39
    v_permlane32_swap_b32 v8, v9
    v_permlane32_swap_b32 v10, v11
    v_permlane32_swap_b32 v12, v13
    v_permlane32_swap_b32 v14, v15
    v_add_f32 v7, v7, v38
    ds_read_b128 v[32:35], v3 offset:0
    ds_read_b128 v[36:39], v3 offset:1024
    v_and_b32_dpp v16, v8, v4 quad_perm:[0,0,0,0] row_mask:0xf bank_mask:0xf
    v_and_b32_dpp v17, v8, v5 quad_perm:[0,0,0,0] row_mask:0xf bank_mask:0xf
    v_and_b32_dpp v18, v9, v4 quad_perm:[0,0,0,0] row_mask:0xf bank_mask:0xf
    v_and_b32_dpp v19, v9, v5 quad_perm:[0,0,0,0] row_mask:0xf bank_mask:0xf
    v_and_b32_dpp v20, v8, v4 quad_perm:[1,1,1,1] row_mask:0xf bank_mask:0xf
    v_and_b32_dpp v21, v8, v5 quad_perm:[1,1,1,1] row_mask:0xf bank_mask:0xf
    s_waitcnt lgkmcnt(0)
    v_smfmac_f32_16x16x64_bf16 v[24:27], v[16:19], v[32:39], v6
    ds_read_b128 v[32:35], v3 offset:2048
    ds_read_b128 v[36:39], v3 offset:3072
    v_and_b32_dpp v22, v9, v4 quad_perm:[1,1,1,1] row_mask:0xf bank_mask:0xf
    v_and_b32_dpp v23, v9, v5 quad_perm:[1,1,1,1] row_mask:0xf bank_mask:0xf
    s_waitcnt lgkmcnt(0)
    v_smfmac_f32_16x16x64_bf16 v[28:31], v[16:19], v[32:39], v6
    ds_read_b128 v[32:35], v3 offset:4096
    ds_read_b128 v[36:39], v3 offset:5120
    v_add_f32_dpp v7, v7, v7 quad_perm:[1,0,3,2] row_mask:0xf bank_mask:0xf
    s_waitcnt vmcnt(8)
    s_cmp_lg_u32 s0, 0
    s_cbranch_scc1 L_deep_79
    s_waitcnt vmcnt(6)
L_deep_79:
    s_add_u32 s5, s4, 59
    s_and_b32 s5, s5, 63
    s_lshl_b32 s5, s5, 12
    buffer_load_dwordx4 v[236:239], v2, s[12:15], s5 offen nt
    v_and_b32_dpp v16, v8, v4 quad_perm:[2,2,2,2] row_mask:0xf bank_mask:0xf
    v_and_b32_dpp v17, v8, v5 quad_perm:[2,2,2,2] row_mask:0xf bank_mask:0xf
    s_waitcnt lgkmcnt(0)
    v_smfmac_f32_16x16x64_bf16 v[24:27], v[20:23], v[32:39], v6
    ds_read_b128 v[32:35], v3 offset:6144
    ds_read_b128 v[36:39], v3 offset:7168
    v_and_b32_dpp v18, v9, v4 quad_perm:[2,2,2,2] row_mask:0xf bank_mask:0xf
    v_and_b32_dpp v19, v9, v5 quad_perm:[2,2,2,2] row_mask:0xf bank_mask:0xf
    s_waitcnt lgkmcnt(0)
    v_smfmac_f32_16x16x64_bf16 v[28:31], v[20:23], v[32:39], v6
    ds_read_b128 v[32:35], v3 offset:8192
    ds_read_b128 v[36:39], v3 offset:9216
    v_add_f32_dpp v7, v7, v7 quad_perm:[2,3,0,1] row_mask:0xf bank_mask:0xf
    v_and_b32_dpp v20, v8, v4 quad_perm:[3,3,3,3] row_mask:0xf bank_mask:0xf
    v_and_b32_dpp v21, v8, v5 quad_perm:[3,3,3,3] row_mask:0xf bank_mask:0xf
    s_waitcnt lgkmcnt(0)
    v_smfmac_f32_16x16x64_bf16 v[24:27], v[16:19], v[32:39], v6
    ds_read_b128 v[32:35], v3 offset:10240
    ds_read_b128 v[36:39], v3 offset:11264
    v_and_b32_dpp v22, v9, v4 quad_perm:[3,3,3,3] row_mask:0xf bank_mask:0xf
    v_and_b32_dpp v23, v9, v5 quad_perm:[3,3,3,3] row_mask:0xf bank_mask:0xf
    s_waitcnt lgkmcnt(0)
    v_smfmac_f32_16x16x64_bf16 v[28:31], v[16:19], v[32:39], v6
    ds_read_b128 v[32:35], v3 offset:12288
    ds_read_b128 v[36:39], v3 offset:13312
    v_add_f32_dpp v7, v7, v7 row_half_mirror row_mask:0xf bank_mask:0xf
    s_waitcnt vmcnt(6)
    s_add_u32 s5, s4, 60
    s_and_b32 s5, s5, 63
    s_lshl_b32 s5, s5, 12
    buffer_load_dwordx4 v[240:243], v2, s[12:15], s5 offen nt
    v_and_b32_dpp v16, v10, v4 quad_perm:[0,0,0,0] row_mask:0xf bank_mask:0xf
    v_and_b32_dpp v17, v10, v5 quad_perm:[0,0,0,0] row_mask:0xf bank_mask:0xf
    s_waitcnt lgkmcnt(0)
    v_smfmac_f32_16x16x64_bf16 v[24:27], v[20:23], v[32:39], v6
    ds_read_b128 v[32:35], v3 offset:14336
    ds_read_b128 v[36:39], v3 offset:15360
    v_and_b32_dpp v18, v11, v4 quad_perm:[0,0,0,0] row_mask:0xf bank_mask:0xf
    v_and_b32_dpp v19, v11, v5 quad_perm:[0,0,0,0] row_mask:0xf bank_mask:0xf
    s_waitcnt lgkmcnt(0)
    v_smfmac_f32_16x16x64_bf16 v[28:31], v[20:23], v[32:39], v6
    ds_read_b128 v[32:35], v3 offset:16384
    ds_read_b128 v[36:39], v3 offset:17408
    v_add_f32_dpp v7, v7, v7 row_mirror row_mask:0xf bank_mask:0xf
    v_and_b32_dpp v20, v10, v4 quad_perm:[1,1,1,1] row_mask:0xf bank_mask:0xf
    v_and_b32_dpp v21, v10, v5 quad_perm:[1,1,1,1] row_mask:0xf bank_mask:0xf
    s_waitcnt lgkmcnt(0)
    v_smfmac_f32_16x16x64_bf16 v[24:27], v[16:19], v[32:39], v6
    ds_read_b128 v[32:35], v3 offset:18432
    ds_read_b128 v[36:39], v3 offset:19456
    v_and_b32_dpp v22, v11, v4 quad_perm:[1,1,1,1] row_mask:0xf bank_mask:0xf
    v_and_b32_dpp v23, v11, v5 quad_perm:[1,1,1,1] row_mask:0xf bank_mask:0xf
    s_waitcnt lgkmcnt(0)
    v_smfmac_f32_16x16x64_bf16 v[28:31], v[16:19], v[32:39], v6
    v_add_f32_dpp v7, v7, v7 row_bcast:15 row_mask:0xa bank_mask:0xf
    s_waitcnt vmcnt(6)
    s_add_u32 s5, s4, 61
    s_and_b32 s5, s5, 63
    s_lshl_b32 s5, s5, 12
    buffer_load_dwordx4 v[244:247], v2, s[12:15], s5 offen nt
    v_and_b32_dpp v16, v10, v4 quad_perm:[2,2,2,2] row_mask:0xf bank_mask:0xf
    v_and_b32_dpp v17, v10, v5 quad_perm:[2,2,2,2] row_mask:0xf bank_mask:0xf
    v_smfmac_f32_16x16x64_bf16 v[24:27], v[20:23], v[80:87], v6
    v_and_b32_dpp v18, v11, v4 quad_perm:[2,2,2,2] row_mask:0xf bank_mask:0xf
    v_and_b32_dpp v19, v11, v5 quad_perm:[2,2,2,2] row_mask:0xf bank_mask:0xf
    v_smfmac_f32_16x16x64_bf16 v[28:31], v[20:23], v[88:95], v6
    v_add_f32_dpp v7, v7, v7 row_bcast:31 row_mask:0xc bank_mask:0xf
    v_and_b32_dpp v20, v10, v4 quad_perm:[3,3,3,3] row_mask:0xf bank_mask:0xf
    v_and_b32_dpp v21, v10, v5 quad_perm:[3,3,3,3] row_mask:0xf bank_mask:0xf
    v_smfmac_f32_16x16x64_bf16 v[24:27], v[16:19], v[96:103], v6
    v_and_b32_dpp v22, v11, v4 quad_perm:[3,3,3,3] row_mask:0xf bank_mask:0xf
    v_and_b32_dpp v23, v11, v5 quad_perm:[3,3,3,3] row_mask:0xf bank_mask:0xf
    v_smfmac_f32_16x16x64_bf16 v[28:31], v[16:19], v[104:111], v6
    v_readlane_b32 s62, v7, 63
    v_and_b32_dpp v16, v12, v4 quad_perm:[0,0,0,0] row_mask:0xf bank_mask:0xf
    v_and_b32_dpp v17, v12, v5 quad_perm:[0,0,0,0] row_mask:0xf bank_mask:0xf
    v_smfmac_f32_16x16x64_bf16 v[24:27], v[20:23], v[112:119], v6
    v_and_b32_dpp v18, v13, v4 quad_perm:[0,0,0,0] row_mask:0xf bank_mask:0xf
    v_and_b32_dpp v19, v13, v5 quad_perm:[0,0,0,0] row_mask:0xf bank_mask:0xf
    v_smfmac_f32_16x16x64_bf16 v[28:31], v[20:23], v[120:127], v6
    s_add_u32 s48, s90, 0
    s_and_b32 s48, s48, 0xff
    s_add_u32 s49, s90, 53
    s_waitcnt vmcnt(6)
    s_add_u32 s5, s4, 62
    s_and_b32 s5, s5, 63
    s_lshl_b32 s5, s5, 12
    buffer_load_dwordx4 v[248:251], v2, s[12:15], s5 offen nt
    v_and_b32_dpp v20, v12, v4 quad_perm:[1,1,1,1] row_mask:0xf bank_mask:0xf
    v_and_b32_dpp v21, v12, v5 quad_perm:[1,1,1,1] row_mask:0xf bank_mask:0xf
    v_smfmac_f32_16x16x64_bf16 v[24:27], v[16:19], v[128:135], v6
    v_and_b32_dpp v22, v13, v4 quad_perm:[1,1,1,1] row_mask:0xf bank_mask:0xf
    v_and_b32_dpp v23, v13, v5 quad_perm:[1,1,1,1] row_mask:0xf bank_mask:0xf
    v_smfmac_f32_16x16x64_bf16 v[28:31], v[16:19], v[136:143], v6
    s_and_b32 s49, s49, 0xff
    s_add_u32 s50, s90, 106
    s_and_b32 s50, s50, 0xff
    v_and_b32_dpp v16, v12, v4 quad_perm:[2,2,2,2] row_mask:0xf bank_mask:0xf
    v_and_b32_dpp v17, v12, v5 quad_perm:[2,2,2,2] row_mask:0xf bank_mask:0xf
    v_smfmac_f32_16x16x64_bf16 v[24:27], v[20:23], v[144:151], v6
    v_and_b32_dpp v18, v13, v4 quad_perm:[2,2,2,2] row_mask:0xf bank_mask:0xf
    v_and_b32_dpp v19, v13, v5 quad_perm:[2,2,2,2] row_mask:0xf bank_mask:0xf
    v_smfmac_f32_16x16x64_bf16 v[28:31], v[20:23], v[152:159], v6
    s_add_u32 s51, s90, 159
    s_and_b32 s51, s51, 0xff
    s_add_u32 s59, s24, 0
    s_waitcnt vmcnt(5)
    s_add_u32 s5, s4, 63
    s_and_b32 s5, s5, 63
    s_lshl_b32 s5, s5, 12
    buffer_load_dwordx4 v[252:255], v2, s[12:15], s5 offen nt
    v_and_b32_dpp v20, v12, v4 quad_perm:[3,3,3,3] row_mask:0xf bank_mask:0xf
    v_and_b32_dpp v21, v12, v5 quad_perm:[3,3,3,3] row_mask:0xf bank_mask:0xf
    v_smfmac_f32_16x16x64_bf16 v[24:27], v[16:19], v[160:167], v6
    v_and_b32_dpp v22, v13, v4 quad_perm:[3,3,3,3] row_mask:0xf bank_mask:0xf
    v_and_b32_dpp v23, v13, v5 quad_perm:[3,3,3,3] row_mask:0xf bank_mask:0xf
    v_smfmac_f32_16x16x64_bf16 v[28:31], v[16:19], v[168:175], v6
    s_add_u32 s60, s25, 0
    v_add3_u32 v35, v43, s90, 0
    v_mov_b32 v38, s61
    v_and_b32_dpp v16, v14, v4 quad_perm:[0,0,0,0] row_mask:0xf bank_mask:0xf
    v_and_b32_dpp v17, v14, v5 quad_perm:[0,0,0,0] row_mask:0xf bank_mask:0xf
    v_smfmac_f32_16x16x64_bf16 v[24:27], v[20:23], v[176:183], v6
    v_and_b32_dpp v18, v15, v4 quad_perm:[0,0,0,0] row_mask:0xf bank_mask:0xf
    v_and_b32_dpp v19, v15, v5 quad_perm:[0,0,0,0] row_mask:0xf bank_mask:0xf
    v_smfmac_f32_16x16x64_bf16 v[28:31], v[20:23], v[184:191], v6
    v_mov_b32 v39, s62
    v_lshlrev_b32_e64 v7, 3, s3
    s_mov_b64 exec, 1
    ds_write_b64 v7, v[38:39] offset:2048
    s_mov_b64 exec, -1
    s_waitcnt vmcnt(5)
    v_add_u32 v1, 0x4000000, v1
    s_add_u32 m0, s54, 20480
    s_add_u32 s5, s4, 0
    s_and_b32 s5, s5, 63
    s_lshl_b32 s5, s5, 12
    buffer_load_dwordx4 v1, s[8:11], s5 offen nt lds
    v_and_b32_dpp v20, v14, v4 quad_perm:[1,1,1,1] row_mask:0xf bank_mask:0xf
    v_and_b32_dpp v21, v14, v5 quad_perm:[1,1,1,1] row_mask:0xf bank_mask:0xf
    v_smfmac_f32_16x16x64_bf16 v[24:27], v[16:19], v[192:199], v6
    v_and_b32_dpp v22, v15, v4 quad_perm:[1,1,1,1] row_mask:0xf bank_mask:0xf
    v_and_b32_dpp v23, v15, v5 quad_perm:[1,1,1,1] row_mask:0xf bank_mask:0xf
    v_smfmac_f32_16x16x64_bf16 v[28:31], v[16:19], v[200:207], v6
    v_mov_b32 v7, 0
    s_add_u32 s28, s90, 2
    s_and_b32 s28, s28, 0xff
    v_and_b32_dpp v16, v14, v4 quad_perm:[2,2,2,2] row_mask:0xf bank_mask:0xf
    v_and_b32_dpp v17, v14, v5 quad_perm:[2,2,2,2] row_mask:0xf bank_mask:0xf
    v_smfmac_f32_16x16x64_bf16 v[24:27], v[20:23], v[208:215], v6
    v_and_b32_dpp v18, v15, v4 quad_perm:[2,2,2,2] row_mask:0xf bank_mask:0xf
    v_and_b32_dpp v19, v15, v5 quad_perm:[2,2,2,2] row_mask:0xf bank_mask:0xf
    v_smfmac_f32_16x16x64_bf16 v[28:31], v[20:23], v[216:223], v6
    s_add_u32 s29, s90, 55
    s_and_b32 s29, s29, 0xff
    s_add_u32 s30, s90, 108
    s_waitcnt vmcnt(5)
    s_add_u32 m0, s54, 21504
    s_add_u32 s5, s4, 1
    s_and_b32 s5, s5, 63
    s_lshl_b32 s5, s5, 12
    buffer_load_dwordx4 v1, s[8:11], s5 offen nt lds
    v_and_b32_dpp v20, v14, v4 quad_perm:[3,3,3,3] row_mask:0xf bank_mask:0xf
    v_and_b32_dpp v21, v14, v5 quad_perm:[3,3,3,3] row_mask:0xf bank_mask:0xf
    v_smfmac_f32_16x16x64_bf16 v[24:27], v[16:19], v[224:231], v6
    v_and_b32_dpp v22, v15, v4 quad_perm:[3,3,3,3] row_mask:0xf bank_mask:0xf
    v_and_b32_dpp v23, v15, v5 quad_perm:[3,3,3,3] row_mask:0xf bank_mask:0xf
    v_smfmac_f32_16x16x64_bf16 v[28:31], v[16:19], v[232:239], v6
    s_and_b32 s30, s30, 0xff
    s_add_u32 s31, s90, 161
    s_and_b32 s31, s31, 0xff
    s_waitcnt vmcnt(5)
    s_add_u32 m0, s54, 22528
    s_add_u32 s5, s4, 2
    s_and_b32 s5, s5, 63
    s_lshl_b32 s5, s5, 12
    buffer_load_dwordx4 v1, s[8:11], s5 offen nt lds
    s_waitcnt vmcnt(5)
    v_smfmac_f32_16x16x64_bf16 v[24:27], v[20:23], v[240:247], v6
    s_add_u32 m0, s54, 23552
    s_add_u32 s5, s4, 3
    s_and_b32 s5, s5, 63
    s_lshl_b32 s5, s5, 12
    buffer_load_dwordx4 v1, s[8:11], s5 offen nt lds
    s_waitcnt vmcnt(5)
    s_add_u32 m0, s54, 24576
    s_add_u32 s5, s4, 4
    s_and_b32 s5, s5, 63
    s_lshl_b32 s5, s5, 12
    buffer_load_dwordx4 v1, s[8:11], s5 offen nt lds
    s_waitcnt vmcnt(5)
    v_smfmac_f32_16x16x64_bf16 v[28:31], v[20:23], v[248:255], v6
    s_nop 7
    v_cndmask_b32_e64 v24, v24, v28, s[64:65]
    v_cndmask_b32_e64 v25, v25, v29, s[64:65]
    v_cndmask_b32_e64 v26, v26, v30, s[64:65]
    v_cndmask_b32_e64 v27, v27, v31, s[64:65]
    s_nop 0
    v_permlane32_swap_b32 v24, v26
    v_permlane32_swap_b32 v25, v27
    v_add_f32 v24, v24, v26
    v_add_f32 v25, v25, v27
    ds_write_b64 v40, v[24:25] offset:0
    s_waitcnt lgkmcnt(0)
    s_barrier
    ds_read_b128 v[8:11], v7 offset:2048
    ds_read_b128 v[12:15], v7 offset:2064
    ds_read_b32 v16, v41 offset:0
    ds_read_b32 v17, v41 offset:512
    ds_read_b32 v18, v41 offset:1024
    ds_read_b32 v19, v41 offset:1536
    s_waitcnt lgkmcnt(4)
    v_max3_f32 v22, v8, v10, v12
    v_max_f32 v22, v22, v14
    v_sub_f32 v8, v8, v22
    v_sub_f32 v10, v10, v22
    v_sub_f32 v12, v12, v22
    v_sub_f32 v14, v14, v22
    v_exp_f32 v8, v8
    v_exp_f32 v10, v10
    v_exp_f32 v12, v12
    v_exp_f32 v14, v14
    v_lshlrev_b32 v21, 8, v22
    v_cndmask_b32_e64 v22, v22, v21, s[72:73]
    s_waitcnt lgkmcnt(0)
    v_cndmask_b32_e64 v16, v16, v9, s[64:65]
    v_cndmask_b32_e64 v17, v17, v11, s[64:65]
    v_cndmask_b32_e64 v18, v18, v13, s[64:65]
    v_cndmask_b32_e64 v19, v19, v15, s[64:65]
    v_mul_f32 v23, v8, v16
    v_fmac_f32 v23, v10, v17
    v_fmac_f32 v23, v12, v18
    v_fmac_f32 v23, v14, v19
    v_cndmask_b32_e64 v23, v23, v22, s[66:67]
    v_bfi_b32 v23, s87, v35, v23
    s_mov_b32 exec_hi, s56
    s_cmp_eq_u32 s53, 0
    s_cbranch_scc1 L_slow_80
    buffer_store_dword v23, v42, s[16:19], s59 offen
L_pub_81:
    s_mov_b32 exec_hi, -1
    s_cmp_lg_u32 s1, 0
    s_cbranch_scc1 L_odd_108
    buffer_load_dwordx4 v[24:27], v46, s[16:19], s60 offen offset:512 sc1
    buffer_load_dwordx4 v[8:11], v45, s[16:19], s60 offen offset:0 sc1
    buffer_load_dwordx4 v[12:15], v45, s[16:19], s60 offen offset:1280 sc1
    buffer_load_dwordx4 v[16:19], v45, s[16:19], s60 offen offset:2560 sc1
    buffer_load_dwordx4 v[20:23], v45, s[16:19], s60 offen offset:3840 sc1
    v_and_b32 v30, 48, v0
    v_lshl_add_u32 v32, s3, 8, v30
    v_lshl_add_u32 v33, s3, 7, v30
    v_lshlrev_b32 v34, 2, v0
    s_add_u32 s59, s26, 0
    s_waitcnt vmcnt(4)
    v_xor_b32 v24, s48, v24
    v_xor_b32 v25, s49, v25
    v_xor_b32 v26, s50, v26
    v_xor_b32 v27, s51, v27
    v_or3_b32 v28, v24, v25, v26
    v_or_b32 v28, v28, v27
    s_waitcnt vmcnt(3)
    v_xor_b32 v8, s48, v8
    v_xor_b32 v9, s49, v9
    v_xor_b32 v10, s50, v10
    v_xor_b32 v11, s51, v11
    v_or3_b32 v28, v28, v8, v9
    v_or3_b32 v28, v28, v10, v11
    s_waitcnt vmcnt(2)
    v_xor_b32 v12, s48, v12
    v_xor_b32 v13, s49, v13
    v_xor_b32 v14, s50, v14
    v_xor_b32 v15, s51, v15
    v_or3_b32 v28, v28, v12, v13
    v_or3_b32 v28, v28, v14, v15
    s_waitcnt vmcnt(1)
    v_xor_b32 v16, s48, v16
    v_xor_b32 v17, s49, v17
    v_xor_b32 v18, s50, v18
    v_xor_b32 v19, s51, v19
    v_or3_b32 v28, v28, v16, v17
    v_or3_b32 v28, v28, v18, v19
    s_waitcnt vmcnt(0)
    v_xor_b32 v20, s48, v20
    v_xor_b32 v21, s49, v21
    v_xor_b32 v22, s50, v22
    v_xor_b32 v23, s51, v23
    v_or3_b32 v28, v28, v20, v21
    v_or3_b32 v28, v28, v22, v23
    v_and_b32 v28, 0xff, v28
    v_cmp_ne_u32 vcc, 0, v28
    s_cbranch_vccnz L_retry_82
L_ok_85:
    v_lshrrev_b32 v26, 8, v26
    v_or_b32 v24, v24, v26
    s_nop 1
    v_max_f32_dpp v28, v24, v24 quad_perm:[1,0,3,2] row_mask:0xf bank_mask:0xf
    s_nop 1
    v_max_f32_dpp v28, v28, v28 quad_perm:[2,3,0,1] row_mask:0xf bank_mask:0xf
    s_nop 1
    v_max_f32_dpp v28, v28, v28 row_half_mirror row_mask:0xf bank_mask:0xf
    v_sub_f32 v24, v24, v28
    v_exp_f32 v24, v24
    s_nop 0
    v_mul_f32 v25, v24, v25
    v_mul_f32_dpp v36, v24, v8 row_newbcast:0 row_mask:0xf bank_mask:0xf
    v_mul_f32_dpp v37, v24, v9 row_newbcast:0 row_mask:0xf bank_mask:0xf
    v_mul_f32_dpp v38, v24, v10 row_newbcast:0 row_mask:0xf bank_mask:0xf
    v_mul_f32_dpp v39, v24, v11 row_newbcast:0 row_mask:0xf bank_mask:0xf
    v_add_f32_dpp v25, v25, v25 quad_perm:[1,0,3,2] row_mask:0xf bank_mask:0xf
    v_fmac_f32_dpp v36, v24, v12 row_newbcast:2 row_mask:0xf bank_mask:0xf
    v_fmac_f32_dpp v37, v24, v13 row_newbcast:2 row_mask:0xf bank_mask:0xf
    v_fmac_f32_dpp v38, v24, v14 row_newbcast:2 row_mask:0xf bank_mask:0xf
    v_fmac_f32_dpp v39, v24, v15 row_newbcast:2 row_mask:0xf bank_mask:0xf
    v_add_f32_dpp v25, v25, v25 quad_perm:[2,3,0,1] row_mask:0xf bank_mask:0xf
    v_fmac_f32_dpp v36, v24, v16 row_newbcast:4 row_mask:0xf bank_mask:0xf
    v_fmac_f32_dpp v37, v24, v17 row_newbcast:4 row_mask:0xf bank_mask:0xf
    v_fmac_f32_dpp v38, v24, v18 row_newbcast:4 row_mask:0xf bank_mask:0xf
    v_fmac_f32_dpp v39, v24, v19 row_newbcast:4 row_mask:0xf bank_mask:0xf
    v_add_f32_dpp v25, v25, v25 row_half_mirror row_mask:0xf bank_mask:0xf
    v_fmac_f32_dpp v36, v24, v20 row_newbcast:6 row_mask:0xf bank_mask:0xf
    v_fmac_f32_dpp v37, v24, v21 row_newbcast:6 row_mask:0xf bank_mask:0xf
    v_fmac_f32_dpp v38, v24, v22 row_newbcast:6 row_mask:0xf bank_mask:0xf
    v_fmac_f32_dpp v39, v24, v23 row_newbcast:6 row_mask:0xf bank_mask:0xf
    v_rcp_f32 v25, v25
    v_permlane32_swap_b32 v36, v38
    v_permlane32_swap_b32 v37, v39
    v_add_f32 v36, v36, v38
    v_add_f32 v37, v37, v39
    v_mul_f32 v36, v36, v25
    v_mul_f32 v37, v37, v25
    v_cvt_pk_bf16_f32 v36, v36, v37
    ds_write_b32 v47, v36 offset:2624
    ds_read_b128 v[8:11], v32 offset:2624
    ds_read_b128 v[12:15], v32 offset:2688
    ds_read_b128 v[16:19], v32 offset:2752
    ds_read_b128 v[20:23], v32 offset:2816
    s_waitcnt lgkmcnt(3)
    v_mfma_f32_16x16x32_bf16 v[24:27], v[48:51], v[8:11], 0
    v_mfma_f32_16x16x32_bf16 v[28:31], v[64:67], v[8:11], 0
    s_waitcnt lgkmcnt(2)
    v_mfma_f32_16x16x32_bf16 v[24:27], v[52:55], v[12:15], v[24:27]
    v_mfma_f32_16x16x32_bf16 v[28:31], v[68:71], v[12:15], v[28:31]
    s_waitcnt lgkmcnt(1)
    v_mfma_f32_16x16x32_bf16 v[24:27], v[56:59], v[16:19], v[24:27]
    v_mfma_f32_16x16x32_bf16 v[28:31], v[72:75], v[16:19], v[28:31]
    s_waitcnt lgkmcnt(0)
    v_mfma_f32_16x16x32_bf16 v[24:27], v[60:63], v[20:23], v[24:27]
    v_mfma_f32_16x16x32_bf16 v[28:31], v[76:79], v[20:23], v[28:31]
    s_mov_b32 exec_lo, 0x00010001
    s_mov_b32 exec_hi, 0x00010001
    s_nop 4
    ds_write_b128 v33, v[24:27] offset:2112
    ds_write_b128 v33, v[28:31] offset:2176
    s_mov_b64 exec, -1
    s_xor_b32 s57, s86, 1799596464
    s_waitcnt lgkmcnt(0)
    s_barrier
    v_mov_b32 v31, s57
    s_cmp_lg_u32 s3, 0
    s_cbranch_scc1 L_w0_86
    s_mov_b32 exec_hi, 0
    ds_read_b32 v10, v34 offset:2112
    ds_read_b32 v11, v34 offset:2240
    ds_read_b32 v12, v34 offset:2368
    ds_read_b32 v13, v34 offset:2496
    s_waitcnt lgkmcnt(0)
    v_add_f32 v10, v10, v11
    v_add_f32 v12, v12, v13
    v_add_f32 v10, v10, v12
    v_bfi_b32 v10, s87, v35, v10
    buffer_store_dword v10, v34, s[16:19], s59 offen sc1
    s_cmp_eq_u32 s53, 0
    s_cbranch_scc1 L_slow_87
    buffer_store_dword v31, v34, s[16:19], s63 offen
L_pub_88:
    s_mov_b32 exec_hi, -1
L_w0_86:
    s_add_u32 m0, s54, 25600
    s_add_u32 s5, s4, 5
    s_and_b32 s5, s5, 63
    s_lshl_b32 s5, s5, 12
    buffer_load_dwordx4 v1, s[8:11], s5 offen nt lds
    s_add_u32 m0, s54, 26624
    s_add_u32 s5, s4, 6
    s_and_b32 s5, s5, 63
    s_lshl_b32 s5, s5, 12
    buffer_load_dwordx4 v1, s[8:11], s5 offen nt lds
    s_add_u32 m0, s54, 27648
    s_add_u32 s5, s4, 7
    s_and_b32 s5, s5, 63
    s_lshl_b32 s5, s5, 12
    buffer_load_dwordx4 v1, s[8:11], s5 offen nt lds
    s_add_u32 m0, s54, 28672
    s_add_u32 s5, s4, 8
    s_and_b32 s5, s5, 63
    s_lshl_b32 s5, s5, 12
    buffer_load_dwordx4 v1, s[8:11], s5 offen nt lds
    s_add_u32 m0, s54, 29696
    s_add_u32 s5, s4, 9
    s_and_b32 s5, s5, 63
    s_lshl_b32 s5, s5, 12
    buffer_load_dwordx4 v1, s[8:11], s5 offen nt lds
    s_add_u32 m0, s54, 30720
    s_add_u32 s5, s4, 10
    s_and_b32 s5, s5, 63
    s_lshl_b32 s5, s5, 12
    buffer_load_dwordx4 v1, s[8:11], s5 offen nt lds
    s_add_u32 m0, s54, 31744
    s_add_u32 s5, s4, 11
    s_and_b32 s5, s5, 63
    s_lshl_b32 s5, s5, 12
    buffer_load_dwordx4 v1, s[8:11], s5 offen nt lds
    s_add_u32 m0, s54, 32768
    s_add_u32 s5, s4, 12
    s_and_b32 s5, s5, 63
    s_lshl_b32 s5, s5, 12
    buffer_load_dwordx4 v1, s[8:11], s5 offen nt lds
    s_add_u32 m0, s54, 33792
    s_add_u32 s5, s4, 13
    s_and_b32 s5, s5, 63
    s_lshl_b32 s5, s5, 12
    buffer_load_dwordx4 v1, s[8:11], s5 offen nt lds
    s_add_u32 m0, s54, 34816
    s_add_u32 s5, s4, 14
    s_and_b32 s5, s5, 63
    s_lshl_b32 s5, s5, 12
    buffer_load_dwordx4 v1, s[8:11], s5 offen nt lds
    s_add_u32 m0, s54, 35840
    s_add_u32 s5, s4, 15
    s_and_b32 s5, s5, 63
    s_lshl_b32 s5, s5, 12
    buffer_load_dwordx4 v1, s[8:11], s5 offen nt lds
    s_add_u32 m0, s54, 36864
    s_add_u32 s5, s4, 16
    s_and_b32 s5, s5, 63
    s_lshl_b32 s5, s5, 12
    buffer_load_dwordx4 v1, s[8:11], s5 offen nt lds
    s_add_u32 m0, s54, 37888
    s_add_u32 s5, s4, 17
    s_and_b32 s5, s5, 63
    s_lshl_b32 s5, s5, 12
    buffer_load_dwordx4 v1, s[8:11], s5 offen nt lds
    s_add_u32 m0, s54, 38912
    s_add_u32 s5, s4, 18
    s_and_b32 s5, s5, 63
    s_lshl_b32 s5, s5, 12
    buffer_load_dwordx4 v1, s[8:11], s5 offen lds
    s_add_u32 m0, s54, 38912
    s_add_u32 s5, s4, 19
    s_and_b32 s5, s5, 63
    s_lshl_b32 s5, s5, 12
    buffer_load_dwordx4 v1, s[8:11], s5 offen lds
    s_add_u32 m0, s54, 38912
    s_add_u32 s5, s4, 20
    s_and_b32 s5, s5, 63
    s_lshl_b32 s5, s5, 12
    buffer_load_dwordx4 v1, s[8:11], s5 offen lds
    s_add_u32 m0, s54, 38912
    s_add_u32 s5, s4, 21
    s_and_b32 s5, s5, 63
    s_lshl_b32 s5, s5, 12
    buffer_load_dwordx4 v1, s[8:11], s5 offen lds
    s_add_u32 m0, s54, 38912
    s_add_u32 s5, s4, 22
    s_and_b32 s5, s5, 63
    s_lshl_b32 s5, s5, 12
    buffer_load_dwordx4 v1, s[8:11], s5 offen lds
    s_add_u32 m0, s54, 38912
    s_add_u32 s5, s4, 23
    s_and_b32 s5, s5, 63
    s_lshl_b32 s5, s5, 12
    buffer_load_dwordx4 v1, s[8:11], s5 offen lds
    s_add_u32 m0, s54, 38912
    s_add_u32 s5, s4, 24
    s_and_b32 s5, s5, 63
    s_lshl_b32 s5, s5, 12
    buffer_load_dwordx4 v1, s[8:11], s5 offen lds
    s_add_u32 m0, s54, 38912
    s_add_u32 s5, s4, 25
    s_and_b32 s5, s5, 63
    s_lshl_b32 s5, s5, 12
    buffer_load_dwordx4 v1, s[8:11], s5 offen lds
    s_add_u32 m0, s54, 38912
    s_add_u32 s5, s4, 26
    s_and_b32 s5, s5, 63
    s_lshl_b32 s5, s5, 12
    buffer_load_dwordx4 v1, s[8:11], s5 offen lds
    s_add_u32 m0, s54, 38912
    s_add_u32 s5, s4, 27
    s_and_b32 s5, s5, 63
    s_lshl_b32 s5, s5, 12
    buffer_load_dwordx4 v1, s[8:11], s5 offen lds
    s_add_u32 m0, s54, 38912
    s_add_u32 s5, s4, 28
    s_and_b32 s5, s5, 63
    s_lshl_b32 s5, s5, 12
    buffer_load_dwordx4 v1, s[8:11], s5 offen lds
    s_add_u32 m0, s54, 38912
    s_add_u32 s5, s4, 29
    s_and_b32 s5, s5, 63
    s_lshl_b32 s5, s5, 12
    buffer_load_dwordx4 v1, s[8:11], s5 offen lds
    s_add_u32 m0, s54, 38912
    s_add_u32 s5, s4, 30
    s_and_b32 s5, s5, 63
    s_lshl_b32 s5, s5, 12
    buffer_load_dwordx4 v1, s[8:11], s5 offen lds
    s_add_u32 m0, s54, 38912
    s_add_u32 s5, s4, 31
    s_and_b32 s5, s5, 63
    s_lshl_b32 s5, s5, 12
    buffer_load_dwordx4 v1, s[8:11], s5 offen lds
    s_add_u32 m0, s54, 38912
    s_add_u32 s5, s4, 32
    s_and_b32 s5, s5, 63
    s_lshl_b32 s5, s5, 12
    buffer_load_dwordx4 v1, s[8:11], s5 offen lds
    s_add_u32 m0, s54, 38912
    s_add_u32 s5, s4, 33
    s_and_b32 s5, s5, 63
    s_lshl_b32 s5, s5, 12
    buffer_load_dwordx4 v1, s[8:11], s5 offen lds
    s_branch L_join_109
L_odd_108:
    v_lshrrev_b32 v37, 1, v46
    buffer_load_dword v24, v37, s[20:23], 0 offen offset:0
    s_mov_b32 s61, 458752
    s_add_u32 m0, s54, 25600
    s_add_u32 s5, s4, 5
    s_and_b32 s5, s5, 63
    s_lshl_b32 s5, s5, 12
    buffer_load_dwordx4 v1, s[8:11], s5 offen nt lds
    s_add_u32 m0, s54, 26624
    s_add_u32 s5, s4, 6
    s_and_b32 s5, s5, 63
    s_lshl_b32 s5, s5, 12
    buffer_load_dwordx4 v1, s[8:11], s5 offen nt lds
    s_add_u32 m0, s54, 27648
    s_add_u32 s5, s4, 7
    s_and_b32 s5, s5, 63
    s_lshl_b32 s5, s5, 12
    buffer_load_dwordx4 v1, s[8:11], s5 offen nt lds
    s_add_u32 m0, s54, 28672
    s_add_u32 s5, s4, 8
    s_and_b32 s5, s5, 63
    s_lshl_b32 s5, s5, 12
    buffer_load_dwordx4 v1, s[8:11], s5 offen nt lds
    s_add_u32 m0, s54, 29696
    s_add_u32 s5, s4, 9
    s_and_b32 s5, s5, 63
    s_lshl_b32 s5, s5, 12
    buffer_load_dwordx4 v1, s[8:11], s5 offen nt lds
    s_add_u32 m0, s54, 30720
    s_add_u32 s5, s4, 10
    s_and_b32 s5, s5, 63
    s_lshl_b32 s5, s5, 12
    buffer_load_dwordx4 v1, s[8:11], s5 offen nt lds
    s_add_u32 m0, s54, 31744
    s_add_u32 s5, s4, 11
    s_and_b32 s5, s5, 63
    s_lshl_b32 s5, s5, 12
    buffer_load_dwordx4 v1, s[8:11], s5 offen nt lds
    s_add_u32 m0, s54, 32768
    s_add_u32 s5, s4, 12
    s_and_b32 s5, s5, 63
    s_lshl_b32 s5, s5, 12
    buffer_load_dwordx4 v1, s[8:11], s5 offen nt lds
    s_add_u32 m0, s54, 33792
    s_add_u32 s5, s4, 13
    s_and_b32 s5, s5, 63
    s_lshl_b32 s5, s5, 12
    buffer_load_dwordx4 v1, s[8:11], s5 offen nt lds
    s_add_u32 m0, s54, 34816
    s_add_u32 s5, s4, 14
    s_and_b32 s5, s5, 63
    s_lshl_b32 s5, s5, 12
    buffer_load_dwordx4 v1, s[8:11], s5 offen nt lds
    s_add_u32 m0, s54, 35840
    s_add_u32 s5, s4, 15
    s_and_b32 s5, s5, 63
    s_lshl_b32 s5, s5, 12
    buffer_load_dwordx4 v1, s[8:11], s5 offen nt lds
    s_add_u32 m0, s54, 36864
    s_add_u32 s5, s4, 16
    s_and_b32 s5, s5, 63
    s_lshl_b32 s5, s5, 12
    buffer_load_dwordx4 v1, s[8:11], s5 offen nt lds
    s_add_u32 m0, s54, 37888
    s_add_u32 s5, s4, 17
    s_and_b32 s5, s5, 63
    s_lshl_b32 s5, s5, 12
    buffer_load_dwordx4 v1, s[8:11], s5 offen nt lds
    s_add_u32 m0, s54, 38912
    s_add_u32 s5, s4, 18
    s_and_b32 s5, s5, 63
    s_lshl_b32 s5, s5, 12
    buffer_load_dwordx4 v1, s[8:11], s5 offen lds
    s_add_u32 m0, s54, 38912
    s_add_u32 s5, s4, 19
    s_and_b32 s5, s5, 63
    s_lshl_b32 s5, s5, 12
    buffer_load_dwordx4 v1, s[8:11], s5 offen lds
    s_add_u32 m0, s54, 38912
    s_add_u32 s5, s4, 20
    s_and_b32 s5, s5, 63
    s_lshl_b32 s5, s5, 12
    buffer_load_dwordx4 v1, s[8:11], s5 offen lds
    s_add_u32 m0, s54, 38912
    s_add_u32 s5, s4, 21
    s_and_b32 s5, s5, 63
    s_lshl_b32 s5, s5, 12
    buffer_load_dwordx4 v1, s[8:11], s5 offen lds
    s_add_u32 m0, s54, 38912
    s_add_u32 s5, s4, 22
    s_and_b32 s5, s5, 63
    s_lshl_b32 s5, s5, 12
    buffer_load_dwordx4 v1, s[8:11], s5 offen lds
    s_add_u32 m0, s54, 38912
    s_add_u32 s5, s4, 23
    s_and_b32 s5, s5, 63
    s_lshl_b32 s5, s5, 12
    buffer_load_dwordx4 v1, s[8:11], s5 offen lds
    s_add_u32 m0, s54, 38912
    s_add_u32 s5, s4, 24
    s_and_b32 s5, s5, 63
    s_lshl_b32 s5, s5, 12
    buffer_load_dwordx4 v1, s[8:11], s5 offen lds
    s_add_u32 m0, s54, 38912
    s_add_u32 s5, s4, 25
    s_and_b32 s5, s5, 63
    s_lshl_b32 s5, s5, 12
    buffer_load_dwordx4 v1, s[8:11], s5 offen lds
    s_add_u32 m0, s54, 38912
    s_add_u32 s5, s4, 26
    s_and_b32 s5, s5, 63
    s_lshl_b32 s5, s5, 12
    buffer_load_dwordx4 v1, s[8:11], s5 offen lds
    s_add_u32 m0, s54, 38912
    s_add_u32 s5, s4, 27
    s_and_b32 s5, s5, 63
    s_lshl_b32 s5, s5, 12
    buffer_load_dwordx4 v1, s[8:11], s5 offen lds
    s_add_u32 m0, s54, 38912
    s_add_u32 s5, s4, 28
    s_and_b32 s5, s5, 63
    s_lshl_b32 s5, s5, 12
    buffer_load_dwordx4 v1, s[8:11], s5 offen lds
    s_add_u32 m0, s54, 38912
    s_add_u32 s5, s4, 29
    s_and_b32 s5, s5, 63
    s_lshl_b32 s5, s5, 12
    buffer_load_dwordx4 v1, s[8:11], s5 offen lds
    s_add_u32 m0, s54, 38912
    s_add_u32 s5, s4, 30
    s_and_b32 s5, s5, 63
    s_lshl_b32 s5, s5, 12
    buffer_load_dwordx4 v1, s[8:11], s5 offen lds
    s_xor_b32 s59, s86, 1799596464
    buffer_load_dword v33, off, s[16:19], s63 sc1
    s_waitcnt vmcnt(0)
    v_cmp_ne_u32 vcc, s59, v33
    s_cbranch_vccnz L_retry_89
L_ok_92:
    s_add_u32 s60, s61, 0
    buffer_load_dwordx4 v[8:11], v45, s[16:19], s60 offen sc1
    s_add_u32 s60, s61, 4096
    buffer_load_dwordx4 v[12:15], v45, s[16:19], s60 offen sc1
    s_add_u32 s60, s61, 8192
    buffer_load_dwordx4 v[16:19], v45, s[16:19], s60 offen sc1
    s_add_u32 s60, s61, 12288
    buffer_load_dwordx4 v[20:23], v45, s[16:19], s60 offen sc1
    v_lshlrev_b32_e64 v34, 3, s3
    v_mov_b32 v39, 0
    v_mov_b32 v38, 0x3f800054
    v_and_b32 v32, 511, v46
    v_add3_u32 v35, v43, s90, 2
    s_bfe_u32 s59, s7, 0x20001
    s_cmp_eq_u32 s59, s3
    s_cselect_b64 s[84:85], -1, 0
    v_and_b32 v25, 0xffff0000, v24
    v_lshlrev_b32 v24, 16, v24
    s_waitcnt vmcnt(3)
    v_xor_b32 v8, s48, v8
    v_xor_b32 v9, s49, v9
    v_xor_b32 v10, s50, v10
    v_xor_b32 v11, s51, v11
    v_or3_b32 v33, v8, v9, v10
    v_or_b32 v33, v33, v11
    s_waitcnt vmcnt(2)
    v_xor_b32 v12, s48, v12
    v_xor_b32 v13, s49, v13
    v_xor_b32 v14, s50, v14
    v_xor_b32 v15, s51, v15
    v_or3_b32 v33, v33, v12, v13
    v_or3_b32 v33, v33, v14, v15
    s_waitcnt vmcnt(1)
    v_xor_b32 v16, s48, v16
    v_xor_b32 v17, s49, v17
    v_xor_b32 v18, s50, v18
    v_xor_b32 v19, s51, v19
    v_or3_b32 v33, v33, v16, v17
    v_or3_b32 v33, v33, v18, v19
    s_waitcnt vmcnt(0)
    v_xor_b32 v20, s48, v20
    v_xor_b32 v21, s49, v21
    v_xor_b32 v22, s50, v22
    v_xor_b32 v23, s51, v23
    v_or3_b32 v33, v33, v20, v21
    v_or3_b32 v33, v33, v22, v23
    v_and_b32 v33, 0xff, v33
    v_cmp_ne_u32 vcc, 0, v33
    s_cbranch_vccnz L_retry_93
L_ok_96:
    v_pk_add_f32 v[8:9], v[8:9], v[12:13]
    v_pk_add_f32 v[16:17], v[16:17], v[20:21]
    v_pk_add_f32 v[10:11], v[10:11], v[14:15]
    v_pk_add_f32 v[18:19], v[18:19], v[22:23]
    v_add_f32 v8, v8, v16
    v_add_f32 v9, v9, v17
    v_add_f32 v10, v10, v18
    v_add_f32 v11, v11, v19
    s_nop 0
    v_permlane32_swap_b32 v8, v10
    v_permlane32_swap_b32 v9, v11
    v_add_f32 v8, v8, v10
    v_add_f32 v9, v9, v11
    v_add_f32 v24, v24, v8
    v_add_f32 v25, v25, v9
    v_add_f32 v26, v24, v25
    v_mul_f32 v27, v24, v24
    v_fmac_f32 v27, v25, v25
    v_add_f32_dpp v26, v26, v26 quad_perm:[1,0,3,2] row_mask:0xf bank_mask:0xf
    s_nop 0
    v_add_f32_dpp v27, v27, v27 quad_perm:[1,0,3,2] row_mask:0xf bank_mask:0xf
    v_add_f32_dpp v26, v26, v26 quad_perm:[2,3,0,1] row_mask:0xf bank_mask:0xf
    s_nop 0
    v_add_f32_dpp v27, v27, v27 quad_perm:[2,3,0,1] row_mask:0xf bank_mask:0xf
    v_add_f32_dpp v26, v26, v26 row_half_mirror row_mask:0xf bank_mask:0xf
    s_nop 0
    v_add_f32_dpp v27, v27, v27 row_half_mirror row_mask:0xf bank_mask:0xf
    v_add_f32_dpp v26, v26, v26 row_mirror row_mask:0xf bank_mask:0xf
    s_nop 0
    v_add_f32_dpp v27, v27, v27 row_mirror row_mask:0xf bank_mask:0xf
    v_add_f32_dpp v26, v26, v26 row_bcast:15 row_mask:0xa bank_mask:0xf
    s_nop 0
    v_add_f32_dpp v27, v27, v27 row_bcast:15 row_mask:0xa bank_mask:0xf
    v_add_f32_dpp v26, v26, v26 row_bcast:31 row_mask:0xc bank_mask:0xf
    s_nop 0
    v_add_f32_dpp v27, v27, v27 row_bcast:31 row_mask:0xc bank_mask:0xf
    s_mov_b32 exec_lo, 0
    s_mov_b32 exec_hi, 0x80000000
    ds_write_b64 v34, v[26:27] offset:2048
    s_mov_b64 exec, -1
    s_movk_i32 s59, 0xfff
    s_mov_b32 s60, 528384
    s_waitcnt lgkmcnt(0)
    s_barrier
    ds_read_b128 v[8:11], v39 offset:2048
    ds_read_b128 v[12:15], v39 offset:2064
    s_waitcnt lgkmcnt(0)
    v_pk_add_f32 v[8:9], v[8:9], v[10:11]
    v_pk_add_f32 v[12:13], v[12:13], v[14:15]
    v_pk_add_f32 v[8:9], v[8:9], v[12:13]
    v_mul_f32 v8, 0x3b000000, v8
    v_mul_f32 v9, 0x3b000000, v9
    v_fma_f32 v9, -v8, v8, v9
    v_max_f32 v9, 0, v9
    v_fmaak_f32 v10, v9, v38, 0x2edbe6ff
    v_rsq_f32 v10, v10
    v_sub_f32 v26, v24, v8
    v_sub_f32 v27, v25, v8
    v_mul_f32 v26, v26, v10
    v_mul_f32 v27, v27, v10
    v_cvt_pk_bf16_f32 v36, v26, v27
    v_and_b32 v16, 0x7fff, v36
    v_bfe_u32 v17, v36, 16, 15
    v_bfe_u32 v18, v36, 15, 1
    v_lshrrev_b32 v19, 31, v36
    v_subrev_u32 v20, 12800, v16
    v_subrev_u32 v21, 12800, v17
    v_med3_i32 v20, v20, 0, s59
    v_med3_i32 v21, v21, 0, s59
    v_lshl_add_u32 v20, v18, 12, v20
    v_lshl_add_u32 v21, v19, 12, v21
    v_lshlrev_b32 v20, 2, v20
    buffer_load_dword v28, v20, s[16:19], s60 offen sc1
    v_lshlrev_b32 v21, 2, v21
    buffer_load_dword v29, v21, s[16:19], s60 offen sc1
    s_add_u32 m0, s54, 38912
    s_add_u32 s5, s4, 31
    s_and_b32 s5, s5, 63
    s_lshl_b32 s5, s5, 12
    buffer_load_dwordx4 v1, s[8:11], s5 offen lds
    s_add_u32 m0, s54, 38912
    s_add_u32 s5, s4, 32
    s_and_b32 s5, s5, 63
    s_lshl_b32 s5, s5, 12
    buffer_load_dwordx4 v1, s[8:11], s5 offen lds
    s_add_u32 m0, s54, 38912
    s_add_u32 s5, s4, 33
    s_and_b32 s5, s5, 63
    s_lshl_b32 s5, s5, 12
    buffer_load_dwordx4 v1, s[8:11], s5 offen lds
    s_mov_b32 s59, 12800
    v_add_u32 v16, -1, v16
    v_add_u32 v17, -1, v17
    v_cmp_gt_u32 s[48:49], s59, v16
    v_cmp_gt_u32 s[50:51], s59, v17
    s_nop 0
    s_or_b64 vcc, s[48:49], s[50:51]
    s_waitcnt vmcnt(3)
    s_cbranch_vccnz L_tiny_97
L_mixed_98:
    v_add_f32 v24, v24, v28
    v_add_f32 v25, v25, v29
    s_mov_b64 exec, s[84:85]
    ds_write_b64 v32, v[24:25] offset:2112
    s_mov_b64 exec, -1
    v_add_f32 v26, v24, v25
    v_mul_f32 v27, v24, v24
    v_fmac_f32 v27, v25, v25
    v_add_f32_dpp v26, v26, v26 quad_perm:[1,0,3,2] row_mask:0xf bank_mask:0xf
    s_nop 0
    v_add_f32_dpp v27, v27, v27 quad_perm:[1,0,3,2] row_mask:0xf bank_mask:0xf
    v_add_f32_dpp v26, v26, v26 quad_perm:[2,3,0,1] row_mask:0xf bank_mask:0xf
    s_nop 0
    v_add_f32_dpp v27, v27, v27 quad_perm:[2,3,0,1] row_mask:0xf bank_mask:0xf
    v_add_f32_dpp v26, v26, v26 row_half_mirror row_mask:0xf bank_mask:0xf
    s_nop 0
    v_add_f32_dpp v27, v27, v27 row_half_mirror row_mask:0xf bank_mask:0xf
    v_add_f32_dpp v26, v26, v26 row_mirror row_mask:0xf bank_mask:0xf
    s_nop 0
    v_add_f32_dpp v27, v27, v27 row_mirror row_mask:0xf bank_mask:0xf
    v_add_f32_dpp v26, v26, v26 row_bcast:15 row_mask:0xa bank_mask:0xf
    s_nop 0
    v_add_f32_dpp v27, v27, v27 row_bcast:15 row_mask:0xa bank_mask:0xf
    v_add_f32_dpp v26, v26, v26 row_bcast:31 row_mask:0xc bank_mask:0xf
    s_nop 0
    v_add_f32_dpp v27, v27, v27 row_bcast:31 row_mask:0xc bank_mask:0xf
    s_mov_b32 exec_lo, 0
    s_mov_b32 exec_hi, 0x80000000
    ds_write_b64 v34, v[26:27] offset:2080
    s_mov_b64 exec, -1
    s_cmp_lg_u32 s2, 9
    s_cbranch_scc1 L_keep_105
    s_mov_b32 s59, 524288
    buffer_store_dwordx2 v[24:25], v46, s[16:19], s59 offen
L_keep_105:
    v_mov_b32 v28, 0
    v_mov_b32 v29, 0
    v_mov_b32 v30, 0
    v_mov_b32 v31, 0
    v_lshlrev_b32 v32, 16, v4
    v_lshlrev_b32 v33, 16, v5
    s_waitcnt lgkmcnt(0)
    s_barrier
    ds_read_b128 v[8:11], v39 offset:2080
    ds_read_b128 v[12:15], v39 offset:2096
    ds_read_b128 v[16:19], v47 offset:2112
    ds_read_b128 v[20:23], v47 offset:2128
    s_waitcnt lgkmcnt(2)
    v_pk_add_f32 v[8:9], v[8:9], v[10:11]
    v_pk_add_f32 v[12:13], v[12:13], v[14:15]
    v_pk_add_f32 v[8:9], v[8:9], v[12:13]
    v_mul_f32 v8, 0x3b000000, v8
    v_mul_f32 v9, 0x3b000000, v9
    v_fma_f32 v9, -v8, v8, v9
    v_max_f32 v9, 0, v9
    v_add_f32 v10, 0x3727c5ac, v9
    v_rsq_f32 v10, v10
    s_waitcnt lgkmcnt(0)
    v_mul_f32 v11, v8, v10
    v_fma_f32 v16, v16, v10, -v11
    v_fma_f32 v17, v17, v10, -v11
    v_fma_f32 v18, v18, v10, -v11
    v_fma_f32 v19, v19, v10, -v11
    v_fma_f32 v20, v20, v10, -v11
    v_fma_f32 v21, v21, v10, -v11
    v_fma_f32 v22, v22, v10, -v11
    v_fma_f32 v23, v23, v10, -v11
    v_cvt_pk_bf16_f32 v16, v16, v17
    v_and_b32 v8, v16, v4
    v_and_b32 v9, v16, v5
    v_and_b32 v10, v16, v32
    v_and_b32 v11, v16, v33
    v_cvt_pk_bf16_f32 v17, v18, v19
    v_and_b32 v12, v17, v4
    v_and_b32 v13, v17, v5
    v_and_b32 v14, v17, v32
    v_and_b32 v15, v17, v33
    v_smfmac_f32_16x16x64_bf16 v[28:31], v[8:11], v[48:55], v6
    v_cvt_pk_bf16_f32 v18, v20, v21
    v_and_b32 v24, v18, v4
    v_and_b32 v25, v18, v5
    v_and_b32 v26, v18, v32
    v_and_b32 v27, v18, v33
    v_smfmac_f32_16x16x64_bf16 v[28:31], v[12:15], v[56:63], v6
    v_cvt_pk_bf16_f32 v19, v22, v23
    v_and_b32 v36, v19, v4
    v_and_b32 v37, v19, v5
    v_and_b32 v38, v19, v32
    v_and_b32 v39, v19, v33
    v_smfmac_f32_16x16x64_bf16 v[28:31], v[24:27], v[64:71], v6
    s_nop 0
    v_smfmac_f32_16x16x64_bf16 v[28:31], v[36:39], v[72:79], v6
    s_mov_b32 exec_hi, 0
    s_nop 6
    ds_write_b128 v40, v[28:31] offset:0
    s_waitcnt lgkmcnt(0)
    s_barrier
    ds_read_b32 v12, v41 offset:0
    ds_read_b32 v13, v41 offset:512
    ds_read_b32 v14, v41 offset:1024
    ds_read_b32 v15, v41 offset:1536
    s_waitcnt lgkmcnt(0)
    v_add_f32 v12, v12, v13
    v_add_f32 v14, v14, v15
    v_add_f32 v12, v12, v14
    v_bfi_b32 v12, s87, v35, v12
    s_cmp_eq_u32 s53, 0
    s_cbranch_scc1 L_slow_106
    buffer_store_dword v12, v41, s[16:19], s26 offen
L_pub_107:
    s_mov_b32 exec_hi, -1
L_join_109:
    buffer_load_dwordx4 v[8:11], v44, s[16:19], s27 offen offset:0 sc1
    buffer_load_dwordx4 v[12:15], v44, s[16:19], s27 offen offset:16 sc1
    s_waitcnt vmcnt(1)
    v_xor_b32 v8, s28, v8
    v_xor_b32 v9, s29, v9
    v_xor_b32 v10, s30, v10
    v_xor_b32 v11, s31, v11
    v_or3_b32 v25, v8, v9, v10
    v_or_b32 v25, v25, v11
    s_waitcnt vmcnt(0)
    v_xor_b32 v12, s28, v12
    v_xor_b32 v13, s29, v13
    v_xor_b32 v14, s30, v14
    v_xor_b32 v15, s31, v15
    v_or3_b32 v25, v25, v12, v13
    v_or3_b32 v25, v25, v14, v15
    v_and_b32 v25, 0xff, v25
    v_cmp_ne_u32 vcc, 0, v25
    s_cbranch_vccnz L_retry_110
L_ok_113:
    v_add_f32_dpp v8, v8, v8 row_ror:4 row_mask:0xf bank_mask:0xf
    v_add_f32_dpp v9, v9, v9 row_ror:4 row_mask:0xf bank_mask:0xf
    v_add_f32_dpp v10, v10, v10 row_ror:4 row_mask:0xf bank_mask:0xf
    v_add_f32_dpp v11, v11, v11 row_ror:4 row_mask:0xf bank_mask:0xf
    v_add_f32_dpp v12, v12, v12 row_ror:4 row_mask:0xf bank_mask:0xf
    v_add_f32_dpp v13, v13, v13 row_ror:4 row_mask:0xf bank_mask:0xf
    v_add_f32_dpp v14, v14, v14 row_ror:4 row_mask:0xf bank_mask:0xf
    v_add_f32_dpp v15, v15, v15 row_ror:4 row_mask:0xf bank_mask:0xf
    v_add_f32_dpp v8, v8, v8 row_ror:8 row_mask:0xf bank_mask:0xf
    v_add_f32_dpp v9, v9, v9 row_ror:8 row_mask:0xf bank_mask:0xf
    v_add_f32_dpp v10, v10, v10 row_ror:8 row_mask:0xf bank_mask:0xf
    v_add_f32_dpp v11, v11, v11 row_ror:8 row_mask:0xf bank_mask:0xf
    v_add_f32_dpp v12, v12, v12 row_ror:8 row_mask:0xf bank_mask:0xf
    v_add_f32_dpp v13, v13, v13 row_ror:8 row_mask:0xf bank_mask:0xf
    v_add_f32_dpp v14, v14, v14 row_ror:8 row_mask:0xf bank_mask:0xf
    v_add_f32_dpp v15, v15, v15 row_ror:8 row_mask:0xf bank_mask:0xf
    v_cvt_pk_bf16_f32 v36, v8, v9
    v_cvt_pk_bf16_f32 v37, v10, v11
    v_cvt_pk_bf16_f32 v38, v12, v13
    v_cvt_pk_bf16_f32 v39, v14, v15
    v_cndmask_b32_e64 v8, 0, v36, s[76:77]
    v_cndmask_b32_e64 v9, 0, v37, s[76:77]
    v_cndmask_b32_e64 v10, 0, v38, s[76:77]
    v_cndmask_b32_e64 v11, 0, v39, s[76:77]
    v_cndmask_b32_e64 v12, 0, v36, s[78:79]
    v_cndmask_b32_e64 v13, 0, v37, s[78:79]
    v_cndmask_b32_e64 v14, 0, v38, s[78:79]
    v_cndmask_b32_e64 v15, 0, v39, s[78:79]
    v_mfma_f32_16x16x32_bf16 v[24:27], a[0:3], v[8:11], 0
    v_cndmask_b32_e64 v16, 0, v36, s[80:81]
    v_cndmask_b32_e64 v17, 0, v37, s[80:81]
    v_cndmask_b32_e64 v18, 0, v38, s[80:81]
    v_cndmask_b32_e64 v19, 0, v39, s[80:81]
    v_mfma_f32_16x16x32_bf16 v[24:27], a[4:7], v[12:15], v[24:27]
    v_cndmask_b32_e64 v20, 0, v36, s[82:83]
    v_cndmask_b32_e64 v21, 0, v37, s[82:83]
    v_cndmask_b32_e64 v22, 0, v38, s[82:83]
    v_cndmask_b32_e64 v23, 0, v39, s[82:83]
    v_mfma_f32_16x16x32_bf16 v[24:27], a[8:11], v[16:19], v[24:27]
    s_nop 0
    v_mfma_f32_16x16x32_bf16 v[24:27], a[12:15], v[20:23], v[24:27]
    v_mfma_f32_16x16x32_bf16 v[28:31], a[16:19], v[8:11], 0
    v_mfma_f32_16x16x32_bf16 v[28:31], a[20:23], v[12:15], v[28:31]
    v_mfma_f32_16x16x32_bf16 v[28:31], a[24:27], v[16:19], v[28:31]
    v_mfma_f32_16x16x32_bf16 v[28:31], a[28:31], v[20:23], v[28:31]
    v_mfma_f32_16x16x32_bf16 v[32:35], a[32:35], v[8:11], 0
    s_nop 2
    v_mov_b32_dpp v24, v24 quad_perm:[0,0,0,0] row_mask:0xf bank_mask:0xf
    v_mov_b32_dpp v26, v26 quad_perm:[2,2,2,2] row_mask:0xf bank_mask:0xf
    v_mfma_f32_16x16x32_bf16 v[32:35], a[36:39], v[12:15], v[32:35]
    v_add_f32_dpp v24, v25, v24 quad_perm:[1,1,1,1] row_mask:0xf bank_mask:0xf
    v_add_f32_dpp v26, v27, v26 quad_perm:[3,3,3,3] row_mask:0xf bank_mask:0xf
    v_mfma_f32_16x16x32_bf16 v[32:35], a[40:43], v[16:19], v[32:35]
    v_add_f32 v24, v24, v26
    v_mfma_f32_16x16x32_bf16 v[32:35], a[44:47], v[20:23], v[32:35]
    v_cndmask_b32_e64 v36, v36, v24, s[68:69]
    v_mfma_f32_16x16x32_bf16 v[24:27], a[48:51], v[8:11], 0
    v_mov_b32_dpp v28, v28 quad_perm:[0,0,0,0] row_mask:0xf bank_mask:0xf
    v_mov_b32_dpp v30, v30 quad_perm:[2,2,2,2] row_mask:0xf bank_mask:0xf
    v_mfma_f32_16x16x32_bf16 v[24:27], a[52:55], v[12:15], v[24:27]
    v_add_f32_dpp v28, v29, v28 quad_perm:[1,1,1,1] row_mask:0xf bank_mask:0xf
    v_add_f32_dpp v30, v31, v30 quad_perm:[3,3,3,3] row_mask:0xf bank_mask:0xf
    v_mfma_f32_16x16x32_bf16 v[24:27], a[56:59], v[16:19], v[24:27]
    v_add_f32 v28, v28, v30
    v_mfma_f32_16x16x32_bf16 v[24:27], a[60:63], v[20:23], v[24:27]
    v_cndmask_b32_e64 v36, v36, v28, s[70:71]
    v_mfma_f32_16x16x32_bf16 v[28:31], a[64:67], v[8:11], 0
    s_add_u32 s5, s4, 34
    s_and_b32 s5, s5, 63
    s_lshl_b32 s5, s5, 12
    buffer_load_dwordx4 a[64:67], v1, s[8:11], s5 offen nt
    v_mov_b32_dpp v32, v32 quad_perm:[0,0,0,0] row_mask:0xf bank_mask:0xf
    v_mov_b32_dpp v34, v34 quad_perm:[2,2,2,2] row_mask:0xf bank_mask:0xf
    v_mfma_f32_16x16x32_bf16 v[28:31], a[68:71], v[12:15], v[28:31]
    s_add_u32 s5, s4, 35
    s_and_b32 s5, s5, 63
    s_lshl_b32 s5, s5, 12
    buffer_load_dwordx4 a[68:71], v1, s[8:11], s5 offen nt
    v_add_f32_dpp v32, v33, v32 quad_perm:[1,1,1,1] row_mask:0xf bank_mask:0xf
    v_add_f32_dpp v34, v35, v34 quad_perm:[3,3,3,3] row_mask:0xf bank_mask:0xf
    v_mfma_f32_16x16x32_bf16 v[28:31], a[72:75], v[16:19], v[28:31]
    s_add_u32 s5, s4, 36
    s_and_b32 s5, s5, 63
    s_lshl_b32 s5, s5, 12
    buffer_load_dwordx4 a[72:75], v1, s[8:11], s5 offen nt
    v_add_f32 v32, v32, v34
    v_mfma_f32_16x16x32_bf16 v[28:31], a[76:79], v[20:23], v[28:31]
    s_add_u32 s5, s4, 18
    s_and_b32 s5, s5, 63
    s_lshl_b32 s5, s5, 12
    buffer_load_dwordx4 a[0:3], v1, s[8:11], s5 offen nt
    v_cndmask_b32_e64 v36, v36, v32, s[72:73]
    v_mfma_f32_16x16x32_bf16 v[32:35], a[80:83], v[8:11], 0
    s_add_u32 s5, s4, 37
    s_and_b32 s5, s5, 63
    s_lshl_b32 s5, s5, 12
    buffer_load_dwordx4 a[76:79], v1, s[8:11], s5 offen nt
    v_mov_b32_dpp v24, v24 quad_perm:[0,0,0,0] row_mask:0xf bank_mask:0xf
    v_mov_b32_dpp v26, v26 quad_perm:[2,2,2,2] row_mask:0xf bank_mask:0xf
    v_mfma_f32_16x16x32_bf16 v[32:35], a[84:87], v[12:15], v[32:35]
    s_add_u32 s5, s4, 38
    s_and_b32 s5, s5, 63
    s_lshl_b32 s5, s5, 12
    buffer_load_dwordx4 a[80:83], v1, s[8:11], s5 offen nt
    v_add_f32_dpp v24, v25, v24 quad_perm:[1,1,1,1] row_mask:0xf bank_mask:0xf
    v_add_f32_dpp v26, v27, v26 quad_perm:[3,3,3,3] row_mask:0xf bank_mask:0xf
    v_mfma_f32_16x16x32_bf16 v[32:35], a[88:91], v[16:19], v[32:35]
    s_add_u32 s5, s4, 39
    s_and_b32 s5, s5, 63
    s_lshl_b32 s5, s5, 12
    buffer_load_dwordx4 a[84:87], v1, s[8:11], s5 offen nt
    v_add_f32 v24, v24, v26
    v_mfma_f32_16x16x32_bf16 v[32:35], a[92:95], v[20:23], v[32:35]
    s_add_u32 s5, s4, 19
    s_and_b32 s5, s5, 63
    s_lshl_b32 s5, s5, 12
    buffer_load_dwordx4 a[4:7], v1, s[8:11], s5 offen nt
    v_cndmask_b32_e64 v36, v36, v24, s[74:75]
    v_mfma_f32_16x16x32_bf16 v[24:27], a[96:99], v[8:11], 0
    s_add_u32 s5, s4, 40
    s_and_b32 s5, s5, 63
    s_lshl_b32 s5, s5, 12
    buffer_load_dwordx4 a[88:91], v1, s[8:11], s5 offen nt
    v_mov_b32_dpp v28, v28 quad_perm:[0,0,0,0] row_mask:0xf bank_mask:0xf
    v_mov_b32_dpp v30, v30 quad_perm:[2,2,2,2] row_mask:0xf bank_mask:0xf
    v_mfma_f32_16x16x32_bf16 v[24:27], a[100:103], v[12:15], v[24:27]
    v_add_f32_dpp v28, v29, v28 quad_perm:[1,1,1,1] row_mask:0xf bank_mask:0xf
    v_add_f32_dpp v30, v31, v30 quad_perm:[3,3,3,3] row_mask:0xf bank_mask:0xf
    v_mfma_f32_16x16x32_bf16 v[24:27], a[104:107], v[16:19], v[24:27]
    v_add_f32 v28, v28, v30
    v_mfma_f32_16x16x32_bf16 v[24:27], a[108:111], v[20:23], v[24:27]
    v_cndmask_b32_e64 v37, v37, v28, s[68:69]
    v_mfma_f32_16x16x32_bf16 v[28:31], a[112:115], v[8:11], 0
    v_mov_b32_dpp v32, v32 quad_perm:[0,0,0,0] row_mask:0xf bank_mask:0xf
    v_mov_b32_dpp v34, v34 quad_perm:[2,2,2,2] row_mask:0xf bank_mask:0xf
    v_mfma_f32_16x16x32_bf16 v[28:31], a[116:119], v[12:15], v[28:31]
    v_add_f32_dpp v32, v33, v32 quad_perm:[1,1,1,1] row_mask:0xf bank_mask:0xf
    v_add_f32_dpp v34, v35, v34 quad_perm:[3,3,3,3] row_mask:0xf bank_mask:0xf
    v_mfma_f32_16x16x32_bf16 v[28:31], a[120:123], v[16:19], v[28:31]
    v_add_f32 v32, v32, v34
    v_mfma_f32_16x16x32_bf16 v[28:31], a[124:127], v[20:23], v[28:31]
    v_cndmask_b32_e64 v37, v37, v32, s[70:71]
    s_waitcnt vmcnt(8)
    s_add_u32 s5, s4, 41
    s_and_b32 s5, s5, 63
    s_lshl_b32 s5, s5, 12
    buffer_load_dwordx4 a[92:95], v1, s[8:11], s5 offen nt
    s_waitcnt vmcnt(8)
    s_add_u32 s5, s4, 42
    s_and_b32 s5, s5, 63
    s_lshl_b32 s5, s5, 12
    buffer_load_dwordx4 a[96:99], v1, s[8:11], s5 offen nt
    v_mfma_f32_16x16x32_bf16 v[32:35], a[128:131], v[8:11], 0
    v_mov_b32_dpp v24, v24 quad_perm:[0,0,0,0] row_mask:0xf bank_mask:0xf
    v_mov_b32_dpp v26, v26 quad_perm:[2,2,2,2] row_mask:0xf bank_mask:0xf
    v_mfma_f32_16x16x32_bf16 v[32:35], a[132:135], v[12:15], v[32:35]
    v_add_f32_dpp v24, v25, v24 quad_perm:[1,1,1,1] row_mask:0xf bank_mask:0xf
    v_add_f32_dpp v26, v27, v26 quad_perm:[3,3,3,3] row_mask:0xf bank_mask:0xf
    v_mfma_f32_16x16x32_bf16 v[32:35], a[136:139], v[16:19], v[32:35]
    v_add_f32 v24, v24, v26
    v_mfma_f32_16x16x32_bf16 v[32:35], a[140:143], v[20:23], v[32:35]
    v_cndmask_b32_e64 v37, v37, v24, s[72:73]
    v_mfma_f32_16x16x32_bf16 v[24:27], a[144:147], v[8:11], 0
    v_mov_b32_dpp v28, v28 quad_perm:[0,0,0,0] row_mask:0xf bank_mask:0xf
    v_mov_b32_dpp v30, v30 quad_perm:[2,2,2,2] row_mask:0xf bank_mask:0xf
    v_mfma_f32_16x16x32_bf16 v[24:27], a[148:151], v[12:15], v[24:27]
    v_add_f32_dpp v28, v29, v28 quad_perm:[1,1,1,1] row_mask:0xf bank_mask:0xf
    v_add_f32_dpp v30, v31, v30 quad_perm:[3,3,3,3] row_mask:0xf bank_mask:0xf
    v_mfma_f32_16x16x32_bf16 v[24:27], a[152:155], v[16:19], v[24:27]
    v_add_f32 v28, v28, v30
    v_mfma_f32_16x16x32_bf16 v[24:27], a[156:159], v[20:23], v[24:27]
    v_cndmask_b32_e64 v37, v37, v28, s[74:75]
    s_waitcnt vmcnt(8)
    s_add_u32 s5, s4, 20
    s_and_b32 s5, s5, 63
    s_lshl_b32 s5, s5, 12
    buffer_load_dwordx4 a[8:11], v1, s[8:11], s5 offen nt
    s_waitcnt vmcnt(8)
    s_add_u32 s5, s4, 43
    s_and_b32 s5, s5, 63
    s_lshl_b32 s5, s5, 12
    buffer_load_dwordx4 a[100:103], v1, s[8:11], s5 offen nt
    v_mfma_f32_16x16x32_bf16 v[28:31], a[160:163], v[8:11], 0
    v_mov_b32_dpp v32, v32 quad_perm:[0,0,0,0] row_mask:0xf bank_mask:0xf
    v_mov_b32_dpp v34, v34 quad_perm:[2,2,2,2] row_mask:0xf bank_mask:0xf
    v_mfma_f32_16x16x32_bf16 v[28:31], a[164:167], v[12:15], v[28:31]
    v_add_f32_dpp v32, v33, v32 quad_perm:[1,1,1,1] row_mask:0xf bank_mask:0xf
    v_add_f32_dpp v34, v35, v34 quad_perm:[3,3,3,3] row_mask:0xf bank_mask:0xf
    v_mfma_f32_16x16x32_bf16 v[28:31], a[168:171], v[16:19], v[28:31]
    v_add_f32 v32, v32, v34
    v_mfma_f32_16x16x32_bf16 v[28:31], a[172:175], v[20:23], v[28:31]
    v_cndmask_b32_e64 v38, v38, v32, s[68:69]
    v_mfma_f32_16x16x32_bf16 v[32:35], a[176:179], v[8:11], 0
    v_mov_b32_dpp v24, v24 quad_perm:[0,0,0,0] row_mask:0xf bank_mask:0xf
    v_mov_b32_dpp v26, v26 quad_perm:[2,2,2,2] row_mask:0xf bank_mask:0xf
    v_mfma_f32_16x16x32_bf16 v[32:35], a[180:183], v[12:15], v[32:35]
    v_add_f32_dpp v24, v25, v24 quad_perm:[1,1,1,1] row_mask:0xf bank_mask:0xf
    v_add_f32_dpp v26, v27, v26 quad_perm:[3,3,3,3] row_mask:0xf bank_mask:0xf
    v_mfma_f32_16x16x32_bf16 v[32:35], a[184:187], v[16:19], v[32:35]
    v_add_f32 v24, v24, v26
    v_mfma_f32_16x16x32_bf16 v[32:35], a[188:191], v[20:23], v[32:35]
    v_cndmask_b32_e64 v38, v38, v24, s[70:71]
    s_waitcnt vmcnt(8)
    s_add_u32 s5, s4, 44
    s_and_b32 s5, s5, 63
    s_lshl_b32 s5, s5, 12
    buffer_load_dwordx4 a[104:107], v1, s[8:11], s5 offen nt
    s_waitcnt vmcnt(8)
    s_add_u32 s5, s4, 45
    s_and_b32 s5, s5, 63
    s_lshl_b32 s5, s5, 12
    buffer_load_dwordx4 a[108:111], v1, s[8:11], s5 offen nt
    v_mfma_f32_16x16x32_bf16 v[24:27], a[192:195], v[8:11], 0
    v_mov_b32_dpp v28, v28 quad_perm:[0,0,0,0] row_mask:0xf bank_mask:0xf
    v_mov_b32_dpp v30, v30 quad_perm:[2,2,2,2] row_mask:0xf bank_mask:0xf
    v_mfma_f32_16x16x32_bf16 v[24:27], a[196:199], v[12:15], v[24:27]
    v_add_f32_dpp v28, v29, v28 quad_perm:[1,1,1,1] row_mask:0xf bank_mask:0xf
    v_add_f32_dpp v30, v31, v30 quad_perm:[3,3,3,3] row_mask:0xf bank_mask:0xf
    v_mfma_f32_16x16x32_bf16 v[24:27], a[200:203], v[16:19], v[24:27]
    v_add_f32 v28, v28, v30
    v_mfma_f32_16x16x32_bf16 v[24:27], a[204:207], v[20:23], v[24:27]
    v_cndmask_b32_e64 v38, v38, v28, s[72:73]
    v_mfma_f32_16x16x32_bf16 v[28:31], a[208:211], v[8:11], 0
    v_mov_b32_dpp v32, v32 quad_perm:[0,0,0,0] row_mask:0xf bank_mask:0xf
    v_mov_b32_dpp v34, v34 quad_perm:[2,2,2,2] row_mask:0xf bank_mask:0xf
    v_mfma_f32_16x16x32_bf16 v[28:31], a[212:215], v[12:15], v[28:31]
    v_add_f32_dpp v32, v33, v32 quad_perm:[1,1,1,1] row_mask:0xf bank_mask:0xf
    v_add_f32_dpp v34, v35, v34 quad_perm:[3,3,3,3] row_mask:0xf bank_mask:0xf
    v_mfma_f32_16x16x32_bf16 v[28:31], a[216:219], v[16:19], v[28:31]
    v_add_f32 v32, v32, v34
    v_mfma_f32_16x16x32_bf16 v[28:31], a[220:223], v[20:23], v[28:31]
    v_cndmask_b32_e64 v38, v38, v32, s[74:75]
    s_waitcnt vmcnt(8)
    s_add_u32 s5, s4, 21
    s_and_b32 s5, s5, 63
    s_lshl_b32 s5, s5, 12
    buffer_load_dwordx4 a[12:15], v1, s[8:11], s5 offen nt
    s_waitcnt vmcnt(8)
    s_add_u32 s5, s4, 46
    s_and_b32 s5, s5, 63
    s_lshl_b32 s5, s5, 12
    buffer_load_dwordx4 a[112:115], v1, s[8:11], s5 offen nt
    v_mfma_f32_16x16x32_bf16 v[32:35], a[224:227], v[8:11], 0
    v_mov_b32_dpp v24, v24 quad_perm:[0,0,0,0] row_mask:0xf bank_mask:0xf
    v_mov_b32_dpp v26, v26 quad_perm:[2,2,2,2] row_mask:0xf bank_mask:0xf
    v_mfma_f32_16x16x32_bf16 v[32:35], a[228:231], v[12:15], v[32:35]
    v_add_f32_dpp v24, v25, v24 quad_perm:[1,1,1,1] row_mask:0xf bank_mask:0xf
    v_add_f32_dpp v26, v27, v26 quad_perm:[3,3,3,3] row_mask:0xf bank_mask:0xf
    v_mfma_f32_16x16x32_bf16 v[32:35], a[232:235], v[16:19], v[32:35]
    v_add_f32 v24, v24, v26
    v_mfma_f32_16x16x32_bf16 v[32:35], a[236:239], v[20:23], v[32:35]
    v_cndmask_b32_e64 v39, v39, v24, s[68:69]
    v_mfma_f32_16x16x32_bf16 v[24:27], a[240:243], v[8:11], 0
    v_mov_b32_dpp v28, v28 quad_perm:[0,0,0,0] row_mask:0xf bank_mask:0xf
    v_mov_b32_dpp v30, v30 quad_perm:[2,2,2,2] row_mask:0xf bank_mask:0xf
    v_mfma_f32_16x16x32_bf16 v[24:27], a[244:247], v[12:15], v[24:27]
    v_add_f32_dpp v28, v29, v28 quad_perm:[1,1,1,1] row_mask:0xf bank_mask:0xf
    v_add_f32_dpp v30, v31, v30 quad_perm:[3,3,3,3] row_mask:0xf bank_mask:0xf
    v_mfma_f32_16x16x32_bf16 v[24:27], a[248:251], v[16:19], v[24:27]
    v_add_f32 v28, v28, v30
    v_mfma_f32_16x16x32_bf16 v[24:27], a[252:255], v[20:23], v[24:27]
    v_cndmask_b32_e64 v39, v39, v28, s[70:71]
    s_waitcnt vmcnt(8)
    s_add_u32 s5, s4, 47
    s_and_b32 s5, s5, 63
    s_lshl_b32 s5, s5, 12
    buffer_load_dwordx4 a[116:119], v1, s[8:11], s5 offen nt
    s_waitcnt vmcnt(8)
    s_add_u32 s5, s4, 48
    s_and_b32 s5, s5, 63
    s_lshl_b32 s5, s5, 12
    buffer_load_dwordx4 a[120:123], v1, s[8:11], s5 offen nt
    v_mov_b32_dpp v32, v32 quad_perm:[0,0,0,0] row_mask:0xf bank_mask:0xf
    v_mov_b32_dpp v34, v34 quad_perm:[2,2,2,2] row_mask:0xf bank_mask:0xf
    s_nop 0
    v_add_f32_dpp v32, v33, v32 quad_perm:[1,1,1,1] row_mask:0xf bank_mask:0xf
    v_add_f32_dpp v34, v35, v34 quad_perm:[3,3,3,3] row_mask:0xf bank_mask:0xf
    v_add_f32 v32, v32, v34
    v_cndmask_b32_e64 v39, v39, v32, s[72:73]
    v_mov_b32_dpp v24, v24 quad_perm:[0,0,0,0] row_mask:0xf bank_mask:0xf
    v_mov_b32_dpp v26, v26 quad_perm:[2,2,2,2] row_mask:0xf bank_mask:0xf
    s_nop 0
    v_add_f32_dpp v24, v25, v24 quad_perm:[1,1,1,1] row_mask:0xf bank_mask:0xf
    v_add_f32_dpp v26, v27, v26 quad_perm:[3,3,3,3] row_mask:0xf bank_mask:0xf
    v_add_f32 v24, v24, v26
    v_cndmask_b32_e64 v39, v39, v24, s[74:75]
    v_max3_f32 v16, v36, v37, v38
    v_max_f32 v16, v16, v39
    v_mov_b32 v24, 0
    v_mov_b32 v25, 0
    v_max_f32_dpp v16, v16, v16 quad_perm:[1,0,3,2] row_mask:0xf bank_mask:0xf
    v_mov_b32 v26, 0
    v_mov_b32 v27, 0
    v_max_f32_dpp v16, v16, v16 quad_perm:[2,3,0,1] row_mask:0xf bank_mask:0xf
    v_mov_b32 v28, 0
    v_mov_b32 v29, 0
    v_max_f32_dpp v16, v16, v16 row_half_mirror row_mask:0xf bank_mask:0xf
    v_mov_b32 v30, 0
    v_mov_b32 v31, 0
    v_max_f32_dpp v16, v16, v16 row_mirror row_mask:0xf bank_mask:0xf
    v_mov_b32 v17, 0x3e0293ee
    s_nop 0
    v_max_f32_dpp v16, v16, v16 row_bcast:15 row_mask:0xa bank_mask:0xf
    s_nop 1
    v_max_f32_dpp v16, v16, v16 row_bcast:31 row_mask:0xc bank_mask:0xf
    v_mul_f32 v16, 0x3e0293ee, v16
    s_nop 0
    v_readlane_b32 s61, v16, 63
    s_nop 1
    v_fma_f32 v36, v36, v17, -s61
    v_fma_f32 v37, v37, v17, -s61
    v_fma_f32 v38, v38, v17, -s61
    v_fma_f32 v39, v39, v17, -s61
    v_exp_f32 v36, v36
    v_exp_f32 v37, v37
    v_exp_f32 v38, v38
    v_exp_f32 v39, v39
    v_cvt_pk_bf16_f32 v8, v36, v36
    v_cvt_pk_bf16_f32 v9, v36, v36
    v_cvt_pk_bf16_f32 v10, v37, v37
    v_cvt_pk_bf16_f32 v11, v37, v37
    v_cvt_pk_bf16_f32 v12, v38, v38
    v_cvt_pk_bf16_f32 v13, v38, v38
    v_cvt_pk_bf16_f32 v14, v39, v39
    v_cvt_pk_bf16_f32 v15, v39, v39
    v_mov_b32_dpp v8, v8 row_shr:4 row_mask:0xf bank_mask:0xa
    v_mov_b32_dpp v9, v9 row_shl:4 row_mask:0xf bank_mask:0x5
    v_mov_b32_dpp v10, v10 row_shr:4 row_mask:0xf bank_mask:0xa
    v_mov_b32_dpp v11, v11 row_shl:4 row_mask:0xf bank_mask:0x5
    v_mov_b32_dpp v12, v12 row_shr:4 row_mask:0xf bank_mask:0xa
    v_mov_b32_dpp v13, v13 row_shl:4 row_mask:0xf bank_mask:0x5
    v_mov_b32_dpp v14, v14 row_shr:4 row_mask:0xf bank_mask:0xa
    v_mov_b32_dpp v15, v15 row_shl:4 row_mask:0xf bank_mask:0x5
    v_add_f32 v7, v36, v37
    v_add_f32 v38, v38, v39
    v_permlane32_swap_b32 v8, v9
    v_permlane32_swap_b32 v10, v11
    v_permlane32_swap_b32 v12, v13
    v_permlane32_swap_b32 v14, v15
    v_add_f32 v7, v7, v38
    ds_read_b128 v[32:35], v3 offset:0
    ds_read_b128 v[36:39], v3 offset:1024
    v_and_b32_dpp v16, v8, v4 quad_perm:[0,0,0,0] row_mask:0xf bank_mask:0xf
    v_and_b32_dpp v17, v8, v5 quad_perm:[0,0,0,0] row_mask:0xf bank_mask:0xf
    v_and_b32_dpp v18, v9, v4 quad_perm:[0,0,0,0] row_mask:0xf bank_mask:0xf
    v_and_b32_dpp v19, v9, v5 quad_perm:[0,0,0,0] row_mask:0xf bank_mask:0xf
    v_and_b32_dpp v20, v8, v4 quad_perm:[1,1,1,1] row_mask:0xf bank_mask:0xf
    v_and_b32_dpp v21, v8, v5 quad_perm:[1,1,1,1] row_mask:0xf bank_mask:0xf
    s_waitcnt lgkmcnt(0)
    v_smfmac_f32_16x16x64_bf16 v[24:27], v[16:19], v[32:39], v6
    ds_read_b128 v[32:35], v3 offset:2048
    ds_read_b128 v[36:39], v3 offset:3072
    v_and_b32_dpp v22, v9, v4 quad_perm:[1,1,1,1] row_mask:0xf bank_mask:0xf
    v_and_b32_dpp v23, v9, v5 quad_perm:[1,1,1,1] row_mask:0xf bank_mask:0xf
    s_waitcnt lgkmcnt(0)
    v_smfmac_f32_16x16x64_bf16 v[28:31], v[16:19], v[32:39], v6
    ds_read_b128 v[32:35], v3 offset:4096
    ds_read_b128 v[36:39], v3 offset:5120
    v_add_f32_dpp v7, v7, v7 quad_perm:[1,0,3,2] row_mask:0xf bank_mask:0xf
    s_waitcnt vmcnt(8)
    s_add_u32 s5, s4, 22
    s_and_b32 s5, s5, 63
    s_lshl_b32 s5, s5, 12
    buffer_load_dwordx4 a[16:19], v1, s[8:11], s5 offen nt
    s_waitcnt vmcnt(8)
    s_add_u32 s5, s4, 49
    s_and_b32 s5, s5, 63
    s_lshl_b32 s5, s5, 12
    buffer_load_dwordx4 a[124:127], v1, s[8:11], s5 offen nt
    v_and_b32_dpp v16, v8, v4 quad_perm:[2,2,2,2] row_mask:0xf bank_mask:0xf
    v_and_b32_dpp v17, v8, v5 quad_perm:[2,2,2,2] row_mask:0xf bank_mask:0xf
    s_waitcnt lgkmcnt(0)
    v_smfmac_f32_16x16x64_bf16 v[24:27], v[20:23], v[32:39], v6
    ds_read_b128 v[32:35], v3 offset:6144
    ds_read_b128 v[36:39], v3 offset:7168
    v_and_b32_dpp v18, v9, v4 quad_perm:[2,2,2,2] row_mask:0xf bank_mask:0xf
    v_and_b32_dpp v19, v9, v5 quad_perm:[2,2,2,2] row_mask:0xf bank_mask:0xf
    s_waitcnt lgkmcnt(0)
    v_smfmac_f32_16x16x64_bf16 v[28:31], v[20:23], v[32:39], v6
    ds_read_b128 v[32:35], v3 offset:8192
    ds_read_b128 v[36:39], v3 offset:9216
    v_add_f32_dpp v7, v7, v7 quad_perm:[2,3,0,1] row_mask:0xf bank_mask:0xf
    v_and_b32_dpp v20, v8, v4 quad_perm:[3,3,3,3] row_mask:0xf bank_mask:0xf
    v_and_b32_dpp v21, v8, v5 quad_perm:[3,3,3,3] row_mask:0xf bank_mask:0xf
    s_waitcnt lgkmcnt(0)
    v_smfmac_f32_16x16x64_bf16 v[24:27], v[16:19], v[32:39], v6
    ds_read_b128 v[32:35], v3 offset:10240
    ds_read_b128 v[36:39], v3 offset:11264
    v_and_b32_dpp v22, v9, v4 quad_perm:[3,3,3,3] row_mask:0xf bank_mask:0xf
    v_and_b32_dpp v23, v9, v5 quad_perm:[3,3,3,3] row_mask:0xf bank_mask:0xf
    s_waitcnt lgkmcnt(0)
    v_smfmac_f32_16x16x64_bf16 v[28:31], v[16:19], v[32:39], v6
    ds_read_b128 v[32:35], v3 offset:12288
    ds_read_b128 v[36:39], v3 offset:13312
    v_add_f32_dpp v7, v7, v7 row_half_mirror row_mask:0xf bank_mask:0xf
    s_waitcnt vmcnt(8)
    s_add_u32 s5, s4, 50
    s_and_b32 s5, s5, 63
    s_lshl_b32 s5, s5, 12
    buffer_load_dwordx4 a[128:131], v1, s[8:11], s5 offen nt
    s_waitcnt vmcnt(8)
    s_add_u32 s5, s4, 51
    s_and_b32 s5, s5, 63
    s_lshl_b32 s5, s5, 12
    buffer_load_dwordx4 a[132:135], v1, s[8:11], s5 offen nt
    v_and_b32_dpp v16, v10, v4 quad_perm:[0,0,0,0] row_mask:0xf bank_mask:0xf
    v_and_b32_dpp v17, v10, v5 quad_perm:[0,0,0,0] row_mask:0xf bank_mask:0xf
    s_waitcnt lgkmcnt(0)
    v_smfmac_f32_16x16x64_bf16 v[24:27], v[20:23], v[32:39], v6
    ds_read_b128 v[32:35], v3 offset:14336
    ds_read_b128 v[36:39], v3 offset:15360
    v_and_b32_dpp v18, v11, v4 quad_perm:[0,0,0,0] row_mask:0xf bank_mask:0xf
    v_and_b32_dpp v19, v11, v5 quad_perm:[0,0,0,0] row_mask:0xf bank_mask:0xf
    s_waitcnt lgkmcnt(0)
    v_smfmac_f32_16x16x64_bf16 v[28:31], v[20:23], v[32:39], v6
    ds_read_b128 v[32:35], v3 offset:16384
    ds_read_b128 v[36:39], v3 offset:17408
    v_add_f32_dpp v7, v7, v7 row_mirror row_mask:0xf bank_mask:0xf
    v_and_b32_dpp v20, v10, v4 quad_perm:[1,1,1,1] row_mask:0xf bank_mask:0xf
    v_and_b32_dpp v21, v10, v5 quad_perm:[1,1,1,1] row_mask:0xf bank_mask:0xf
    s_waitcnt lgkmcnt(0)
    v_smfmac_f32_16x16x64_bf16 v[24:27], v[16:19], v[32:39], v6
    ds_read_b128 v[32:35], v3 offset:18432
    ds_read_b128 v[36:39], v3 offset:19456
    v_and_b32_dpp v22, v11, v4 quad_perm:[1,1,1,1] row_mask:0xf bank_mask:0xf
    v_and_b32_dpp v23, v11, v5 quad_perm:[1,1,1,1] row_mask:0xf bank_mask:0xf
    s_waitcnt lgkmcnt(0)
    v_smfmac_f32_16x16x64_bf16 v[28:31], v[16:19], v[32:39], v6
    v_add_f32_dpp v7, v7, v7 row_bcast:15 row_mask:0xa bank_mask:0xf
    s_waitcnt vmcnt(8)
    s_add_u32 s5, s4, 23
    s_and_b32 s5, s5, 63
    s_lshl_b32 s5, s5, 12
    buffer_load_dwordx4 a[20:23], v1, s[8:11], s5 offen nt
    s_waitcnt vmcnt(8)
    s_add_u32 s5, s4, 52
    s_and_b32 s5, s5, 63
    s_lshl_b32 s5, s5, 12
    buffer_load_dwordx4 a[136:139], v1, s[8:11], s5 offen nt
    v_and_b32_dpp v16, v10, v4 quad_perm:[2,2,2,2] row_mask:0xf bank_mask:0xf
    v_and_b32_dpp v17, v10, v5 quad_perm:[2,2,2,2] row_mask:0xf bank_mask:0xf
    v_smfmac_f32_16x16x64_bf16 v[24:27], v[20:23], v[80:87], v6
    v_and_b32_dpp v18, v11, v4 quad_perm:[2,2,2,2] row_mask:0xf bank_mask:0xf
    v_and_b32_dpp v19, v11, v5 quad_perm:[2,2,2,2] row_mask:0xf bank_mask:0xf
    v_smfmac_f32_16x16x64_bf16 v[28:31], v[20:23], v[88:95], v6
    v_add_f32_dpp v7, v7, v7 row_bcast:31 row_mask:0xc bank_mask:0xf
    v_and_b32_dpp v20, v10, v4 quad_perm:[3,3,3,3] row_mask:0xf bank_mask:0xf
    v_and_b32_dpp v21, v10, v5 quad_perm:[3,3,3,3] row_mask:0xf bank_mask:0xf
    v_smfmac_f32_16x16x64_bf16 v[24:27], v[16:19], v[96:103], v6
    v_and_b32_dpp v22, v11, v4 quad_perm:[3,3,3,3] row_mask:0xf bank_mask:0xf
    v_and_b32_dpp v23, v11, v5 quad_perm:[3,3,3,3] row_mask:0xf bank_mask:0xf
    v_smfmac_f32_16x16x64_bf16 v[28:31], v[16:19], v[104:111], v6
    v_readlane_b32 s62, v7, 63
    v_and_b32_dpp v16, v12, v4 quad_perm:[0,0,0,0] row_mask:0xf bank_mask:0xf
    v_and_b32_dpp v17, v12, v5 quad_perm:[0,0,0,0] row_mask:0xf bank_mask:0xf
    v_smfmac_f32_16x16x64_bf16 v[24:27], v[20:23], v[112:119], v6
    v_and_b32_dpp v18, v13, v4 quad_perm:[0,0,0,0] row_mask:0xf bank_mask:0xf
    v_and_b32_dpp v19, v13, v5 quad_perm:[0,0,0,0] row_mask:0xf bank_mask:0xf
    v_smfmac_f32_16x16x64_bf16 v[28:31], v[20:23], v[120:127], v6
    s_add_u32 s48, s90, 1
    s_and_b32 s48, s48, 0xff
    s_add_u32 s49, s90, 54
    s_waitcnt vmcnt(8)
    s_add_u32 s5, s4, 53
    s_and_b32 s5, s5, 63
    s_lshl_b32 s5, s5, 12
    buffer_load_dwordx4 a[140:143], v1, s[8:11], s5 offen nt
    s_waitcnt vmcnt(8)
    s_add_u32 s5, s4, 54
    s_and_b32 s5, s5, 63
    s_lshl_b32 s5, s5, 12
    buffer_load_dwordx4 a[144:147], v1, s[8:11], s5 offen nt
    v_and_b32_dpp v20, v12, v4 quad_perm:[1,1,1,1] row_mask:0xf bank_mask:0xf
    v_and_b32_dpp v21, v12, v5 quad_perm:[1,1,1,1] row_mask:0xf bank_mask:0xf
    v_smfmac_f32_16x16x64_bf16 v[24:27], v[16:19], v[128:135], v6
    v_and_b32_dpp v22, v13, v4 quad_perm:[1,1,1,1] row_mask:0xf bank_mask:0xf
    v_and_b32_dpp v23, v13, v5 quad_perm:[1,1,1,1] row_mask:0xf bank_mask:0xf
    v_smfmac_f32_16x16x64_bf16 v[28:31], v[16:19], v[136:143], v6
    s_and_b32 s49, s49, 0xff
    s_add_u32 s50, s90, 107
    s_and_b32 s50, s50, 0xff
    v_and_b32_dpp v16, v12, v4 quad_perm:[2,2,2,2] row_mask:0xf bank_mask:0xf
    v_and_b32_dpp v17, v12, v5 quad_perm:[2,2,2,2] row_mask:0xf bank_mask:0xf
    v_smfmac_f32_16x16x64_bf16 v[24:27], v[20:23], v[144:151], v6
    v_and_b32_dpp v18, v13, v4 quad_perm:[2,2,2,2] row_mask:0xf bank_mask:0xf
    v_and_b32_dpp v19, v13, v5 quad_perm:[2,2,2,2] row_mask:0xf bank_mask:0xf
    v_smfmac_f32_16x16x64_bf16 v[28:31], v[20:23], v[152:159], v6
    s_add_u32 s51, s90, 160
    s_and_b32 s51, s51, 0xff
    s_add_u32 s59, s24, 163840
    s_waitcnt vmcnt(8)
    s_add_u32 s5, s4, 24
    s_and_b32 s5, s5, 63
    s_lshl_b32 s5, s5, 12
    buffer_load_dwordx4 a[24:27], v1, s[8:11], s5 offen nt
    s_waitcnt vmcnt(8)
    s_add_u32 s5, s4, 55
    s_and_b32 s5, s5, 63
    s_lshl_b32 s5, s5, 12
    buffer_load_dwordx4 a[148:151], v1, s[8:11], s5 offen nt
    v_and_b32_dpp v20, v12, v4 quad_perm:[3,3,3,3] row_mask:0xf bank_mask:0xf
    v_and_b32_dpp v21, v12, v5 quad_perm:[3,3,3,3] row_mask:0xf bank_mask:0xf
    v_smfmac_f32_16x16x64_bf16 v[24:27], v[16:19], v[160:167], v6
    v_and_b32_dpp v22, v13, v4 quad_perm:[3,3,3,3] row_mask:0xf bank_mask:0xf
    v_and_b32_dpp v23, v13, v5 quad_perm:[3,3,3,3] row_mask:0xf bank_mask:0xf
    v_smfmac_f32_16x16x64_bf16 v[28:31], v[16:19], v[168:175], v6
    s_add_u32 s60, s25, 163840
    v_add3_u32 v35, v43, s90, 1
    v_mov_b32 v38, s61
    v_and_b32_dpp v16, v14, v4 quad_perm:[0,0,0,0] row_mask:0xf bank_mask:0xf
    v_and_b32_dpp v17, v14, v5 quad_perm:[0,0,0,0] row_mask:0xf bank_mask:0xf
    v_smfmac_f32_16x16x64_bf16 v[24:27], v[20:23], v[176:183], v6
    v_and_b32_dpp v18, v15, v4 quad_perm:[0,0,0,0] row_mask:0xf bank_mask:0xf
    v_and_b32_dpp v19, v15, v5 quad_perm:[0,0,0,0] row_mask:0xf bank_mask:0xf
    v_smfmac_f32_16x16x64_bf16 v[28:31], v[20:23], v[184:191], v6
    v_mov_b32 v39, s62
    v_lshlrev_b32_e64 v7, 3, s3
    s_mov_b64 exec, 1
    ds_write_b64 v7, v[38:39] offset:2048
    s_mov_b64 exec, -1
    s_waitcnt vmcnt(8)
    s_add_u32 s5, s4, 56
    s_and_b32 s5, s5, 63
    s_lshl_b32 s5, s5, 12
    buffer_load_dwordx4 a[152:155], v1, s[8:11], s5 offen nt
    s_waitcnt vmcnt(8)
    s_add_u32 s5, s4, 57
    s_and_b32 s5, s5, 63
    s_lshl_b32 s5, s5, 12
    buffer_load_dwordx4 a[156:159], v1, s[8:11], s5 offen nt
    v_and_b32_dpp v20, v14, v4 quad_perm:[1,1,1,1] row_mask:0xf bank_mask:0xf
    v_and_b32_dpp v21, v14, v5 quad_perm:[1,1,1,1] row_mask:0xf bank_mask:0xf
    v_smfmac_f32_16x16x64_bf16 v[24:27], v[16:19], v[192:199], v6
    v_and_b32_dpp v22, v15, v4 quad_perm:[1,1,1,1] row_mask:0xf bank_mask:0xf
    v_and_b32_dpp v23, v15, v5 quad_perm:[1,1,1,1] row_mask:0xf bank_mask:0xf
    v_smfmac_f32_16x16x64_bf16 v[28:31], v[16:19], v[200:207], v6
    v_mov_b32 v7, 0
    s_add_u32 s28, s90, 1
    s_and_b32 s28, s28, 0xff
    v_and_b32_dpp v16, v14, v4 quad_perm:[2,2,2,2] row_mask:0xf bank_mask:0xf
    v_and_b32_dpp v17, v14, v5 quad_perm:[2,2,2,2] row_mask:0xf bank_mask:0xf
    v_smfmac_f32_16x16x64_bf16 v[24:27], v[20:23], v[208:215], v6
    v_and_b32_dpp v18, v15, v4 quad_perm:[2,2,2,2] row_mask:0xf bank_mask:0xf
    v_and_b32_dpp v19, v15, v5 quad_perm:[2,2,2,2] row_mask:0xf bank_mask:0xf
    v_smfmac_f32_16x16x64_bf16 v[28:31], v[20:23], v[216:223], v6
    s_add_u32 s29, s90, 54
    s_and_b32 s29, s29, 0xff
    s_add_u32 s30, s90, 107
    s_waitcnt vmcnt(8)
    s_add_u32 s5, s4, 25
    s_and_b32 s5, s5, 63
    s_lshl_b32 s5, s5, 12
    buffer_load_dwordx4 a[28:31], v1, s[8:11], s5 offen nt
    s_waitcnt vmcnt(8)
    s_add_u32 s5, s4, 58
    s_and_b32 s5, s5, 63
    s_lshl_b32 s5, s5, 12
    buffer_load_dwordx4 a[160:163], v1, s[8:11], s5 offen nt
    v_and_b32_dpp v20, v14, v4 quad_perm:[3,3,3,3] row_mask:0xf bank_mask:0xf
    v_and_b32_dpp v21, v14, v5 quad_perm:[3,3,3,3] row_mask:0xf bank_mask:0xf
    v_smfmac_f32_16x16x64_bf16 v[24:27], v[16:19], v[224:231], v6
    v_and_b32_dpp v22, v15, v4 quad_perm:[3,3,3,3] row_mask:0xf bank_mask:0xf
    v_and_b32_dpp v23, v15, v5 quad_perm:[3,3,3,3] row_mask:0xf bank_mask:0xf
    v_smfmac_f32_16x16x64_bf16 v[28:31], v[16:19], v[232:239], v6
    s_and_b32 s30, s30, 0xff
    s_add_u32 s31, s90, 160
    s_and_b32 s31, s31, 0xff
    v_smfmac_f32_16x16x64_bf16 v[24:27], v[20:23], v[240:247], v6
    v_smfmac_f32_16x16x64_bf16 v[28:31], v[20:23], v[248:255], v6
    s_nop 7
    v_cndmask_b32_e64 v24, v24, v28, s[64:65]
    v_cndmask_b32_e64 v25, v25, v29, s[64:65]
    v_cndmask_b32_e64 v26, v26, v30, s[64:65]
    v_cndmask_b32_e64 v27, v27, v31, s[64:65]
    s_nop 0
    v_permlane32_swap_b32 v24, v26
    v_permlane32_swap_b32 v25, v27
    v_add_f32 v24, v24, v26
    v_add_f32 v25, v25, v27
    ds_write_b64 v40, v[24:25] offset:0
    s_waitcnt vmcnt(8)
    s_add_u32 s5, s4, 59
    s_and_b32 s5, s5, 63
    s_lshl_b32 s5, s5, 12
    buffer_load_dwordx4 a[164:167], v1, s[8:11], s5 offen nt
    s_waitcnt vmcnt(8)
    s_add_u32 s5, s4, 60
    s_and_b32 s5, s5, 63
    s_lshl_b32 s5, s5, 12
    buffer_load_dwordx4 a[168:171], v1, s[8:11], s5 offen nt
    s_waitcnt lgkmcnt(0)
    s_barrier
    ds_read_b128 v[8:11], v7 offset:2048
    ds_read_b128 v[12:15], v7 offset:2064
    ds_read_b32 v16, v41 offset:0
    ds_read_b32 v17, v41 offset:512
    ds_read_b32 v18, v41 offset:1024
    ds_read_b32 v19, v41 offset:1536
    s_waitcnt lgkmcnt(4)
    v_max3_f32 v22, v8, v10, v12
    v_max_f32 v22, v22, v14
    v_sub_f32 v8, v8, v22
    v_sub_f32 v10, v10, v22
    v_sub_f32 v12, v12, v22
    v_sub_f32 v14, v14, v22
    v_exp_f32 v8, v8
    v_exp_f32 v10, v10
    v_exp_f32 v12, v12
    v_exp_f32 v14, v14
    v_lshlrev_b32 v21, 8, v22
    v_cndmask_b32_e64 v22, v22, v21, s[72:73]
    s_waitcnt lgkmcnt(0)
    v_cndmask_b32_e64 v16, v16, v9, s[64:65]
    v_cndmask_b32_e64 v17, v17, v11, s[64:65]
    v_cndmask_b32_e64 v18, v18, v13, s[64:65]
    v_cndmask_b32_e64 v19, v19, v15, s[64:65]
    v_mul_f32 v23, v8, v16
    v_fmac_f32 v23, v10, v17
    v_fmac_f32 v23, v12, v18
    v_fmac_f32 v23, v14, v19
    v_cndmask_b32_e64 v23, v23, v22, s[66:67]
    v_bfi_b32 v23, s87, v35, v23
    s_mov_b32 exec_hi, s56
    s_cmp_eq_u32 s53, 0
    s_cbranch_scc1 L_slow_114
    buffer_store_dword v23, v42, s[16:19], s59 offen
L_pub_115:
    s_mov_b32 exec_hi, -1
    ds_read_b128 a[184:187], v3 offset:20480
    s_waitcnt vmcnt(9)
    s_add_u32 s5, s4, 26
    s_and_b32 s5, s5, 63
    s_lshl_b32 s5, s5, 12
    buffer_load_dwordx4 a[32:35], v1, s[8:11], s5 offen nt
    s_waitcnt vmcnt(9)
    s_add_u32 s5, s4, 61
    s_and_b32 s5, s5, 63
    s_lshl_b32 s5, s5, 12
    buffer_load_dwordx4 a[172:175], v1, s[8:11], s5 offen nt
    ds_read_b128 a[188:191], v3 offset:21504
    ds_read_b128 a[192:195], v3 offset:22528
    ds_read_b128 a[196:199], v3 offset:23552
    ds_read_b128 a[200:203], v3 offset:24576
    ds_read_b128 a[204:207], v3 offset:25600
    ds_read_b128 a[208:211], v3 offset:26624
    ds_read_b128 a[212:215], v3 offset:27648
    ds_read_b128 a[216:219], v3 offset:28672
    ds_read_b128 a[220:223], v3 offset:29696
    ds_read_b128 a[224:227], v3 offset:30720
    ds_read_b128 a[228:231], v3 offset:31744
    ds_read_b128 a[232:235], v3 offset:32768
    ds_read_b128 a[236:239], v3 offset:33792
    ds_read_b128 a[240:243], v3 offset:34816
    ds_read_b128 a[244:247], v3 offset:35840
    ds_read_b128 a[248:251], v3 offset:36864
    ds_read_b128 a[252:255], v3 offset:37888
    s_waitcnt lgkmcnt(0)
    s_cmp_lg_u32 s1, 0
    s_cbranch_scc1 L_odd_116
    s_waitcnt lgkmcnt(0)
    s_barrier
    s_branch L_join_117
L_retry_67:
    s_mov_b32 s57, 524288
L_rloop_68:
    s_mov_b64 exec, vcc
    buffer_load_dwordx4 v[8:11], v44, s[16:19], s27 offen offset:0 sc1
    buffer_load_dwordx4 v[12:15], v44, s[16:19], s27 offen offset:16 sc1
    s_waitcnt vmcnt(1)
    v_xor_b32 v8, s28, v8
    v_xor_b32 v9, s29, v9
    v_xor_b32 v10, s30, v10
    v_xor_b32 v11, s31, v11
    v_or3_b32 v25, v8, v9, v10
    v_or_b32 v25, v25, v11
    s_waitcnt vmcnt(0)
    v_xor_b32 v12, s28, v12
    v_xor_b32 v13, s29, v13
    v_xor_b32 v14, s30, v14
    v_xor_b32 v15, s31, v15
    v_or3_b32 v25, v25, v12, v13
    v_or3_b32 v25, v25, v14, v15
    v_and_b32 v25, 0xff, v25
    v_cmp_ne_u32 vcc, 0, v25
    s_cbranch_vccz L_rdone_69
    s_sub_u32 s57, s57, 1
    s_cmp_lg_u32 s57, 0
    s_cbranch_scc1 L_rloop_68
L_rdone_69:
    s_mov_b64 exec, -1
    s_branch L_ok_70
L_slow_80:
    buffer_store_dword v23, v42, s[16:19], s59 offen sc1
    s_branch L_pub_81
L_retry_82:
    s_mov_b32 s57, 524288
L_rloop_83:
    s_mov_b64 exec, vcc
    buffer_load_dwordx4 v[24:27], v46, s[16:19], s60 offen offset:512 sc1
    buffer_load_dwordx4 v[8:11], v45, s[16:19], s60 offen offset:0 sc1
    buffer_load_dwordx4 v[12:15], v45, s[16:19], s60 offen offset:1280 sc1
    buffer_load_dwordx4 v[16:19], v45, s[16:19], s60 offen offset:2560 sc1
    buffer_load_dwordx4 v[20:23], v45, s[16:19], s60 offen offset:3840 sc1
    s_waitcnt vmcnt(4)
    v_xor_b32 v24, s48, v24
    v_xor_b32 v25, s49, v25
    v_xor_b32 v26, s50, v26
    v_xor_b32 v27, s51, v27
    v_or3_b32 v28, v24, v25, v26
    v_or_b32 v28, v28, v27
    s_waitcnt vmcnt(3)
    v_xor_b32 v8, s48, v8
    v_xor_b32 v9, s49, v9
    v_xor_b32 v10, s50, v10
    v_xor_b32 v11, s51, v11
    v_or3_b32 v28, v28, v8, v9
    v_or3_b32 v28, v28, v10, v11
    s_waitcnt vmcnt(2)
    v_xor_b32 v12, s48, v12
    v_xor_b32 v13, s49, v13
    v_xor_b32 v14, s50, v14
    v_xor_b32 v15, s51, v15
    v_or3_b32 v28, v28, v12, v13
    v_or3_b32 v28, v28, v14, v15
    s_waitcnt vmcnt(1)
    v_xor_b32 v16, s48, v16
    v_xor_b32 v17, s49, v17
    v_xor_b32 v18, s50, v18
    v_xor_b32 v19, s51, v19
    v_or3_b32 v28, v28, v16, v17
    v_or3_b32 v28, v28, v18, v19
    s_waitcnt vmcnt(0)
    v_xor_b32 v20, s48, v20
    v_xor_b32 v21, s49, v21
    v_xor_b32 v22, s50, v22
    v_xor_b32 v23, s51, v23
    v_or3_b32 v28, v28, v20, v21
    v_or3_b32 v28, v28, v22, v23
    v_and_b32 v28, 0xff, v28
    v_cmp_ne_u32 vcc, 0, v28
    s_cbranch_vccz L_rdone_84
    s_sub_u32 s57, s57, 1
    s_cmp_lg_u32 s57, 0
    s_cbranch_scc1 L_rloop_83
L_rdone_84:
    s_mov_b64 exec, -1
    s_branch L_ok_85
L_slow_87:
    buffer_store_dword v31, v34, s[16:19], s63 offen sc1
    s_branch L_pub_88
L_retry_89:
    s_mov_b32 s57, 524288
L_rloop_90:
    s_mov_b64 exec, vcc
    buffer_load_dword v33, off, s[16:19], s63 sc1
    s_waitcnt vmcnt(0)
    v_cmp_ne_u32 vcc, s59, v33
    s_cbranch_vccz L_rdone_91
    s_sub_u32 s57, s57, 1
    s_cmp_lg_u32 s57, 0
    s_cbranch_scc1 L_rloop_90
L_rdone_91:
    s_mov_b64 exec, -1
    s_branch L_ok_92
L_retry_93:
    s_mov_b32 s57, 524288
L_rloop_94:
    s_mov_b64 exec, vcc
    s_add_u32 s60, s61, 0
    buffer_load_dwordx4 v[8:11], v45, s[16:19], s60 offen sc1
    s_add_u32 s60, s61, 4096
    buffer_load_dwordx4 v[12:15], v45, s[16:19], s60 offen sc1
    s_add_u32 s60, s61, 8192
    buffer_load_dwordx4 v[16:19], v45, s[16:19], s60 offen sc1
    s_add_u32 s60, s61, 12288
    buffer_load_dwordx4 v[20:23], v45, s[16:19], s60 offen sc1
    s_waitcnt vmcnt(3)
    v_xor_b32 v8, s48, v8
    v_xor_b32 v9, s49, v9
    v_xor_b32 v10, s50, v10
    v_xor_b32 v11, s51, v11
    v_or3_b32 v33, v8, v9, v10
    v_or_b32 v33, v33, v11
    s_waitcnt vmcnt(2)
    v_xor_b32 v12, s48, v12
    v_xor_b32 v13, s49, v13
    v_xor_b32 v14, s50, v14
    v_xor_b32 v15, s51, v15
    v_or3_b32 v33, v33, v12, v13
    v_or3_b32 v33, v33, v14, v15
    s_waitcnt vmcnt(1)
    v_xor_b32 v16, s48, v16
    v_xor_b32 v17, s49, v17
    v_xor_b32 v18, s50, v18
    v_xor_b32 v19, s51, v19
    v_or3_b32 v33, v33, v16, v17
    v_or3_b32 v33, v33, v18, v19
    s_waitcnt vmcnt(0)
    v_xor_b32 v20, s48, v20
    v_xor_b32 v21, s49, v21
    v_xor_b32 v22, s50, v22
    v_xor_b32 v23, s51, v23
    v_or3_b32 v33, v33, v20, v21
    v_or3_b32 v33, v33, v22, v23
    v_and_b32 v33, 0xff, v33
    v_cmp_ne_u32 vcc, 0, v33
    s_cbranch_vccz L_rdone_95
    s_sub_u32 s57, s57, 1
    s_cmp_lg_u32 s57, 0
    s_cbranch_scc1 L_rloop_94
L_rdone_95:
    s_mov_b64 exec, -1
    s_branch L_ok_96
L_tiny_97:
L_mx_99:
    s_cmp_eq_u64 s[48:49], 0
    s_cbranch_scc1 L_mxe_101
    s_ff1_i32_b64 s57, s[48:49]
    s_bitset0_b64 s[48:49], s57
    v_readlane_b32 s5, v36, s57
    s_nop 0
    s_lshl_b32 s5, s5, 16
    v_mov_b32 v8, s5
    v_lshlrev_b32 v9, 1, v0
    v_mov_b32 v12, 0
    s_mov_b32 s5, 0
L_mxf_100:
    buffer_load_ushort v13, v9, s[32:35], s5 offen
    buffer_load_ushort v14, v9, s[36:39], s5 offen
    buffer_load_ushort v15, v9, s[40:43], s5 offen
    s_waitcnt vmcnt(0)
    v_lshlrev_b32 v13, 16, v13
    v_lshlrev_b32 v14, 16, v14
    v_lshlrev_b32 v15, 16, v15
    v_fma_f32 v10, v8, v13, v14
    v_mul_f32 v11, v10, v10
    v_mul_f32 v11, 0xbdd2d3e8, v11
    v_add_f32 v11, 0xc0135761, v11
    v_mul_f32 v11, v10, v11
    v_exp_f32 v11, v11
    v_mul_f32 v10, v10, v15
    v_add_f32 v11, 1.0, v11
    v_rcp_f32 v11, v11
    s_add_u32 s5, s5, 128
    s_cmp_lt_u32 s5, 2752
    v_fmac_f32 v12, v10, v11
    s_cbranch_scc1 L_mxf_100
    s_nop 0
    v_add_f32_dpp v12, v12, v12 quad_perm:[1,0,3,2] row_mask:0xf bank_mask:0xf
    s_nop 1
    v_add_f32_dpp v12, v12, v12 quad_perm:[2,3,0,1] row_mask:0xf bank_mask:0xf
    s_nop 1
    v_add_f32_dpp v12, v12, v12 row_half_mirror row_mask:0xf bank_mask:0xf
    s_nop 1
    v_add_f32_dpp v12, v12, v12 row_mirror row_mask:0xf bank_mask:0xf
    s_nop 1
    v_add_f32_dpp v12, v12, v12 row_bcast:15 row_mask:0xa bank_mask:0xf
    s_nop 1
    v_add_f32_dpp v12, v12, v12 row_bcast:31 row_mask:0xc bank_mask:0xf
    v_add_f32 v12, s55, v12
    s_nop 0
    v_readlane_b32 s5, v12, 63
    s_mov_b32 m0, s57
    s_nop 3
    v_writelane_b32 v28, s5, m0
    s_branch L_mx_99
L_mxe_101:
L_mx_102:
    s_cmp_eq_u64 s[50:51], 0
    s_cbranch_scc1 L_mxe_104
    s_ff1_i32_b64 s57, s[50:51]
    s_bitset0_b64 s[50:51], s57
    v_readlane_b32 s5, v36, s57
    s_nop 0
    s_and_b32 s5, s5, 0xffff0000
    v_mov_b32 v8, s5
    v_lshlrev_b32 v9, 1, v0
    v_mov_b32 v12, 0
    s_mov_b32 s5, 0
L_mxf_103:
    buffer_load_ushort v13, v9, s[32:35], s5 offen
    buffer_load_ushort v14, v9, s[36:39], s5 offen
    buffer_load_ushort v15, v9, s[40:43], s5 offen
    s_waitcnt vmcnt(0)
    v_lshlrev_b32 v13, 16, v13
    v_lshlrev_b32 v14, 16, v14
    v_lshlrev_b32 v15, 16, v15
    v_fma_f32 v10, v8, v13, v14
    v_mul_f32 v11, v10, v10
    v_mul_f32 v11, 0xbdd2d3e8, v11
    v_add_f32 v11, 0xc0135761, v11
    v_mul_f32 v11, v10, v11
    v_exp_f32 v11, v11
    v_mul_f32 v10, v10, v15
    v_add_f32 v11, 1.0, v11
    v_rcp_f32 v11, v11
    s_add_u32 s5, s5, 128
    s_cmp_lt_u32 s5, 2752
    v_fmac_f32 v12, v10, v11
    s_cbranch_scc1 L_mxf_103
    s_nop 0
    v_add_f32_dpp v12, v12, v12 quad_perm:[1,0,3,2] row_mask:0xf bank_mask:0xf
    s_nop 1
    v_add_f32_dpp v12, v12, v12 quad_perm:[2,3,0,1] row_mask:0xf bank_mask:0xf
    s_nop 1
    v_add_f32_dpp v12, v12, v12 row_half_mirror row_mask:0xf bank_mask:0xf
    s_nop 1
    v_add_f32_dpp v12, v12, v12 row_mirror row_mask:0xf bank_mask:0xf
    s_nop 1
    v_add_f32_dpp v12, v12, v12 row_bcast:15 row_mask:0xa bank_mask:0xf
    s_nop 1
    v_add_f32_dpp v12, v12, v12 row_bcast:31 row_mask:0xc bank_mask:0xf
    v_add_f32 v12, s55, v12
    s_nop 0
    v_readlane_b32 s5, v12, 63
    s_mov_b32 m0, s57
    s_nop 3
    v_writelane_b32 v29, s5, m0
    s_branch L_mx_102
L_mxe_104:
    s_branch L_mixed_98
L_slow_106:
    buffer_store_dword v12, v41, s[16:19], s26 offen sc1
    s_branch L_pub_107
L_retry_110:
    s_mov_b32 s57, 524288
L_rloop_111:
    s_mov_b64 exec, vcc
    buffer_load_dwordx4 v[8:11], v44, s[16:19], s27 offen offset:0 sc1
    buffer_load_dwordx4 v[12:15], v44, s[16:19], s27 offen offset:16 sc1
    s_waitcnt vmcnt(1)
    v_xor_b32 v8, s28, v8
    v_xor_b32 v9, s29, v9
    v_xor_b32 v10, s30, v10
    v_xor_b32 v11, s31, v11
    v_or3_b32 v25, v8, v9, v10
    v_or_b32 v25, v25, v11
    s_waitcnt vmcnt(0)
    v_xor_b32 v12, s28, v12
    v_xor_b32 v13, s29, v13
    v_xor_b32 v14, s30, v14
    v_xor_b32 v15, s31, v15
    v_or3_b32 v25, v25, v12, v13
    v_or3_b32 v25, v25, v14, v15
    v_and_b32 v25, 0xff, v25
    v_cmp_ne_u32 vcc, 0, v25
    s_cbranch_vccz L_rdone_112
    s_sub_u32 s57, s57, 1
    s_cmp_lg_u32 s57, 0
    s_cbranch_scc1 L_rloop_111
L_rdone_112:
    s_mov_b64 exec, -1
    s_branch L_ok_113
L_slow_114:
    buffer_store_dword v23, v42, s[16:19], s59 offen sc1
    s_branch L_pub_115
.p2align 12
.fill 31, 4, 0xbf800000
L_phase_1:
L_odd_116:
    s_waitcnt lgkmcnt(0)
    s_barrier
L_join_117:
    s_getpc_b64 s[84:85]
L_pc2:
    s_lshl_b32 s59, s7, 2
    s_add_u32 s59, s59, s3
    s_lshl_b32 s59, s59, 8
    s_add_u32 s59, s59, L_tail-L_pc2
    v_lshl_add_u32 v28, v0, 7, s59
    v_min_u32 v28, L_code_end-L_pc2-4, v28
    v_mov_b32 v31, s85
    v_add_co_u32 v30, vcc, s84, v28
    s_nop 1
    v_addc_co_u32 v31, vcc, 0, v31, vcc
    s_mov_b64 exec, 3
    global_load_dword v28, v[30:31], off
    s_mov_b64 exec, -1
    s_add_u32 s60, s27, 65536
    buffer_load_dwordx4 v[8:11], v44, s[16:19], s60 offen offset:0 sc1
    buffer_load_dwordx4 v[12:15], v44, s[16:19], s60 offen offset:16 sc1
    s_waitcnt vmcnt(10)
    s_add_u32 s5, s4, 62
    s_and_b32 s5, s5, 63
    s_lshl_b32 s5, s5, 12
    buffer_load_dwordx4 a[176:179], v1, s[8:11], s5 offen nt
    s_waitcnt vmcnt(10)
    s_add_u32 s5, s4, 63
    s_and_b32 s5, s5, 63
    s_lshl_b32 s5, s5, 12
    buffer_load_dwordx4 a[180:183], v1, s[8:11], s5 offen nt
    s_waitcnt vmcnt(10)
    s_add_u32 s5, s4, 27
    s_and_b32 s5, s5, 63
    s_lshl_b32 s5, s5, 12
    buffer_load_dwordx4 a[36:39], v1, s[8:11], s5 offen nt
    s_waitcnt vmcnt(10)
    v_add_u32 v2, 0x4000000, v2
    s_add_u32 m0, s54, 0
    s_add_u32 s5, s4, 0
    s_and_b32 s5, s5, 63
    s_lshl_b32 s5, s5, 12
    buffer_load_dwordx4 v2, s[12:15], s5 offen nt lds
    s_waitcnt vmcnt(10)
    s_add_u32 m0, s54, 1024
    s_add_u32 s5, s4, 1
    s_and_b32 s5, s5, 63
    s_lshl_b32 s5, s5, 12
    buffer_load_dwordx4 v2, s[12:15], s5 offen nt lds
    s_waitcnt vmcnt(9)
    s_add_u32 m0, s54, 2048
    s_add_u32 s5, s4, 2
    s_and_b32 s5, s5, 63
    s_lshl_b32 s5, s5, 12
    buffer_load_dwordx4 v2, s[12:15], s5 offen nt lds
    s_waitcnt vmcnt(7)
    v_xor_b32 v8, s28, v8
    v_xor_b32 v9, s29, v9
    v_xor_b32 v10, s30, v10
    v_xor_b32 v11, s31, v11
    v_or3_b32 v25, v8, v9, v10
    v_or_b32 v25, v25, v11
    s_waitcnt vmcnt(6)
    v_xor_b32 v12, s28, v12
    v_xor_b32 v13, s29, v13
    v_xor_b32 v14, s30, v14
    v_xor_b32 v15, s31, v15
    v_or3_b32 v25, v25, v12, v13
    v_or3_b32 v25, v25, v14, v15
    v_and_b32 v25, 0xff, v25
    v_cmp_ne_u32 vcc, 0, v25
    s_cbranch_vccnz L_retry_118
L_ok_121:
    v_add_f32_dpp v8, v8, v8 row_ror:4 row_mask:0xf bank_mask:0xf
    v_add_f32_dpp v9, v9, v9 row_ror:4 row_mask:0xf bank_mask:0xf
    v_add_f32_dpp v10, v10, v10 row_ror:4 row_mask:0xf bank_mask:0xf
    v_add_f32_dpp v11, v11, v11 row_ror:4 row_mask:0xf bank_mask:0xf
    v_add_f32_dpp v12, v12, v12 row_ror:4 row_mask:0xf bank_mask:0xf
    v_add_f32_dpp v13, v13, v13 row_ror:4 row_mask:0xf bank_mask:0xf
    v_add_f32_dpp v14, v14, v14 row_ror:4 row_mask:0xf bank_mask:0xf
    v_add_f32_dpp v15, v15, v15 row_ror:4 row_mask:0xf bank_mask:0xf
    v_add_f32_dpp v8, v8, v8 row_ror:8 row_mask:0xf bank_mask:0xf
    v_add_f32_dpp v9, v9, v9 row_ror:8 row_mask:0xf bank_mask:0xf
    v_add_f32_dpp v10, v10, v10 row_ror:8 row_mask:0xf bank_mask:0xf
    v_add_f32_dpp v11, v11, v11 row_ror:8 row_mask:0xf bank_mask:0xf
    v_add_f32_dpp v12, v12, v12 row_ror:8 row_mask:0xf bank_mask:0xf
    v_add_f32_dpp v13, v13, v13 row_ror:8 row_mask:0xf bank_mask:0xf
    v_add_f32_dpp v14, v14, v14 row_ror:8 row_mask:0xf bank_mask:0xf
    v_add_f32_dpp v15, v15, v15 row_ror:8 row_mask:0xf bank_mask:0xf
    v_cvt_pk_bf16_f32 v36, v8, v9
    v_cvt_pk_bf16_f32 v37, v10, v11
    v_cvt_pk_bf16_f32 v38, v12, v13
    v_cvt_pk_bf16_f32 v39, v14, v15
    v_cndmask_b32_e64 v8, 0, v36, s[76:77]
    v_cndmask_b32_e64 v9, 0, v37, s[76:77]
    v_cndmask_b32_e64 v10, 0, v38, s[76:77]
    v_cndmask_b32_e64 v11, 0, v39, s[76:77]
    v_cndmask_b32_e64 v12, 0, v36, s[78:79]
    v_cndmask_b32_e64 v13, 0, v37, s[78:79]
    v_cndmask_b32_e64 v14, 0, v38, s[78:79]
    v_cndmask_b32_e64 v15, 0, v39, s[78:79]
    v_mfma_f32_16x16x32_bf16 v[24:27], a[184:187], v[8:11], 0
    v_cndmask_b32_e64 v16, 0, v36, s[80:81]
    v_cndmask_b32_e64 v17, 0, v37, s[80:81]
    v_cndmask_b32_e64 v18, 0, v38, s[80:81]
    v_cndmask_b32_e64 v19, 0, v39, s[80:81]
    v_mfma_f32_16x16x32_bf16 v[24:27], a[188:191], v[12:15], v[24:27]
    v_cndmask_b32_e64 v20, 0, v36, s[82:83]
    v_cndmask_b32_e64 v21, 0, v37, s[82:83]
    v_cndmask_b32_e64 v22, 0, v38, s[82:83]
    v_cndmask_b32_e64 v23, 0, v39, s[82:83]
    v_mfma_f32_16x16x32_bf16 v[24:27], a[192:195], v[16:19], v[24:27]
    s_nop 0
    v_mfma_f32_16x16x32_bf16 v[24:27], a[196:199], v[20:23], v[24:27]
    s_add_u32 s5, s4, 28
    s_and_b32 s5, s5, 63
    s_lshl_b32 s5, s5, 12
    buffer_load_dwordx4 a[40:43], v1, s[8:11], s5 offen nt
    v_mfma_f32_16x16x32_bf16 v[28:31], a[200:203], v[8:11], 0
    v_mfma_f32_16x16x32_bf16 v[28:31], a[204:207], v[12:15], v[28:31]
    v_mfma_f32_16x16x32_bf16 v[28:31], a[208:211], v[16:19], v[28:31]
    v_mfma_f32_16x16x32_bf16 v[28:31], a[212:215], v[20:23], v[28:31]
    v_mfma_f32_16x16x32_bf16 v[32:35], a[216:219], v[8:11], 0
    v_mov_b32_dpp v24, v24 quad_perm:[0,0,0,0] row_mask:0xf bank_mask:0xf
    v_mov_b32_dpp v26, v26 quad_perm:[2,2,2,2] row_mask:0xf bank_mask:0xf
    v_mfma_f32_16x16x32_bf16 v[32:35], a[220:223], v[12:15], v[32:35]
    v_add_f32_dpp v24, v25, v24 quad_perm:[1,1,1,1] row_mask:0xf bank_mask:0xf
    v_add_f32_dpp v26, v27, v26 quad_perm:[3,3,3,3] row_mask:0xf bank_mask:0xf
    v_mfma_f32_16x16x32_bf16 v[32:35], a[224:227], v[16:19], v[32:35]
    v_add_f32 v24, v24, v26
    v_mfma_f32_16x16x32_bf16 v[32:35], a[228:231], v[20:23], v[32:35]
    v_cndmask_b32_e64 v36, v36, v24, s[68:69]
    s_waitcnt vmcnt(6)
    s_add_u32 m0, s54, 3072
    s_add_u32 s5, s4, 3
    s_and_b32 s5, s5, 63
    s_lshl_b32 s5, s5, 12
    buffer_load_dwordx4 v2, s[12:15], s5 offen nt lds
    v_mfma_f32_16x16x32_bf16 v[24:27], a[232:235], v[8:11], 0
    v_mov_b32_dpp v28, v28 quad_perm:[0,0,0,0] row_mask:0xf bank_mask:0xf
    v_mov_b32_dpp v30, v30 quad_perm:[2,2,2,2] row_mask:0xf bank_mask:0xf
    v_mfma_f32_16x16x32_bf16 v[24:27], a[236:239], v[12:15], v[24:27]
    v_add_f32_dpp v28, v29, v28 quad_perm:[1,1,1,1] row_mask:0xf bank_mask:0xf
    v_add_f32_dpp v30, v31, v30 quad_perm:[3,3,3,3] row_mask:0xf bank_mask:0xf
    v_mfma_f32_16x16x32_bf16 v[24:27], a[240:243], v[16:19], v[24:27]
    v_add_f32 v28, v28, v30
    v_mfma_f32_16x16x32_bf16 v[24:27], a[244:247], v[20:23], v[24:27]
    v_cndmask_b32_e64 v36, v36, v28, s[70:71]
    v_mfma_f32_16x16x32_bf16 v[28:31], a[248:251], v[8:11], 0
    v_mov_b32_dpp v32, v32 quad_perm:[0,0,0,0] row_mask:0xf bank_mask:0xf
    v_mov_b32_dpp v34, v34 quad_perm:[2,2,2,2] row_mask:0xf bank_mask:0xf
    v_mfma_f32_16x16x32_bf16 v[28:31], a[252:255], v[12:15], v[28:31]
    v_add_f32_dpp v32, v33, v32 quad_perm:[1,1,1,1] row_mask:0xf bank_mask:0xf
    v_add_f32_dpp v34, v35, v34 quad_perm:[3,3,3,3] row_mask:0xf bank_mask:0xf
    v_mfma_f32_16x16x32_bf16 v[28:31], a[0:3], v[16:19], v[28:31]
    v_add_f32 v32, v32, v34
    v_mfma_f32_16x16x32_bf16 v[28:31], a[4:7], v[20:23], v[28:31]
    v_cndmask_b32_e64 v36, v36, v32, s[72:73]
    s_waitcnt vmcnt(6)
    s_add_u32 m0, s54, 4096
    s_add_u32 s5, s4, 4
    s_and_b32 s5, s5, 63
    s_lshl_b32 s5, s5, 12
    buffer_load_dwordx4 v2, s[12:15], s5 offen nt lds
    v_mfma_f32_16x16x32_bf16 v[32:35], a[8:11], v[8:11], 0
    v_mov_b32_dpp v24, v24 quad_perm:[0,0,0,0] row_mask:0xf bank_mask:0xf
    v_mov_b32_dpp v26, v26 quad_perm:[2,2,2,2] row_mask:0xf bank_mask:0xf
    v_mfma_f32_16x16x32_bf16 v[32:35], a[12:15], v[12:15], v[32:35]
    v_add_f32_dpp v24, v25, v24 quad_perm:[1,1,1,1] row_mask:0xf bank_mask:0xf
    v_add_f32_dpp v26, v27, v26 quad_perm:[3,3,3,3] row_mask:0xf bank_mask:0xf
    v_mfma_f32_16x16x32_bf16 v[32:35], a[16:19], v[16:19], v[32:35]
    v_add_f32 v24, v24, v26
    v_mfma_f32_16x16x32_bf16 v[32:35], a[20:23], v[20:23], v[32:35]
    v_cndmask_b32_e64 v36, v36, v24, s[74:75]
    v_mfma_f32_16x16x32_bf16 v[24:27], a[24:27], v[8:11], 0
    v_mov_b32_dpp v28, v28 quad_perm:[0,0,0,0] row_mask:0xf bank_mask:0xf
    v_mov_b32_dpp v30, v30 quad_perm:[2,2,2,2] row_mask:0xf bank_mask:0xf
    v_mfma_f32_16x16x32_bf16 v[24:27], a[28:31], v[12:15], v[24:27]
    v_add_f32_dpp v28, v29, v28 quad_perm:[1,1,1,1] row_mask:0xf bank_mask:0xf
    v_add_f32_dpp v30, v31, v30 quad_perm:[3,3,3,3] row_mask:0xf bank_mask:0xf
    v_mfma_f32_16x16x32_bf16 v[24:27], a[32:35], v[16:19], v[24:27]
    v_add_f32 v28, v28, v30
    s_waitcnt vmcnt(6)
    v_mfma_f32_16x16x32_bf16 v[24:27], a[36:39], v[20:23], v[24:27]
    v_cndmask_b32_e64 v37, v37, v28, s[68:69]
    s_add_u32 m0, s54, 5120
    s_add_u32 s5, s4, 5
    s_and_b32 s5, s5, 63
    s_lshl_b32 s5, s5, 12
    buffer_load_dwordx4 v2, s[12:15], s5 offen nt lds
    s_waitcnt vmcnt(6)
    s_add_u32 s5, s4, 29
    s_and_b32 s5, s5, 63
    s_lshl_b32 s5, s5, 12
    buffer_load_dwordx4 a[44:47], v1, s[8:11], s5 offen nt
    s_waitcnt vmcnt(6)
    s_add_u32 m0, s54, 6144
    s_add_u32 s5, s4, 6
    s_and_b32 s5, s5, 63
    s_lshl_b32 s5, s5, 12
    buffer_load_dwordx4 v2, s[12:15], s5 offen nt lds
    s_waitcnt vmcnt(6)
    s_add_u32 m0, s54, 7168
    s_add_u32 s5, s4, 7
    s_and_b32 s5, s5, 63
    s_lshl_b32 s5, s5, 12
    buffer_load_dwordx4 v2, s[12:15], s5 offen nt lds
    s_waitcnt vmcnt(6)
    v_mfma_f32_16x16x32_bf16 v[28:31], a[40:43], v[8:11], 0
    v_mov_b32_dpp v32, v32 quad_perm:[0,0,0,0] row_mask:0xf bank_mask:0xf
    v_mov_b32_dpp v34, v34 quad_perm:[2,2,2,2] row_mask:0xf bank_mask:0xf
    s_add_u32 m0, s54, 8192
    s_add_u32 s5, s4, 8
    s_and_b32 s5, s5, 63
    s_lshl_b32 s5, s5, 12
    buffer_load_dwordx4 v2, s[12:15], s5 offen nt lds
    s_waitcnt vmcnt(6)
    s_add_u32 s5, s4, 30
    s_and_b32 s5, s5, 63
    s_lshl_b32 s5, s5, 12
    buffer_load_dwordx4 a[48:51], v1, s[8:11], s5 offen nt
    s_waitcnt vmcnt(6)
    s_add_u32 m0, s54, 9216
    s_add_u32 s5, s4, 9
    s_and_b32 s5, s5, 63
    s_lshl_b32 s5, s5, 12
    buffer_load_dwordx4 v2, s[12:15], s5 offen nt lds
    s_waitcnt vmcnt(6)
    s_add_u32 m0, s54, 10240
    s_add_u32 s5, s4, 10
    s_and_b32 s5, s5, 63
    s_lshl_b32 s5, s5, 12
    buffer_load_dwordx4 v2, s[12:15], s5 offen nt lds
    s_waitcnt vmcnt(6)
    v_mfma_f32_16x16x32_bf16 v[28:31], a[44:47], v[12:15], v[28:31]
    v_add_f32_dpp v32, v33, v32 quad_perm:[1,1,1,1] row_mask:0xf bank_mask:0xf
    v_add_f32_dpp v34, v35, v34 quad_perm:[3,3,3,3] row_mask:0xf bank_mask:0xf
    s_add_u32 m0, s54, 11264
    s_add_u32 s5, s4, 11
    s_and_b32 s5, s5, 63
    s_lshl_b32 s5, s5, 12
    buffer_load_dwordx4 v2, s[12:15], s5 offen nt lds
    s_waitcnt vmcnt(6)
    s_add_u32 s5, s4, 31
    s_and_b32 s5, s5, 63
    s_lshl_b32 s5, s5, 12
    buffer_load_dwordx4 a[52:55], v1, s[8:11], s5 offen nt
    s_waitcnt vmcnt(6)
    s_add_u32 m0, s54, 12288
    s_add_u32 s5, s4, 12
    s_and_b32 s5, s5, 63
    s_lshl_b32 s5, s5, 12
    buffer_load_dwordx4 v2, s[12:15], s5 offen nt lds
    s_waitcnt vmcnt(6)
    s_add_u32 m0, s54, 13312
    s_add_u32 s5, s4, 13
    s_and_b32 s5, s5, 63
    s_lshl_b32 s5, s5, 12
    buffer_load_dwordx4 v2, s[12:15], s5 offen nt lds
    s_waitcnt vmcnt(6)
    v_mfma_f32_16x16x32_bf16 v[28:31], a[48:51], v[16:19], v[28:31]
    v_add_f32 v32, v32, v34
    s_add_u32 m0, s54, 14336
    s_add_u32 s5, s4, 14
    s_and_b32 s5, s5, 63
    s_lshl_b32 s5, s5, 12
    buffer_load_dwordx4 v2, s[12:15], s5 offen nt lds
    s_waitcnt vmcnt(6)
    s_add_u32 s5, s4, 32
    s_and_b32 s5, s5, 63
    s_lshl_b32 s5, s5, 12
    buffer_load_dwordx4 a[56:59], v1, s[8:11], s5 offen nt
    s_waitcnt vmcnt(6)
    s_add_u32 m0, s54, 15360
    s_add_u32 s5, s4, 15
    s_and_b32 s5, s5, 63
    s_lshl_b32 s5, s5, 12
    buffer_load_dwordx4 v2, s[12:15], s5 offen nt lds
    s_waitcnt vmcnt(6)
    s_add_u32 m0, s54, 16384
    s_add_u32 s5, s4, 16
    s_and_b32 s5, s5, 63
    s_lshl_b32 s5, s5, 12
    buffer_load_dwordx4 v2, s[12:15], s5 offen nt lds
    s_waitcnt vmcnt(6)
    v_mfma_f32_16x16x32_bf16 v[28:31], a[52:55], v[20:23], v[28:31]
    v_cndmask_b32_e64 v37, v37, v32, s[70:71]
    s_add_u32 m0, s54, 17408
    s_add_u32 s5, s4, 17
    s_and_b32 s5, s5, 63
    s_lshl_b32 s5, s5, 12
    buffer_load_dwordx4 v2, s[12:15], s5 offen nt lds
    s_waitcnt vmcnt(6)
    s_add_u32 s5, s4, 33
    s_and_b32 s5, s5, 63
    s_lshl_b32 s5, s5, 12
    buffer_load_dwordx4 a[60:63], v1, s[8:11], s5 offen nt
    s_waitcnt vmcnt(6)
    s_add_u32 m0, s54, 18432
    s_add_u32 s5, s4, 18
    s_and_b32 s5, s5, 63
    s_lshl_b32 s5, s5, 12
    buffer_load_dwordx4 v2, s[12:15], s5 offen nt lds
    s_waitcnt vmcnt(6)
    s_add_u32 m0, s54, 19456
    s_add_u32 s5, s4, 19
    s_and_b32 s5, s5, 63
    s_lshl_b32 s5, s5, 12
    buffer_load_dwordx4 v2, s[12:15], s5 offen nt lds
    s_waitcnt vmcnt(6)
    v_mfma_f32_16x16x32_bf16 v[32:35], a[56:59], v[8:11], 0
    v_mov_b32_dpp v24, v24 quad_perm:[0,0,0,0] row_mask:0xf bank_mask:0xf
    v_mov_b32_dpp v26, v26 quad_perm:[2,2,2,2] row_mask:0xf bank_mask:0xf
    s_add_u32 s5, s4, 20
    s_and_b32 s5, s5, 63
    s_lshl_b32 s5, s5, 12
    buffer_load_dwordx4 v[80:83], v2, s[12:15], s5 offen nt
    s_waitcnt vmcnt(6)
    s_add_u32 s5, s4, 21
    s_and_b32 s5, s5, 63
    s_lshl_b32 s5, s5, 12
    buffer_load_dwordx4 v[84:87], v2, s[12:15], s5 offen nt
    s_waitcnt vmcnt(6)
    s_add_u32 s5, s4, 22
    s_and_b32 s5, s5, 63
    s_lshl_b32 s5, s5, 12
    buffer_load_dwordx4 v[88:91], v2, s[12:15], s5 offen nt
    s_waitcnt vmcnt(6)
    s_add_u32 s5, s4, 23
    s_and_b32 s5, s5, 63
    s_lshl_b32 s5, s5, 12
    buffer_load_dwordx4 v[92:95], v2, s[12:15], s5 offen nt
    s_waitcnt vmcnt(6)
    v_mfma_f32_16x16x32_bf16 v[32:35], a[60:63], v[12:15], v[32:35]
    v_add_f32_dpp v24, v25, v24 quad_perm:[1,1,1,1] row_mask:0xf bank_mask:0xf
    v_add_f32_dpp v26, v27, v26 quad_perm:[3,3,3,3] row_mask:0xf bank_mask:0xf
    v_mfma_f32_16x16x32_bf16 v[32:35], a[64:67], v[16:19], v[32:35]
    v_add_f32 v24, v24, v26
    v_mfma_f32_16x16x32_bf16 v[32:35], a[68:71], v[20:23], v[32:35]
    v_cndmask_b32_e64 v37, v37, v24, s[72:73]
    v_mfma_f32_16x16x32_bf16 v[24:27], a[72:75], v[8:11], 0
    v_mov_b32_dpp v28, v28 quad_perm:[0,0,0,0] row_mask:0xf bank_mask:0xf
    v_mov_b32_dpp v30, v30 quad_perm:[2,2,2,2] row_mask:0xf bank_mask:0xf
    v_mfma_f32_16x16x32_bf16 v[24:27], a[76:79], v[12:15], v[24:27]
    v_add_f32_dpp v28, v29, v28 quad_perm:[1,1,1,1] row_mask:0xf bank_mask:0xf
    v_add_f32_dpp v30, v31, v30 quad_perm:[3,3,3,3] row_mask:0xf bank_mask:0xf
    v_mfma_f32_16x16x32_bf16 v[24:27], a[80:83], v[16:19], v[24:27]
    v_add_f32 v28, v28, v30
    v_mfma_f32_16x16x32_bf16 v[24:27], a[84:87], v[20:23], v[24:27]
    v_cndmask_b32_e64 v37, v37, v28, s[74:75]
    s_add_u32 s5, s4, 24
    s_and_b32 s5, s5, 63
    s_lshl_b32 s5, s5, 12
    buffer_load_dwordx4 v[96:99], v2, s[12:15], s5 offen nt
    v_mfma_f32_16x16x32_bf16 v[28:31], a[88:91], v[8:11], 0
    v_mov_b32_dpp v32, v32 quad_perm:[0,0,0,0] row_mask:0xf bank_mask:0xf
    v_mov_b32_dpp v34, v34 quad_perm:[2,2,2,2] row_mask:0xf bank_mask:0xf
    v_mfma_f32_16x16x32_bf16 v[28:31], a[92:95], v[12:15], v[28:31]
    v_add_f32_dpp v32, v33, v32 quad_perm:[1,1,1,1] row_mask:0xf bank_mask:0xf
    v_add_f32_dpp v34, v35, v34 quad_perm:[3,3,3,3] row_mask:0xf bank_mask:0xf
    v_mfma_f32_16x16x32_bf16 v[28:31], a[96:99], v[16:19], v[28:31]
    v_add_f32 v32, v32, v34
    v_mfma_f32_16x16x32_bf16 v[28:31], a[100:103], v[20:23], v[28:31]
    v_cndmask_b32_e64 v38, v38, v32, s[68:69]
    v_mfma_f32_16x16x32_bf16 v[32:35], a[104:107], v[8:11], 0
    v_mov_b32_dpp v24, v24 quad_perm:[0,0,0,0] row_mask:0xf bank_mask:0xf
    v_mov_b32_dpp v26, v26 quad_perm:[2,2,2,2] row_mask:0xf bank_mask:0xf
    v_mfma_f32_16x16x32_bf16 v[32:35], a[108:111], v[12:15], v[32:35]
    v_add_f32_dpp v24, v25, v24 quad_perm:[1,1,1,1] row_mask:0xf bank_mask:0xf
    v_add_f32_dpp v26, v27, v26 quad_perm:[3,3,3,3] row_mask:0xf bank_mask:0xf
    v_mfma_f32_16x16x32_bf16 v[32:35], a[112:115], v[16:19], v[32:35]
    v_add_f32 v24, v24, v26
    v_mfma_f32_16x16x32_bf16 v[32:35], a[116:119], v[20:23], v[32:35]
    v_cndmask_b32_e64 v38, v38, v24, s[70:71]
    s_waitcnt vmcnt(6)
    s_add_u32 s5, s4, 25
    s_and_b32 s5, s5, 63
    s_lshl_b32 s5, s5, 12
    buffer_load_dwordx4 v[100:103], v2, s[12:15], s5 offen nt
    v_mfma_f32_16x16x32_bf16 v[24:27], a[120:123], v[8:11], 0
    v_mov_b32_dpp v28, v28 quad_perm:[0,0,0,0] row_mask:0xf bank_mask:0xf
    v_mov_b32_dpp v30, v30 quad_perm:[2,2,2,2] row_mask:0xf bank_mask:0xf
    v_mfma_f32_16x16x32_bf16 v[24:27], a[124:127], v[12:15], v[24:27]
    v_add_f32_dpp v28, v29, v28 quad_perm:[1,1,1,1] row_mask:0xf bank_mask:0xf
    v_add_f32_dpp v30, v31, v30 quad_perm:[3,3,3,3] row_mask:0xf bank_mask:0xf
    v_mfma_f32_16x16x32_bf16 v[24:27], a[128:131], v[16:19], v[24:27]
    v_add_f32 v28, v28, v30
    v_mfma_f32_16x16x32_bf16 v[24:27], a[132:135], v[20:23], v[24:27]
    v_cndmask_b32_e64 v38, v38, v28, s[72:73]
    v_mfma_f32_16x16x32_bf16 v[28:31], a[136:139], v[8:11], 0
    v_mov_b32_dpp v32, v32 quad_perm:[0,0,0,0] row_mask:0xf bank_mask:0xf
    v_mov_b32_dpp v34, v34 quad_perm:[2,2,2,2] row_mask:0xf bank_mask:0xf
    v_mfma_f32_16x16x32_bf16 v[28:31], a[140:143], v[12:15], v[28:31]
    v_add_f32_dpp v32, v33, v32 quad_perm:[1,1,1,1] row_mask:0xf bank_mask:0xf
    v_add_f32_dpp v34, v35, v34 quad_perm:[3,3,3,3] row_mask:0xf bank_mask:0xf
    v_mfma_f32_16x16x32_bf16 v[28:31], a[144:147], v[16:19], v[28:31]
    v_add_f32 v32, v32, v34
    v_mfma_f32_16x16x32_bf16 v[28:31], a[148:151], v[20:23], v[28:31]
    v_cndmask_b32_e64 v38, v38, v32, s[74:75]
    s_waitcnt vmcnt(6)
    s_add_u32 s5, s4, 26
    s_and_b32 s5, s5, 63
    s_lshl_b32 s5, s5, 12
    buffer_load_dwordx4 v[104:107], v2, s[12:15], s5 offen nt
    v_mfma_f32_16x16x32_bf16 v[32:35], a[152:155], v[8:11], 0
    v_mov_b32_dpp v24, v24 quad_perm:[0,0,0,0] row_mask:0xf bank_mask:0xf
    v_mov_b32_dpp v26, v26 quad_perm:[2,2,2,2] row_mask:0xf bank_mask:0xf
    v_mfma_f32_16x16x32_bf16 v[32:35], a[156:159], v[12:15], v[32:35]
    v_add_f32_dpp v24, v25, v24 quad_perm:[1,1,1,1] row_mask:0xf bank_mask:0xf
    v_add_f32_dpp v26, v27, v26 quad_perm:[3,3,3,3] row_mask:0xf bank_mask:0xf
    v_mfma_f32_16x16x32_bf16 v[32:35], a[160:163], v[16:19], v[32:35]
    v_add_f32 v24, v24, v26
    v_mfma_f32_16x16x32_bf16 v[32:35], a[164:167], v[20:23], v[32:35]
    v_cndmask_b32_e64 v39, v39, v24, s[68:69]
    v_mfma_f32_16x16x32_bf16 v[24:27], a[168:171], v[8:11], 0
    v_mov_b32_dpp v28, v28 quad_perm:[0,0,0,0] row_mask:0xf bank_mask:0xf
    v_mov_b32_dpp v30, v30 quad_perm:[2,2,2,2] row_mask:0xf bank_mask:0xf
    v_mfma_f32_16x16x32_bf16 v[24:27], a[172:175], v[12:15], v[24:27]
    v_add_f32_dpp v28, v29, v28 quad_perm:[1,1,1,1] row_mask:0xf bank_mask:0xf
    v_add_f32_dpp v30, v31, v30 quad_perm:[3,3,3,3] row_mask:0xf bank_mask:0xf
    v_mfma_f32_16x16x32_bf16 v[24:27], a[176:179], v[16:19], v[24:27]
    v_add_f32 v28, v28, v30
    v_mfma_f32_16x16x32_bf16 v[24:27], a[180:183], v[20:23], v[24:27]
    v_cndmask_b32_e64 v39, v39, v28, s[70:71]
    s_waitcnt vmcnt(6)
    s_add_u32 s5, s4, 27
    s_and_b32 s5, s5, 63
    s_lshl_b32 s5, s5, 12
    buffer_load_dwordx4 v[108:111], v2, s[12:15], s5 offen nt
    v_mov_b32_dpp v32, v32 quad_perm:[0,0,0,0] row_mask:0xf bank_mask:0xf
    v_mov_b32_dpp v34, v34 quad_perm:[2,2,2,2] row_mask:0xf bank_mask:0xf
    s_nop 0
    v_add_f32_dpp v32, v33, v32 quad_perm:[1,1,1,1] row_mask:0xf bank_mask:0xf
    v_add_f32_dpp v34, v35, v34 quad_perm:[3,3,3,3] row_mask:0xf bank_mask:0xf
    v_add_f32 v32, v32, v34
    v_cndmask_b32_e64 v39, v39, v32, s[72:73]
    v_mov_b32_dpp v24, v24 quad_perm:[0,0,0,0] row_mask:0xf bank_mask:0xf
    v_mov_b32_dpp v26, v26 quad_perm:[2,2,2,2] row_mask:0xf bank_mask:0xf
    s_nop 0
    v_add_f32_dpp v24, v25, v24 quad_perm:[1,1,1,1] row_mask:0xf bank_mask:0xf
    v_add_f32_dpp v26, v27, v26 quad_perm:[3,3,3,3] row_mask:0xf bank_mask:0xf
    v_add_f32 v24, v24, v26
    v_cndmask_b32_e64 v39, v39, v24, s[74:75]
    s_add_u32 s5, s4, 28
    s_and_b32 s5, s5, 63
    s_lshl_b32 s5, s5, 12
    buffer_load_dwordx4 v[112:115], v2, s[12:15], s5 offen nt
    s_add_u32 s5, s4, 29
    s_and_b32 s5, s5, 63
    s_lshl_b32 s5, s5, 12
    buffer_load_dwordx4 v[116:119], v2, s[12:15], s5 offen nt
    v_max3_f32 v16, v36, v37, v38
    v_max_f32 v16, v16, v39
    v_mov_b32 v24, 0
    v_mov_b32 v25, 0
    v_max_f32_dpp v16, v16, v16 quad_perm:[1,0,3,2] row_mask:0xf bank_mask:0xf
    v_mov_b32 v26, 0
    v_mov_b32 v27, 0
    v_max_f32_dpp v16, v16, v16 quad_perm:[2,3,0,1] row_mask:0xf bank_mask:0xf
    v_mov_b32 v28, 0
    v_mov_b32 v29, 0
    v_max_f32_dpp v16, v16, v16 row_half_mirror row_mask:0xf bank_mask:0xf
    v_mov_b32 v30, 0
    v_mov_b32 v31, 0
    v_max_f32_dpp v16, v16, v16 row_mirror row_mask:0xf bank_mask:0xf
    v_mov_b32 v17, 0x3e0293ee
    s_nop 0
    v_max_f32_dpp v16, v16, v16 row_bcast:15 row_mask:0xa bank_mask:0xf
    s_nop 1
    v_max_f32_dpp v16, v16, v16 row_bcast:31 row_mask:0xc bank_mask:0xf
    v_mul_f32 v16, 0x3e0293ee, v16
    s_nop 0
    v_readlane_b32 s61, v16, 63
    s_nop 1
    v_fma_f32 v36, v36, v17, -s61
    v_fma_f32 v37, v37, v17, -s61
    v_fma_f32 v38, v38, v17, -s61
    v_fma_f32 v39, v39, v17, -s61
    v_exp_f32 v36, v36
    v_exp_f32 v37, v37
    v_exp_f32 v38, v38
    v_exp_f32 v39, v39
    v_cvt_pk_bf16_f32 v8, v36, v36
    v_cvt_pk_bf16_f32 v9, v36, v36
    v_cvt_pk_bf16_f32 v10, v37, v37
    v_cvt_pk_bf16_f32 v11, v37, v37
    v_cvt_pk_bf16_f32 v12, v38, v38
    v_cvt_pk_bf16_f32 v13, v38, v38
    v_cvt_pk_bf16_f32 v14, v39, v39
    v_cvt_pk_bf16_f32 v15, v39, v39
    v_mov_b32_dpp v8, v8 row_shr:4 row_mask:0xf bank_mask:0xa
    v_mov_b32_dpp v9, v9 row_shl:4 row_mask:0xf bank_mask:0x5
    v_mov_b32_dpp v10, v10 row_shr:4 row_mask:0xf bank_mask:0xa
    v_mov_b32_dpp v11, v11 row_shl:4 row_mask:0xf bank_mask:0x5
    v_mov_b32_dpp v12, v12 row_shr:4 row_mask:0xf bank_mask:0xa
    v_mov_b32_dpp v13, v13 row_shl:4 row_mask:0xf bank_mask:0x5
    v_mov_b32_dpp v14, v14 row_shr:4 row_mask:0xf bank_mask:0xa
    v_mov_b32_dpp v15, v15 row_shl:4 row_mask:0xf bank_mask:0x5
    v_add_f32 v7, v36, v37
    v_add_f32 v38, v38, v39
    v_permlane32_swap_b32 v8, v9
    v_permlane32_swap_b32 v10, v11
    v_permlane32_swap_b32 v12, v13
    v_permlane32_swap_b32 v14, v15
    v_add_f32 v7, v7, v38
    ds_read_b128 v[32:35], v3 offset:0
    ds_read_b128 v[36:39], v3 offset:1024
    v_and_b32_dpp v16, v8, v4 quad_perm:[0,0,0,0] row_mask:0xf bank_mask:0xf
    v_and_b32_dpp v17, v8, v5 quad_perm:[0,0,0,0] row_mask:0xf bank_mask:0xf
    v_and_b32_dpp v18, v9, v4 quad_perm:[0,0,0,0] row_mask:0xf bank_mask:0xf
    v_and_b32_dpp v19, v9, v5 quad_perm:[0,0,0,0] row_mask:0xf bank_mask:0xf
    v_and_b32_dpp v20, v8, v4 quad_perm:[1,1,1,1] row_mask:0xf bank_mask:0xf
    v_and_b32_dpp v21, v8, v5 quad_perm:[1,1,1,1] row_mask:0xf bank_mask:0xf
    s_waitcnt lgkmcnt(0)
    v_smfmac_f32_16x16x64_bf16 v[24:27], v[16:19], v[32:39], v6
    ds_read_b128 v[32:35], v3 offset:2048
    ds_read_b128 v[36:39], v3 offset:3072
    v_and_b32_dpp v22, v9, v4 quad_perm:[1,1,1,1] row_mask:0xf bank_mask:0xf
    v_and_b32_dpp v23, v9, v5 quad_perm:[1,1,1,1] row_mask:0xf bank_mask:0xf
    s_waitcnt lgkmcnt(0)
    v_smfmac_f32_16x16x64_bf16 v[28:31], v[16:19], v[32:39], v6
    ds_read_b128 v[32:35], v3 offset:4096
    ds_read_b128 v[36:39], v3 offset:5120
    v_add_f32_dpp v7, v7, v7 quad_perm:[1,0,3,2] row_mask:0xf bank_mask:0xf
    s_waitcnt vmcnt(5)
    s_add_u32 s5, s4, 30
    s_and_b32 s5, s5, 63
    s_lshl_b32 s5, s5, 12
    buffer_load_dwordx4 v[120:123], v2, s[12:15], s5 offen nt
    v_and_b32_dpp v16, v8, v4 quad_perm:[2,2,2,2] row_mask:0xf bank_mask:0xf
    v_and_b32_dpp v17, v8, v5 quad_perm:[2,2,2,2] row_mask:0xf bank_mask:0xf
    s_waitcnt lgkmcnt(0)
    v_smfmac_f32_16x16x64_bf16 v[24:27], v[20:23], v[32:39], v6
    ds_read_b128 v[32:35], v3 offset:6144
    ds_read_b128 v[36:39], v3 offset:7168
    v_and_b32_dpp v18, v9, v4 quad_perm:[2,2,2,2] row_mask:0xf bank_mask:0xf
    v_and_b32_dpp v19, v9, v5 quad_perm:[2,2,2,2] row_mask:0xf bank_mask:0xf
    s_waitcnt lgkmcnt(0)
    v_smfmac_f32_16x16x64_bf16 v[28:31], v[20:23], v[32:39], v6
    ds_read_b128 v[32:35], v3 offset:8192
    ds_read_b128 v[36:39], v3 offset:9216
    v_add_f32_dpp v7, v7, v7 quad_perm:[2,3,0,1] row_mask:0xf bank_mask:0xf
    v_and_b32_dpp v20, v8, v4 quad_perm:[3,3,3,3] row_mask:0xf bank_mask:0xf
    v_and_b32_dpp v21, v8, v5 quad_perm:[3,3,3,3] row_mask:0xf bank_mask:0xf
    s_waitcnt lgkmcnt(0)
    v_smfmac_f32_16x16x64_bf16 v[24:27], v[16:19], v[32:39], v6
    ds_read_b128 v[32:35], v3 offset:10240
    ds_read_b128 v[36:39], v3 offset:11264
    v_and_b32_dpp v22, v9, v4 quad_perm:[3,3,3,3] row_mask:0xf bank_mask:0xf
    v_and_b32_dpp v23, v9, v5 quad_perm:[3,3,3,3] row_mask:0xf bank_mask:0xf
    s_waitcnt lgkmcnt(0)
    v_smfmac_f32_16x16x64_bf16 v[28:31], v[16:19], v[32:39], v6
    ds_read_b128 v[32:35], v3 offset:12288
    ds_read_b128 v[36:39], v3 offset:13312
    v_add_f32_dpp v7, v7, v7 row_half_mirror row_mask:0xf bank_mask:0xf
    s_waitcnt vmcnt(5)
    s_add_u32 s5, s4, 31
    s_and_b32 s5, s5, 63
    s_lshl_b32 s5, s5, 12
    buffer_load_dwordx4 v[124:127], v2, s[12:15], s5 offen nt
    v_and_b32_dpp v16, v10, v4 quad_perm:[0,0,0,0] row_mask:0xf bank_mask:0xf
    v_and_b32_dpp v17, v10, v5 quad_perm:[0,0,0,0] row_mask:0xf bank_mask:0xf
    s_waitcnt lgkmcnt(0)
    v_smfmac_f32_16x16x64_bf16 v[24:27], v[20:23], v[32:39], v6
    ds_read_b128 v[32:35], v3 offset:14336
    ds_read_b128 v[36:39], v3 offset:15360
    v_and_b32_dpp v18, v11, v4 quad_perm:[0,0,0,0] row_mask:0xf bank_mask:0xf
    v_and_b32_dpp v19, v11, v5 quad_perm:[0,0,0,0] row_mask:0xf bank_mask:0xf
    s_waitcnt lgkmcnt(0)
    v_smfmac_f32_16x16x64_bf16 v[28:31], v[20:23], v[32:39], v6
    ds_read_b128 v[32:35], v3 offset:16384
    ds_read_b128 v[36:39], v3 offset:17408
    v_add_f32_dpp v7, v7, v7 row_mirror row_mask:0xf bank_mask:0xf
    v_and_b32_dpp v20, v10, v4 quad_perm:[1,1,1,1] row_mask:0xf bank_mask:0xf
    v_and_b32_dpp v21, v10, v5 quad_perm:[1,1,1,1] row_mask:0xf bank_mask:0xf
    s_waitcnt lgkmcnt(0)
    v_smfmac_f32_16x16x64_bf16 v[24:27], v[16:19], v[32:39], v6
    ds_read_b128 v[32:35], v3 offset:18432
    ds_read_b128 v[36:39], v3 offset:19456
    v_and_b32_dpp v22, v11, v4 quad_perm:[1,1,1,1] row_mask:0xf bank_mask:0xf
    v_and_b32_dpp v23, v11, v5 quad_perm:[1,1,1,1] row_mask:0xf bank_mask:0xf
    s_waitcnt lgkmcnt(0)
    v_smfmac_f32_16x16x64_bf16 v[28:31], v[16:19], v[32:39], v6
    v_add_f32_dpp v7, v7, v7 row_bcast:15 row_mask:0xa bank_mask:0xf
    s_waitcnt vmcnt(5)
    s_add_u32 s5, s4, 32
    s_and_b32 s5, s5, 63
    s_lshl_b32 s5, s5, 12
    buffer_load_dwordx4 v[128:131], v2, s[12:15], s5 offen nt
    v_and_b32_dpp v16, v10, v4 quad_perm:[2,2,2,2] row_mask:0xf bank_mask:0xf
    v_and_b32_dpp v17, v10, v5 quad_perm:[2,2,2,2] row_mask:0xf bank_mask:0xf
    v_smfmac_f32_16x16x64_bf16 v[24:27], v[20:23], v[80:87], v6
    v_and_b32_dpp v18, v11, v4 quad_perm:[2,2,2,2] row_mask:0xf bank_mask:0xf
    v_and_b32_dpp v19, v11, v5 quad_perm:[2,2,2,2] row_mask:0xf bank_mask:0xf
    v_smfmac_f32_16x16x64_bf16 v[28:31], v[20:23], v[88:95], v6
    v_add_f32_dpp v7, v7, v7 row_bcast:31 row_mask:0xc bank_mask:0xf
    v_and_b32_dpp v20, v10, v4 quad_perm:[3,3,3,3] row_mask:0xf bank_mask:0xf
    v_and_b32_dpp v21, v10, v5 quad_perm:[3,3,3,3] row_mask:0xf bank_mask:0xf
    v_smfmac_f32_16x16x64_bf16 v[24:27], v[16:19], v[96:103], v6
    v_and_b32_dpp v22, v11, v4 quad_perm:[3,3,3,3] row_mask:0xf bank_mask:0xf
    v_and_b32_dpp v23, v11, v5 quad_perm:[3,3,3,3] row_mask:0xf bank_mask:0xf
    s_waitcnt vmcnt(5)
    v_smfmac_f32_16x16x64_bf16 v[28:31], v[16:19], v[104:111], v6
    v_readlane_b32 s62, v7, 63
    v_and_b32_dpp v16, v12, v4 quad_perm:[0,0,0,0] row_mask:0xf bank_mask:0xf
    v_and_b32_dpp v17, v12, v5 quad_perm:[0,0,0,0] row_mask:0xf bank_mask:0xf
    s_add_u32 s5, s4, 33
    s_and_b32 s5, s5, 63
    s_lshl_b32 s5, s5, 12
    buffer_load_dwordx4 v[132:135], v2, s[12:15], s5 offen nt
    s_waitcnt vmcnt(5)
    s_add_u32 s5, s4, 34
    s_and_b32 s5, s5, 63
    s_lshl_b32 s5, s5, 12
    buffer_load_dwordx4 v[136:139], v2, s[12:15], s5 offen nt
    s_waitcnt vmcnt(5)
    v_smfmac_f32_16x16x64_bf16 v[24:27], v[20:23], v[112:119], v6
    v_and_b32_dpp v18, v13, v4 quad_perm:[0,0,0,0] row_mask:0xf bank_mask:0xf
    v_and_b32_dpp v19, v13, v5 quad_perm:[0,0,0,0] row_mask:0xf bank_mask:0xf
    s_add_u32 s5, s4, 35
    s_and_b32 s5, s5, 63
    s_lshl_b32 s5, s5, 12
    buffer_load_dwordx4 v[140:143], v2, s[12:15], s5 offen nt
    s_waitcnt vmcnt(5)
    s_add_u32 s5, s4, 36
    s_and_b32 s5, s5, 63
    s_lshl_b32 s5, s5, 12
    buffer_load_dwordx4 v[144:147], v2, s[12:15], s5 offen nt
    s_waitcnt vmcnt(5)
    v_smfmac_f32_16x16x64_bf16 v[28:31], v[20:23], v[120:127], v6
L_anchor_1:
    s_add_u32 s48, s90, 2
    s_and_b32 s48, s48, 0xff
    s_add_u32 s49, s90, 55
    s_and_b32 s49, s49, 0xff
    s_add_u32 s50, s90, 108
    s_and_b32 s50, s50, 0xff
    s_add_u32 s51, s90, 161
    s_and_b32 s51, s51, 0xff
    s_add_u32 s59, s24, 0
    s_add_u32 s60, s25, 0
    v_add3_u32 v35, v43, s90, 2
    v_mov_b32 v38, s61
    v_mov_b32 v39, s62
    v_lshlrev_b32_e64 v7, 3, s3
    s_mov_b64 exec, 1
    ds_write_b64 v7, v[38:39] offset:2048
    s_mov_b64 exec, -1
    v_mov_b32 v7, 0
    s_add_u32 s28, s90, 3
    s_and_b32 s28, s28, 0xff
    s_add_u32 s29, s90, 56
    s_and_b32 s29, s29, 0xff
    s_add_u32 s30, s90, 109
    s_and_b32 s30, s30, 0xff
    s_add_u32 s31, s90, 162
    s_and_b32 s31, s31, 0xff
    s_add_u32 s5, s4, 37
    s_and_b32 s5, s5, 63
    s_lshl_b32 s5, s5, 12
    buffer_load_dwordx4 v[148:151], v2, s[12:15], s5 offen nt
    v_and_b32_dpp v20, v12, v4 quad_perm:[1,1,1,1] row_mask:0xf bank_mask:0xf
    v_and_b32_dpp v21, v12, v5 quad_perm:[1,1,1,1] row_mask:0xf bank_mask:0xf
    s_waitcnt vmcnt(5)
    s_add_u32 s5, s4, 38
    s_and_b32 s5, s5, 63
    s_lshl_b32 s5, s5, 12
    buffer_load_dwordx4 v[152:155], v2, s[12:15], s5 offen nt
    s_waitcnt vmcnt(5)
    v_smfmac_f32_16x16x64_bf16 v[24:27], v[16:19], v[128:135], v6
    v_and_b32_dpp v22, v13, v4 quad_perm:[1,1,1,1] row_mask:0xf bank_mask:0xf
    v_and_b32_dpp v23, v13, v5 quad_perm:[1,1,1,1] row_mask:0xf bank_mask:0xf
    s_add_u32 s5, s4, 39
    s_and_b32 s5, s5, 63
    s_lshl_b32 s5, s5, 12
    buffer_load_dwordx4 v[156:159], v2, s[12:15], s5 offen nt
    s_waitcnt vmcnt(5)
    s_add_u32 s5, s4, 40
    s_and_b32 s5, s5, 63
    s_lshl_b32 s5, s5, 12
    buffer_load_dwordx4 v[160:163], v2, s[12:15], s5 offen nt
    s_waitcnt vmcnt(5)
    v_smfmac_f32_16x16x64_bf16 v[28:31], v[16:19], v[136:143], v6
    s_waitcnt lgkmcnt(0)
    s_barrier
    ds_read_b128 v[32:35], v7 offset:2048
    ds_read_b128 v[36:39], v7 offset:2064
    s_waitcnt lgkmcnt(0)
    v_max3_f32 v7, v32, v34, v36
    v_max_f32 v7, v7, v38
    v_sub_f32 v32, v32, v7
    v_sub_f32 v34, v34, v7
    v_sub_f32 v36, v36, v7
    v_sub_f32 v38, v38, v7
    v_exp_f32 v32, v32
    v_exp_f32 v34, v34
    v_exp_f32 v36, v36
    v_exp_f32 v38, v38
    v_mul_f32 v33, v32, v33
    v_fmac_f32 v33, v34, v35
    v_fmac_f32 v33, v36, v37
    v_fmac_f32 v33, v38, v39
    v_lshlrev_b32 v32, 8, v7
    v_cndmask_b32_e64 v7, v7, v32, s[72:73]
    v_cndmask_b32_e64 v33, v33, v7, s[66:67]
    v_add3_u32 v35, v43, s90, 2
    v_bfi_b32 v33, s87, v35, v33
    s_cmp_lg_u32 s3, 0
    s_cbranch_scc1 L_w0_122
    s_mov_b32 exec_lo, 0
    s_cmp_eq_u32 s53, 0
    s_cbranch_scc1 L_slow_123
    buffer_store_dword v33, v42, s[16:19], s59 offen
L_pub_124:
    s_mov_b32 exec_lo, -1
L_w0_122:
    s_add_u32 s5, s4, 41
    s_and_b32 s5, s5, 63
    s_lshl_b32 s5, s5, 12
    buffer_load_dwordx4 v[164:167], v2, s[12:15], s5 offen nt
    v_and_b32_dpp v16, v12, v4 quad_perm:[2,2,2,2] row_mask:0xf bank_mask:0xf
    v_and_b32_dpp v17, v12, v5 quad_perm:[2,2,2,2] row_mask:0xf bank_mask:0xf
    s_waitcnt vmcnt(5)
    s_add_u32 s5, s4, 42
    s_and_b32 s5, s5, 63
    s_lshl_b32 s5, s5, 12
    buffer_load_dwordx4 v[168:171], v2, s[12:15], s5 offen nt
    s_waitcnt vmcnt(5)
    v_smfmac_f32_16x16x64_bf16 v[24:27], v[20:23], v[144:151], v6
    v_and_b32_dpp v18, v13, v4 quad_perm:[2,2,2,2] row_mask:0xf bank_mask:0xf
    v_and_b32_dpp v19, v13, v5 quad_perm:[2,2,2,2] row_mask:0xf bank_mask:0xf
    s_add_u32 s5, s4, 43
    s_and_b32 s5, s5, 63
    s_lshl_b32 s5, s5, 12
    buffer_load_dwordx4 v[172:175], v2, s[12:15], s5 offen nt
    s_waitcnt vmcnt(5)
    s_add_u32 s5, s4, 44
    s_and_b32 s5, s5, 63
    s_lshl_b32 s5, s5, 12
    buffer_load_dwordx4 v[176:179], v2, s[12:15], s5 offen nt
    s_waitcnt vmcnt(5)
    v_smfmac_f32_16x16x64_bf16 v[28:31], v[20:23], v[152:159], v6
    v_and_b32_dpp v20, v12, v4 quad_perm:[3,3,3,3] row_mask:0xf bank_mask:0xf
    v_and_b32_dpp v21, v12, v5 quad_perm:[3,3,3,3] row_mask:0xf bank_mask:0xf
    s_add_u32 s5, s4, 45
    s_and_b32 s5, s5, 63
    s_lshl_b32 s5, s5, 12
    buffer_load_dwordx4 v[180:183], v2, s[12:15], s5 offen nt
    s_waitcnt vmcnt(5)
    s_add_u32 s5, s4, 46
    s_and_b32 s5, s5, 63
    s_lshl_b32 s5, s5, 12
    buffer_load_dwordx4 v[184:187], v2, s[12:15], s5 offen nt
    s_waitcnt vmcnt(5)
    v_smfmac_f32_16x16x64_bf16 v[24:27], v[16:19], v[160:167], v6
    v_and_b32_dpp v22, v13, v4 quad_perm:[3,3,3,3] row_mask:0xf bank_mask:0xf
    v_and_b32_dpp v23, v13, v5 quad_perm:[3,3,3,3] row_mask:0xf bank_mask:0xf
    s_add_u32 s5, s4, 47
    s_and_b32 s5, s5, 63
    s_lshl_b32 s5, s5, 12
    buffer_load_dwordx4 v[188:191], v2, s[12:15], s5 offen nt
    s_waitcnt vmcnt(5)
    s_add_u32 s5, s4, 48
    s_and_b32 s5, s5, 63
    s_lshl_b32 s5, s5, 12
    buffer_load_dwordx4 v[192:195], v2, s[12:15], s5 offen nt
    s_waitcnt vmcnt(5)
    v_smfmac_f32_16x16x64_bf16 v[28:31], v[16:19], v[168:175], v6
    v_and_b32_dpp v16, v14, v4 quad_perm:[0,0,0,0] row_mask:0xf bank_mask:0xf
    v_and_b32_dpp v17, v14, v5 quad_perm:[0,0,0,0] row_mask:0xf bank_mask:0xf
    s_add_u32 s5, s4, 49
    s_and_b32 s5, s5, 63
    s_lshl_b32 s5, s5, 12
    buffer_load_dwordx4 v[196:199], v2, s[12:15], s5 offen nt
    s_waitcnt vmcnt(5)
    s_add_u32 s5, s4, 50
    s_and_b32 s5, s5, 63
    s_lshl_b32 s5, s5, 12
    buffer_load_dwordx4 v[200:203], v2, s[12:15], s5 offen nt
    s_waitcnt vmcnt(5)
    v_smfmac_f32_16x16x64_bf16 v[24:27], v[20:23], v[176:183], v6
    v_and_b32_dpp v18, v15, v4 quad_perm:[0,0,0,0] row_mask:0xf bank_mask:0xf
    v_and_b32_dpp v19, v15, v5 quad_perm:[0,0,0,0] row_mask:0xf bank_mask:0xf
    s_add_u32 s5, s4, 51
    s_and_b32 s5, s5, 63
    s_lshl_b32 s5, s5, 12
    buffer_load_dwordx4 v[204:207], v2, s[12:15], s5 offen nt
    s_waitcnt vmcnt(5)
    s_add_u32 s5, s4, 52
    s_and_b32 s5, s5, 63
    s_lshl_b32 s5, s5, 12
    buffer_load_dwordx4 v[208:211], v2, s[12:15], s5 offen nt
    s_waitcnt vmcnt(5)
    v_smfmac_f32_16x16x64_bf16 v[28:31], v[20:23], v[184:191], v6
    v_and_b32 v32, 7, v0
    v_mul_u32_u24 v32, 640, v32
    s_lshr_b32 s62, s52, 3
    s_mul_i32 s62, s62, 5120
    s_add_u32 s62, s62, 0
    buffer_load_dwordx4 v[36:39], v32, s[16:19], s62 offen offset:512 sc1
    s_add_u32 s5, s4, 53
    s_and_b32 s5, s5, 63
    s_lshl_b32 s5, s5, 12
    buffer_load_dwordx4 v[212:215], v2, s[12:15], s5 offen nt
    s_waitcnt vmcnt(6)
    s_add_u32 s5, s4, 54
    s_and_b32 s5, s5, 63
    s_lshl_b32 s5, s5, 12
    buffer_load_dwordx4 v[216:219], v2, s[12:15], s5 offen nt
    s_waitcnt vmcnt(6)
    s_add_u32 s5, s4, 55
    s_and_b32 s5, s5, 63
    s_lshl_b32 s5, s5, 12
    buffer_load_dwordx4 v[220:223], v2, s[12:15], s5 offen nt
    s_waitcnt vmcnt(6)
    s_add_u32 s5, s4, 56
    s_and_b32 s5, s5, 63
    s_lshl_b32 s5, s5, 12
    buffer_load_dwordx4 v[224:227], v2, s[12:15], s5 offen nt
    s_waitcnt vmcnt(6)
    s_add_u32 s5, s4, 57
    s_and_b32 s5, s5, 63
    s_lshl_b32 s5, s5, 12
    buffer_load_dwordx4 v[228:231], v2, s[12:15], s5 offen nt
    s_waitcnt vmcnt(5)
    v_xor_b32 v36, s48, v36
    v_xor_b32 v37, s49, v37
    v_xor_b32 v38, s50, v38
    v_xor_b32 v39, s51, v39
    v_or3_b32 v33, v36, v37, v38
    v_or_b32 v33, v33, v39
    v_and_b32 v33, 0xff, v33
    v_cmp_ne_u32 vcc, 0, v33
    s_cbranch_vccnz L_retry_125
L_ok_128:
    v_lshrrev_b32 v38, 8, v38
    v_or_b32 v36, v36, v38
    s_nop 1
    v_max_f32_dpp v33, v36, v36 quad_perm:[1,0,3,2] row_mask:0xf bank_mask:0xf
    s_nop 1
    v_max_f32_dpp v33, v33, v33 quad_perm:[2,3,0,1] row_mask:0xf bank_mask:0xf
    s_nop 1
    v_max_f32_dpp v33, v33, v33 row_half_mirror row_mask:0xf bank_mask:0xf
    v_sub_f32 v36, v36, v33
    v_exp_f32 v36, v36
    v_sub_f32 v33, s61, v33
    v_mul_f32 v37, v36, v37
    v_exp_f32 v33, v33
    s_nop 0
    v_add_f32_dpp v37, v37, v37 quad_perm:[1,0,3,2] row_mask:0xf bank_mask:0xf
    s_nop 1
    v_add_f32_dpp v37, v37, v37 quad_perm:[2,3,0,1] row_mask:0xf bank_mask:0xf
    s_nop 1
    v_add_f32_dpp v37, v37, v37 row_half_mirror row_mask:0xf bank_mask:0xf
    v_rcp_f32 v37, v37
    s_nop 0
    v_mul_f32 v34, v33, v37
    v_and_b32_dpp v20, v14, v4 quad_perm:[1,1,1,1] row_mask:0xf bank_mask:0xf
    v_and_b32_dpp v21, v14, v5 quad_perm:[1,1,1,1] row_mask:0xf bank_mask:0xf
    v_smfmac_f32_16x16x64_bf16 v[24:27], v[16:19], v[192:199], v6
    v_and_b32_dpp v22, v15, v4 quad_perm:[1,1,1,1] row_mask:0xf bank_mask:0xf
    v_and_b32_dpp v23, v15, v5 quad_perm:[1,1,1,1] row_mask:0xf bank_mask:0xf
    v_smfmac_f32_16x16x64_bf16 v[28:31], v[16:19], v[200:207], v6
    s_add_u32 s5, s4, 58
    s_and_b32 s5, s5, 63
    s_lshl_b32 s5, s5, 12
    buffer_load_dwordx4 v[232:235], v2, s[12:15], s5 offen nt
    v_and_b32_dpp v16, v14, v4 quad_perm:[2,2,2,2] row_mask:0xf bank_mask:0xf
    v_and_b32_dpp v17, v14, v5 quad_perm:[2,2,2,2] row_mask:0xf bank_mask:0xf
    s_waitcnt vmcnt(5)
    v_smfmac_f32_16x16x64_bf16 v[24:27], v[20:23], v[208:215], v6
    v_and_b32_dpp v18, v15, v4 quad_perm:[2,2,2,2] row_mask:0xf bank_mask:0xf
    v_and_b32_dpp v19, v15, v5 quad_perm:[2,2,2,2] row_mask:0xf bank_mask:0xf
    s_add_u32 s5, s4, 59
    s_and_b32 s5, s5, 63
    s_lshl_b32 s5, s5, 12
    buffer_load_dwordx4 v[236:239], v2, s[12:15], s5 offen nt
    s_waitcnt vmcnt(5)
    s_add_u32 s5, s4, 60
    s_and_b32 s5, s5, 63
    s_lshl_b32 s5, s5, 12
    buffer_load_dwordx4 v[240:243], v2, s[12:15], s5 offen nt
    s_waitcnt vmcnt(5)
    v_smfmac_f32_16x16x64_bf16 v[28:31], v[20:23], v[216:223], v6
    v_and_b32_dpp v20, v14, v4 quad_perm:[3,3,3,3] row_mask:0xf bank_mask:0xf
    v_and_b32_dpp v21, v14, v5 quad_perm:[3,3,3,3] row_mask:0xf bank_mask:0xf
    s_add_u32 s5, s4, 61
    s_and_b32 s5, s5, 63
    s_lshl_b32 s5, s5, 12
    buffer_load_dwordx4 v[244:247], v2, s[12:15], s5 offen nt
    s_waitcnt vmcnt(5)
    s_add_u32 s5, s4, 62
    s_and_b32 s5, s5, 63
    s_lshl_b32 s5, s5, 12
    buffer_load_dwordx4 v[248:251], v2, s[12:15], s5 offen nt
    s_waitcnt vmcnt(5)
    v_smfmac_f32_16x16x64_bf16 v[24:27], v[16:19], v[224:231], v6
    v_and_b32_dpp v22, v15, v4 quad_perm:[3,3,3,3] row_mask:0xf bank_mask:0xf
    v_and_b32_dpp v23, v15, v5 quad_perm:[3,3,3,3] row_mask:0xf bank_mask:0xf
    s_add_u32 s5, s4, 63
    s_and_b32 s5, s5, 63
    s_lshl_b32 s5, s5, 12
    buffer_load_dwordx4 v[252:255], v2, s[12:15], s5 offen nt
    s_waitcnt vmcnt(4)
    v_smfmac_f32_16x16x64_bf16 v[28:31], v[16:19], v[232:239], v6
    s_waitcnt vmcnt(2)
    v_smfmac_f32_16x16x64_bf16 v[24:27], v[20:23], v[240:247], v6
    s_waitcnt vmcnt(0)
    v_smfmac_f32_16x16x64_bf16 v[28:31], v[20:23], v[248:255], v6
L_tail:
    s_nop 7
    v_cndmask_b32_e64 v24, v24, v28, s[64:65]
    v_cndmask_b32_e64 v25, v25, v29, s[64:65]
    v_cndmask_b32_e64 v26, v26, v30, s[64:65]
    v_cndmask_b32_e64 v27, v27, v31, s[64:65]
    s_nop 0
    v_permlane32_swap_b32 v24, v26
    v_permlane32_swap_b32 v25, v27
    v_add_f32 v24, v24, v26
    v_add_f32 v25, v25, v27
    v_mul_f32 v24, v24, v34
    v_mul_f32 v25, v25, v34
    ds_write_b64 v40, v[24:25] offset:0
    s_waitcnt lgkmcnt(0)
    s_barrier
    s_mov_b32 exec_hi, 0
    ds_read_b32 v16, v41 offset:0
    ds_read_b32 v17, v41 offset:512
    ds_read_b32 v18, v41 offset:1024
    ds_read_b32 v19, v41 offset:1536
    s_waitcnt lgkmcnt(0)
    v_add_f32 v16, v16, v17
    v_add_f32 v18, v18, v19
    v_add_f32 v23, v16, v18
    v_bfi_b32 v23, s87, v35, v23
    s_cmp_eq_u32 s53, 0
    s_cbranch_scc1 L_slow_129
    buffer_store_dword v23, v41, s[16:19], s59 offen
L_pub_130:
    s_mov_b32 exec_hi, -1
    s_cmp_lg_u32 s1, 0
    s_cbranch_scc1 L_odd_163
    buffer_load_dwordx4 v[8:11], v45, s[16:19], s60 offen offset:0 sc1
    buffer_load_dwordx4 v[12:15], v45, s[16:19], s60 offen offset:1280 sc1
    buffer_load_dwordx4 v[16:19], v45, s[16:19], s60 offen offset:2560 sc1
    buffer_load_dwordx4 v[20:23], v45, s[16:19], s60 offen offset:3840 sc1
    v_and_b32 v30, 48, v0
    v_lshl_add_u32 v32, s3, 8, v30
    v_lshl_add_u32 v33, s3, 7, v30
    v_lshlrev_b32 v34, 2, v0
    s_add_u32 s59, s26, 32768
    s_waitcnt vmcnt(3)
    v_xor_b32 v8, s48, v8
    v_xor_b32 v9, s49, v9
    v_xor_b32 v10, s50, v10
    v_xor_b32 v11, s51, v11
    v_or3_b32 v28, v8, v9, v10
    v_or_b32 v28, v28, v11
    s_waitcnt vmcnt(2)
    v_xor_b32 v12, s48, v12
    v_xor_b32 v13, s49, v13
    v_xor_b32 v14, s50, v14
    v_xor_b32 v15, s51, v15
    v_or3_b32 v28, v28, v12, v13
    v_or3_b32 v28, v28, v14, v15
    s_waitcnt vmcnt(1)
    v_xor_b32 v16, s48, v16
    v_xor_b32 v17, s49, v17
    v_xor_b32 v18, s50, v18
    v_xor_b32 v19, s51, v19
    v_or3_b32 v28, v28, v16, v17
    v_or3_b32 v28, v28, v18, v19
    s_waitcnt vmcnt(0)
    v_xor_b32 v20, s48, v20
    v_xor_b32 v21, s49, v21
    v_xor_b32 v22, s50, v22
    v_xor_b32 v23, s51, v23
    v_or3_b32 v28, v28, v20, v21
    v_or3_b32 v28, v28, v22, v23
    v_and_b32 v28, 0xff, v28
    v_cmp_ne_u32 vcc, 0, v28
    s_cbranch_vccnz L_retry_131
L_ok_134:
    v_pk_add_f32 v[8:9], v[8:9], v[12:13]
    v_pk_add_f32 v[16:17], v[16:17], v[20:21]
    v_pk_add_f32 v[10:11], v[10:11], v[14:15]
    v_pk_add_f32 v[18:19], v[18:19], v[22:23]
    v_add_f32 v36, v8, v16
    v_add_f32 v37, v9, v17
    v_add_f32 v38, v10, v18
    v_add_f32 v39, v11, v19
    s_nop 0
    v_permlane32_swap_b32 v36, v38
    v_permlane32_swap_b32 v37, v39
    v_add_f32 v36, v36, v38
    v_add_f32 v37, v37, v39
    v_cvt_pk_bf16_f32 v36, v36, v37
    ds_write_b32 v47, v36 offset:2624
    ds_read_b128 v[8:11], v32 offset:2624
    ds_read_b128 v[12:15], v32 offset:2688
    ds_read_b128 v[16:19], v32 offset:2752
    ds_read_b128 v[20:23], v32 offset:2816
    s_waitcnt lgkmcnt(3)
    v_mfma_f32_16x16x32_bf16 v[24:27], v[48:51], v[8:11], 0
    v_mfma_f32_16x16x32_bf16 v[28:31], v[64:67], v[8:11], 0
    s_waitcnt lgkmcnt(2)
    v_mfma_f32_16x16x32_bf16 v[24:27], v[52:55], v[12:15], v[24:27]
    v_mfma_f32_16x16x32_bf16 v[28:31], v[68:71], v[12:15], v[28:31]
    s_waitcnt lgkmcnt(1)
    v_mfma_f32_16x16x32_bf16 v[24:27], v[56:59], v[16:19], v[24:27]
    v_mfma_f32_16x16x32_bf16 v[28:31], v[72:75], v[16:19], v[28:31]
    s_waitcnt lgkmcnt(0)
    v_mfma_f32_16x16x32_bf16 v[24:27], v[60:63], v[20:23], v[24:27]
    v_mfma_f32_16x16x32_bf16 v[28:31], v[76:79], v[20:23], v[28:31]
    s_mov_b32 exec_lo, 0x00010001
    s_mov_b32 exec_hi, 0x00010001
    s_nop 4
    ds_write_b128 v33, v[24:27] offset:2112
    ds_write_b128 v33, v[28:31] offset:2176
    s_mov_b64 exec, -1
    s_xor_b32 s57, s86, 1799596466
    s_waitcnt lgkmcnt(0)
    s_barrier
    v_mov_b32 v31, s57
    s_cmp_lg_u32 s3, 0
    s_cbranch_scc1 L_w0_135
    s_mov_b32 exec_hi, 0
    ds_read_b32 v10, v34 offset:2112
    ds_read_b32 v11, v34 offset:2240
    ds_read_b32 v12, v34 offset:2368
    ds_read_b32 v13, v34 offset:2496
    s_waitcnt lgkmcnt(0)
    v_add_f32 v10, v10, v11
    v_add_f32 v12, v12, v13
    v_add_f32 v10, v10, v12
    v_bfi_b32 v10, s87, v35, v10
    buffer_store_dword v10, v34, s[16:19], s59 offen sc1
    s_cmp_eq_u32 s53, 0
    s_cbranch_scc1 L_slow_136
    buffer_store_dword v31, v34, s[16:19], s63 offen
L_pub_137:
    s_mov_b32 exec_hi, -1
L_w0_135:
    s_add_u32 s48, s90, 1
    s_and_b32 s48, s48, 0xff
    s_add_u32 s49, s90, 54
    s_and_b32 s49, s49, 0xff
    s_add_u32 s50, s90, 107
    s_and_b32 s50, s50, 0xff
    s_add_u32 s51, s90, 160
    s_and_b32 s51, s51, 0xff
    v_add3_u32 v35, v43, s90, 1
    s_add_u32 s60, s25, 163840
    s_waitcnt lgkmcnt(0)
    s_barrier
    buffer_load_dwordx4 v[24:27], v46, s[16:19], s60 offen offset:512 sc1
    buffer_load_dwordx4 v[8:11], v45, s[16:19], s60 offen offset:0 sc1
    buffer_load_dwordx4 v[12:15], v45, s[16:19], s60 offen offset:1280 sc1
    buffer_load_dwordx4 v[16:19], v45, s[16:19], s60 offen offset:2560 sc1
    buffer_load_dwordx4 v[20:23], v45, s[16:19], s60 offen offset:3840 sc1
    v_and_b32 v30, 48, v0
    v_lshl_add_u32 v32, s3, 8, v30
    v_lshl_add_u32 v33, s3, 7, v30
    v_lshlrev_b32 v34, 2, v0
    s_add_u32 s59, s26, 16384
    s_waitcnt vmcnt(4)
    v_xor_b32 v24, s48, v24
    v_xor_b32 v25, s49, v25
    v_xor_b32 v26, s50, v26
    v_xor_b32 v27, s51, v27
    v_or3_b32 v28, v24, v25, v26
    v_or_b32 v28, v28, v27
    s_waitcnt vmcnt(3)
    v_xor_b32 v8, s48, v8
    v_xor_b32 v9, s49, v9
    v_xor_b32 v10, s50, v10
    v_xor_b32 v11, s51, v11
    v_or3_b32 v28, v28, v8, v9
    v_or3_b32 v28, v28, v10, v11
    s_waitcnt vmcnt(2)
    v_xor_b32 v12, s48, v12
    v_xor_b32 v13, s49, v13
    v_xor_b32 v14, s50, v14
    v_xor_b32 v15, s51, v15
    v_or3_b32 v28, v28, v12, v13
    v_or3_b32 v28, v28, v14, v15
    s_waitcnt vmcnt(1)
    v_xor_b32 v16, s48, v16
    v_xor_b32 v17, s49, v17
    v_xor_b32 v18, s50, v18
    v_xor_b32 v19, s51, v19
    v_or3_b32 v28, v28, v16, v17
    v_or3_b32 v28, v28, v18, v19
    s_waitcnt vmcnt(0)
    v_xor_b32 v20, s48, v20
    v_xor_b32 v21, s49, v21
    v_xor_b32 v22, s50, v22
    v_xor_b32 v23, s51, v23
    v_or3_b32 v28, v28, v20, v21
    v_or3_b32 v28, v28, v22, v23
    v_and_b32 v28, 0xff, v28
    v_cmp_ne_u32 vcc, 0, v28
    s_cbranch_vccnz L_retry_138
L_ok_141:
    v_lshrrev_b32 v26, 8, v26
    v_or_b32 v24, v24, v26
    s_nop 1
    v_max_f32_dpp v28, v24, v24 quad_perm:[1,0,3,2] row_mask:0xf bank_mask:0xf
    s_nop 1
    v_max_f32_dpp v28, v28, v28 quad_perm:[2,3,0,1] row_mask:0xf bank_mask:0xf
    s_nop 1
    v_max_f32_dpp v28, v28, v28 row_half_mirror row_mask:0xf bank_mask:0xf
    v_sub_f32 v24, v24, v28
    v_exp_f32 v24, v24
    s_nop 0
    v_mul_f32 v25, v24, v25
    v_mul_f32_dpp v36, v24, v8 row_newbcast:0 row_mask:0xf bank_mask:0xf
    v_mul_f32_dpp v37, v24, v9 row_newbcast:0 row_mask:0xf bank_mask:0xf
    v_mul_f32_dpp v38, v24, v10 row_newbcast:0 row_mask:0xf bank_mask:0xf
    v_mul_f32_dpp v39, v24, v11 row_newbcast:0 row_mask:0xf bank_mask:0xf
    v_add_f32_dpp v25, v25, v25 quad_perm:[1,0,3,2] row_mask:0xf bank_mask:0xf
    v_fmac_f32_dpp v36, v24, v12 row_newbcast:2 row_mask:0xf bank_mask:0xf
    v_fmac_f32_dpp v37, v24, v13 row_newbcast:2 row_mask:0xf bank_mask:0xf
    v_fmac_f32_dpp v38, v24, v14 row_newbcast:2 row_mask:0xf bank_mask:0xf
    v_fmac_f32_dpp v39, v24, v15 row_newbcast:2 row_mask:0xf bank_mask:0xf
    v_add_f32_dpp v25, v25, v25 quad_perm:[2,3,0,1] row_mask:0xf bank_mask:0xf
    v_fmac_f32_dpp v36, v24, v16 row_newbcast:4 row_mask:0xf bank_mask:0xf
    v_fmac_f32_dpp v37, v24, v17 row_newbcast:4 row_mask:0xf bank_mask:0xf
    v_fmac_f32_dpp v38, v24, v18 row_newbcast:4 row_mask:0xf bank_mask:0xf
    v_fmac_f32_dpp v39, v24, v19 row_newbcast:4 row_mask:0xf bank_mask:0xf
    v_add_f32_dpp v25, v25, v25 row_half_mirror row_mask:0xf bank_mask:0xf
    v_fmac_f32_dpp v36, v24, v20 row_newbcast:6 row_mask:0xf bank_mask:0xf
    v_fmac_f32_dpp v37, v24, v21 row_newbcast:6 row_mask:0xf bank_mask:0xf
    v_fmac_f32_dpp v38, v24, v22 row_newbcast:6 row_mask:0xf bank_mask:0xf
    v_fmac_f32_dpp v39, v24, v23 row_newbcast:6 row_mask:0xf bank_mask:0xf
    v_rcp_f32 v25, v25
    v_permlane32_swap_b32 v36, v38
    v_permlane32_swap_b32 v37, v39
    v_add_f32 v36, v36, v38
    v_add_f32 v37, v37, v39
    v_mul_f32 v36, v36, v25
    v_mul_f32 v37, v37, v25
    v_cvt_pk_bf16_f32 v36, v36, v37
    ds_write_b32 v47, v36 offset:2624
    ds_read_b128 v[8:11], v32 offset:2624
    ds_read_b128 v[12:15], v32 offset:2688
    ds_read_b128 v[16:19], v32 offset:2752
    ds_read_b128 v[20:23], v32 offset:2816
    s_waitcnt lgkmcnt(3)
    v_mfma_f32_16x16x32_bf16 v[24:27], v[48:51], v[8:11], 0
    v_mfma_f32_16x16x32_bf16 v[28:31], v[64:67], v[8:11], 0
    s_waitcnt lgkmcnt(2)
    v_mfma_f32_16x16x32_bf16 v[24:27], v[52:55], v[12:15], v[24:27]
    v_mfma_f32_16x16x32_bf16 v[28:31], v[68:71], v[12:15], v[28:31]
    s_waitcnt lgkmcnt(1)
    v_mfma_f32_16x16x32_bf16 v[24:27], v[56:59], v[16:19], v[24:27]
    v_mfma_f32_16x16x32_bf16 v[28:31], v[72:75], v[16:19], v[28:31]
    s_waitcnt lgkmcnt(0)
    v_mfma_f32_16x16x32_bf16 v[24:27], v[60:63], v[20:23], v[24:27]
    v_mfma_f32_16x16x32_bf16 v[28:31], v[76:79], v[20:23], v[28:31]
    s_mov_b32 exec_lo, 0x00010001
    s_mov_b32 exec_hi, 0x00010001
    s_nop 4
    ds_write_b128 v33, v[24:27] offset:2112
    ds_write_b128 v33, v[28:31] offset:2176
    s_mov_b64 exec, -1
    s_xor_b32 s57, s86, 1799596465
    s_waitcnt lgkmcnt(0)
    s_barrier
    v_mov_b32 v31, s57
    s_cmp_lg_u32 s3, 0
    s_cbranch_scc1 L_w0_142
    s_mov_b32 exec_hi, 0
    ds_read_b32 v10, v34 offset:2112
    ds_read_b32 v11, v34 offset:2240
    ds_read_b32 v12, v34 offset:2368
    ds_read_b32 v13, v34 offset:2496
    s_waitcnt lgkmcnt(0)
    v_add_f32 v10, v10, v11
    v_add_f32 v12, v12, v13
    v_add_f32 v10, v10, v12
    v_bfi_b32 v10, s87, v35, v10
    buffer_store_dword v10, v34, s[16:19], s59 offen sc1
    s_mov_b32 exec_hi, -1
L_w0_142:
    s_branch L_join_164
L_odd_163:
    v_lshrrev_b32 v37, 1, v46
    buffer_load_dword v24, v37, s[20:23], 0 offen offset:1024
    s_mov_b32 s61, 491520
    v_lshlrev_b32 v7, 4, v0
    s_lshl_b32 s59, s3, 13
    s_add_u32 s59, s59, 528384
    s_add_u32 m0, s54, 20480
    s_add_u32 s60, s59, 0
    buffer_load_dwordx4 v7, s[16:19], s60 offen sc1 lds
    s_add_u32 m0, s54, 21504
    s_add_u32 s60, s59, 1024
    buffer_load_dwordx4 v7, s[16:19], s60 offen sc1 lds
    s_add_u32 m0, s54, 22528
    s_add_u32 s60, s59, 2048
    buffer_load_dwordx4 v7, s[16:19], s60 offen sc1 lds
    s_add_u32 m0, s54, 23552
    s_add_u32 s60, s59, 3072
    buffer_load_dwordx4 v7, s[16:19], s60 offen sc1 lds
    s_add_u32 m0, s54, 24576
    s_add_u32 s60, s59, 4096
    buffer_load_dwordx4 v7, s[16:19], s60 offen sc1 lds
    s_add_u32 m0, s54, 25600
    s_add_u32 s60, s59, 5120
    buffer_load_dwordx4 v7, s[16:19], s60 offen sc1 lds
    s_add_u32 m0, s54, 26624
    s_add_u32 s60, s59, 6144
    buffer_load_dwordx4 v7, s[16:19], s60 offen sc1 lds
    s_add_u32 m0, s54, 27648
    s_add_u32 s60, s59, 7168
    buffer_load_dwordx4 v7, s[16:19], s60 offen sc1 lds
    s_xor_b32 s59, s86, 1799596466
    buffer_load_dword v33, off, s[16:19], s63 sc1
    s_branch L_page_143
L_retry_118:
    s_mov_b32 s57, 524288
L_rloop_119:
    s_mov_b64 exec, vcc
    buffer_load_dwordx4 v[8:11], v44, s[16:19], s60 offen offset:0 sc1
    buffer_load_dwordx4 v[12:15], v44, s[16:19], s60 offen offset:16 sc1
    s_waitcnt vmcnt(1)
    v_xor_b32 v8, s28, v8
    v_xor_b32 v9, s29, v9
    v_xor_b32 v10, s30, v10
    v_xor_b32 v11, s31, v11
    v_or3_b32 v25, v8, v9, v10
    v_or_b32 v25, v25, v11
    s_waitcnt vmcnt(0)
    v_xor_b32 v12, s28, v12
    v_xor_b32 v13, s29, v13
    v_xor_b32 v14, s30, v14
    v_xor_b32 v15, s31, v15
    v_or3_b32 v25, v25, v12, v13
    v_or3_b32 v25, v25, v14, v15
    v_and_b32 v25, 0xff, v25
    v_cmp_ne_u32 vcc, 0, v25
    s_cbranch_vccz L_rdone_120
    s_sub_u32 s57, s57, 1
    s_cmp_lg_u32 s57, 0
    s_cbranch_scc1 L_rloop_119
L_rdone_120:
    s_mov_b64 exec, -1
    s_branch L_ok_121
L_slow_123:
    buffer_store_dword v33, v42, s[16:19], s59 offen sc1
    s_branch L_pub_124
L_retry_125:
    s_mov_b32 s57, 524288
L_rloop_126:
    s_mov_b64 exec, vcc
    buffer_load_dwordx4 v[36:39], v32, s[16:19], s62 offen offset:512 sc1
    s_waitcnt vmcnt(0)
    v_xor_b32 v36, s48, v36
    v_xor_b32 v37, s49, v37
    v_xor_b32 v38, s50, v38
    v_xor_b32 v39, s51, v39
    v_or3_b32 v33, v36, v37, v38
    v_or_b32 v33, v33, v39
    v_and_b32 v33, 0xff, v33
    v_cmp_ne_u32 vcc, 0, v33
    s_cbranch_vccz L_rdone_127
    s_sub_u32 s57, s57, 1
    s_cmp_lg_u32 s57, 0
    s_cbranch_scc1 L_rloop_126
L_rdone_127:
    s_mov_b64 exec, -1
    s_branch L_ok_128
L_slow_129:
    buffer_store_dword v23, v41, s[16:19], s59 offen sc1
    s_branch L_pub_130
L_retry_131:
    s_mov_b32 s57, 524288
L_rloop_132:
    s_mov_b64 exec, vcc
    buffer_load_dwordx4 v[8:11], v45, s[16:19], s60 offen offset:0 sc1
    buffer_load_dwordx4 v[12:15], v45, s[16:19], s60 offen offset:1280 sc1
    buffer_load_dwordx4 v[16:19], v45, s[16:19], s60 offen offset:2560 sc1
    buffer_load_dwordx4 v[20:23], v45, s[16:19], s60 offen offset:3840 sc1
    s_waitcnt vmcnt(3)
    v_xor_b32 v8, s48, v8
    v_xor_b32 v9, s49, v9
    v_xor_b32 v10, s50, v10
    v_xor_b32 v11, s51, v11
    v_or3_b32 v28, v8, v9, v10
    v_or_b32 v28, v28, v11
    s_waitcnt vmcnt(2)
    v_xor_b32 v12, s48, v12
    v_xor_b32 v13, s49, v13
    v_xor_b32 v14, s50, v14
    v_xor_b32 v15, s51, v15
    v_or3_b32 v28, v28, v12, v13
    v_or3_b32 v28, v28, v14, v15
    s_waitcnt vmcnt(1)
    v_xor_b32 v16, s48, v16
    v_xor_b32 v17, s49, v17
    v_xor_b32 v18, s50, v18
    v_xor_b32 v19, s51, v19
    v_or3_b32 v28, v28, v16, v17
    v_or3_b32 v28, v28, v18, v19
    s_waitcnt vmcnt(0)
    v_xor_b32 v20, s48, v20
    v_xor_b32 v21, s49, v21
    v_xor_b32 v22, s50, v22
    v_xor_b32 v23, s51, v23
    v_or3_b32 v28, v28, v20, v21
    v_or3_b32 v28, v28, v22, v23
    v_and_b32 v28, 0xff, v28
    v_cmp_ne_u32 vcc, 0, v28
    s_cbranch_vccz L_rdone_133
    s_sub_u32 s57, s57, 1
    s_cmp_lg_u32 s57, 0
    s_cbranch_scc1 L_rloop_132
L_rdone_133:
    s_mov_b64 exec, -1
    s_branch L_ok_134
L_slow_136:
    buffer_store_dword v31, v34, s[16:19], s63 offen sc1
    s_branch L_pub_137
L_retry_138:
    s_mov_b32 s57, 524288
L_rloop_139:
    s_mov_b64 exec, vcc
    buffer_load_dwordx4 v[24:27], v46, s[16:19], s60 offen offset:512 sc1
    buffer_load_dwordx4 v[8:11], v45, s[16:19], s60 offen offset:0 sc1
    buffer_load_dwordx4 v[12:15], v45, s[16:19], s60 offen offset:1280 sc1
    buffer_load_dwordx4 v[16:19], v45, s[16:19], s60 offen offset:2560 sc1
    buffer_load_dwordx4 v[20:23], v45, s[16:19], s60 offen offset:3840 sc1
    s_waitcnt vmcnt(4)
    v_xor_b32 v24, s48, v24
    v_xor_b32 v25, s49, v25
    v_xor_b32 v26, s50, v26
    v_xor_b32 v27, s51, v27
    v_or3_b32 v28, v24, v25, v26
    v_or_b32 v28, v28, v27
    s_waitcnt vmcnt(3)
    v_xor_b32 v8, s48, v8
    v_xor_b32 v9, s49, v9
    v_xor_b32 v10, s50, v10
    v_xor_b32 v11, s51, v11
    v_or3_b32 v28, v28, v8, v9
    v_or3_b32 v28, v28, v10, v11
    s_waitcnt vmcnt(2)
    v_xor_b32 v12, s48, v12
    v_xor_b32 v13, s49, v13
    v_xor_b32 v14, s50, v14
    v_xor_b32 v15, s51, v15
    v_or3_b32 v28, v28, v12, v13
    v_or3_b32 v28, v28, v14, v15
    s_waitcnt vmcnt(1)
    v_xor_b32 v16, s48, v16
    v_xor_b32 v17, s49, v17
    v_xor_b32 v18, s50, v18
    v_xor_b32 v19, s51, v19
    v_or3_b32 v28, v28, v16, v17
    v_or3_b32 v28, v28, v18, v19
    s_waitcnt vmcnt(0)
    v_xor_b32 v20, s48, v20
    v_xor_b32 v21, s49, v21
    v_xor_b32 v22, s50, v22
    v_xor_b32 v23, s51, v23
    v_or3_b32 v28, v28, v20, v21
    v_or3_b32 v28, v28, v22, v23
    v_and_b32 v28, 0xff, v28
    v_cmp_ne_u32 vcc, 0, v28
    s_cbranch_vccz L_rdone_140
    s_sub_u32 s57, s57, 1
    s_cmp_lg_u32 s57, 0
    s_cbranch_scc1 L_rloop_139
L_rdone_140:
    s_mov_b64 exec, -1
    s_branch L_ok_141
.p2align 12
L_page_143:
    s_waitcnt vmcnt(0)
    v_cmp_ne_u32 vcc, s59, v33
    s_cbranch_vccnz L_retry_144
L_ok_147:
    s_add_u32 s60, s61, 0
    buffer_load_dwordx4 v[8:11], v45, s[16:19], s60 offen sc1
    s_add_u32 s60, s61, 4096
    buffer_load_dwordx4 v[12:15], v45, s[16:19], s60 offen sc1
    s_add_u32 s60, s61, 8192
    buffer_load_dwordx4 v[16:19], v45, s[16:19], s60 offen sc1
    s_add_u32 s60, s61, 12288
    buffer_load_dwordx4 v[20:23], v45, s[16:19], s60 offen sc1
    v_lshlrev_b32_e64 v34, 3, s3
    v_mov_b32 v39, 0
    v_mov_b32 v38, 0x3f800054
    v_and_b32 v32, 511, v46
    v_add3_u32 v35, v43, s90, 3
    s_bfe_u32 s59, s7, 0x20001
    s_cmp_eq_u32 s59, s3
    s_cselect_b64 s[84:85], -1, 0
    v_and_b32 v25, 0xffff0000, v24
    v_lshlrev_b32 v24, 16, v24
    s_waitcnt vmcnt(3)
    v_xor_b32 v8, s48, v8
    v_xor_b32 v9, s49, v9
    v_xor_b32 v10, s50, v10
    v_xor_b32 v11, s51, v11
    v_or3_b32 v33, v8, v9, v10
    v_or_b32 v33, v33, v11
    s_waitcnt vmcnt(2)
    v_xor_b32 v12, s48, v12
    v_xor_b32 v13, s49, v13
    v_xor_b32 v14, s50, v14
    v_xor_b32 v15, s51, v15
    v_or3_b32 v33, v33, v12, v13
    v_or3_b32 v33, v33, v14, v15
    s_waitcnt vmcnt(1)
    v_xor_b32 v16, s48, v16
    v_xor_b32 v17, s49, v17
    v_xor_b32 v18, s50, v18
    v_xor_b32 v19, s51, v19
    v_or3_b32 v33, v33, v16, v17
    v_or3_b32 v33, v33, v18, v19
    s_waitcnt vmcnt(0)
    v_xor_b32 v20, s48, v20
    v_xor_b32 v21, s49, v21
    v_xor_b32 v22, s50, v22
    v_xor_b32 v23, s51, v23
    v_or3_b32 v33, v33, v20, v21
    v_or3_b32 v33, v33, v22, v23
    v_and_b32 v33, 0xff, v33
    v_cmp_ne_u32 vcc, 0, v33
    s_cbranch_vccnz L_retry_148
L_ok_151:
    v_pk_add_f32 v[8:9], v[8:9], v[12:13]
    v_pk_add_f32 v[16:17], v[16:17], v[20:21]
    v_pk_add_f32 v[10:11], v[10:11], v[14:15]
    v_pk_add_f32 v[18:19], v[18:19], v[22:23]
    v_add_f32 v8, v8, v16
    v_add_f32 v9, v9, v17
    v_add_f32 v10, v10, v18
    v_add_f32 v11, v11, v19
    s_nop 0
    v_permlane32_swap_b32 v8, v10
    v_permlane32_swap_b32 v9, v11
    v_add_f32 v8, v8, v10
    v_add_f32 v9, v9, v11
    v_add_f32 v24, v24, v8
    v_add_f32 v25, v25, v9
    v_add_f32 v26, v24, v25
    v_mul_f32 v27, v24, v24
    v_fmac_f32 v27, v25, v25
    v_add_f32_dpp v26, v26, v26 quad_perm:[1,0,3,2] row_mask:0xf bank_mask:0xf
    s_nop 0
    v_add_f32_dpp v27, v27, v27 quad_perm:[1,0,3,2] row_mask:0xf bank_mask:0xf
    v_add_f32_dpp v26, v26, v26 quad_perm:[2,3,0,1] row_mask:0xf bank_mask:0xf
    s_nop 0
    v_add_f32_dpp v27, v27, v27 quad_perm:[2,3,0,1] row_mask:0xf bank_mask:0xf
    v_add_f32_dpp v26, v26, v26 row_half_mirror row_mask:0xf bank_mask:0xf
    s_nop 0
    v_add_f32_dpp v27, v27, v27 row_half_mirror row_mask:0xf bank_mask:0xf
    v_add_f32_dpp v26, v26, v26 row_mirror row_mask:0xf bank_mask:0xf
    s_nop 0
    v_add_f32_dpp v27, v27, v27 row_mirror row_mask:0xf bank_mask:0xf
    v_add_f32_dpp v26, v26, v26 row_bcast:15 row_mask:0xa bank_mask:0xf
    s_nop 0
    v_add_f32_dpp v27, v27, v27 row_bcast:15 row_mask:0xa bank_mask:0xf
    v_add_f32_dpp v26, v26, v26 row_bcast:31 row_mask:0xc bank_mask:0xf
    s_nop 0
    v_add_f32_dpp v27, v27, v27 row_bcast:31 row_mask:0xc bank_mask:0xf
    s_mov_b32 exec_lo, 0
    s_mov_b32 exec_hi, 0x80000000
    ds_write_b64 v34, v[26:27] offset:2048
    s_mov_b64 exec, -1
    s_movk_i32 s59, 0xfff
    s_mov_b32 s60, 31744
    s_waitcnt lgkmcnt(0)
    s_barrier
    ds_read_b128 v[8:11], v39 offset:2048
    ds_read_b128 v[12:15], v39 offset:2064
    s_waitcnt lgkmcnt(0)
    v_pk_add_f32 v[8:9], v[8:9], v[10:11]
    v_pk_add_f32 v[12:13], v[12:13], v[14:15]
    v_pk_add_f32 v[8:9], v[8:9], v[12:13]
    v_mul_f32 v8, 0x3b000000, v8
    v_mul_f32 v9, 0x3b000000, v9
    v_fma_f32 v9, -v8, v8, v9
    v_max_f32 v9, 0, v9
    v_fmaak_f32 v10, v9, v38, 0x2edbe6ff
    v_rsq_f32 v10, v10
    v_sub_f32 v26, v24, v8
    v_sub_f32 v27, v25, v8
    v_mul_f32 v26, v26, v10
    v_mul_f32 v27, v27, v10
    v_cvt_pk_bf16_f32 v36, v26, v27
    v_and_b32 v16, 0x7fff, v36
    v_bfe_u32 v17, v36, 16, 15
    v_bfe_u32 v18, v36, 15, 1
    v_lshrrev_b32 v19, 31, v36
    v_subrev_u32 v20, 12800, v16
    v_subrev_u32 v21, 12800, v17
    v_med3_i32 v20, v20, 0, s59
    v_med3_i32 v21, v21, 0, s59
    v_lshl_add_u32 v20, v18, 12, v20
    v_lshl_add_u32 v21, v19, 12, v21
    v_lshrrev_b32 v22, 11, v20
    v_lshlrev_b32 v20, 2, v20
    v_lshrrev_b32 v23, 11, v21
    v_lshlrev_b32 v21, 2, v21
    v_mad_u32_u24 v20, v22, s60, v20
    ds_read_b32 v28, v20 offset:24576
    v_mad_u32_u24 v21, v23, s60, v21
    ds_read_b32 v29, v21 offset:24576
    s_mov_b32 s59, 12800
    v_add_u32 v16, -1, v16
    v_add_u32 v17, -1, v17
    v_cmp_gt_u32 s[48:49], s59, v16
    v_cmp_gt_u32 s[50:51], s59, v17
    s_nop 0
    s_or_b64 vcc, s[48:49], s[50:51]
    s_waitcnt lgkmcnt(0)
    s_cbranch_vccnz L_tiny_152
L_mixed_153:
    v_add_f32 v24, v24, v28
    v_add_f32 v25, v25, v29
    s_mov_b64 exec, s[84:85]
    ds_write_b64 v32, v[24:25] offset:2112
    s_mov_b64 exec, -1
    v_add_f32 v26, v24, v25
    v_mul_f32 v27, v24, v24
    v_fmac_f32 v27, v25, v25
    v_add_f32_dpp v26, v26, v26 quad_perm:[1,0,3,2] row_mask:0xf bank_mask:0xf
    s_nop 0
    v_add_f32_dpp v27, v27, v27 quad_perm:[1,0,3,2] row_mask:0xf bank_mask:0xf
    v_add_f32_dpp v26, v26, v26 quad_perm:[2,3,0,1] row_mask:0xf bank_mask:0xf
    s_nop 0
    v_add_f32_dpp v27, v27, v27 quad_perm:[2,3,0,1] row_mask:0xf bank_mask:0xf
    v_add_f32_dpp v26, v26, v26 row_half_mirror row_mask:0xf bank_mask:0xf
    s_nop 0
    v_add_f32_dpp v27, v27, v27 row_half_mirror row_mask:0xf bank_mask:0xf
    v_add_f32_dpp v26, v26, v26 row_mirror row_mask:0xf bank_mask:0xf
    s_nop 0
    v_add_f32_dpp v27, v27, v27 row_mirror row_mask:0xf bank_mask:0xf
    v_add_f32_dpp v26, v26, v26 row_bcast:15 row_mask:0xa bank_mask:0xf
    s_nop 0
    v_add_f32_dpp v27, v27, v27 row_bcast:15 row_mask:0xa bank_mask:0xf
    v_add_f32_dpp v26, v26, v26 row_bcast:31 row_mask:0xc bank_mask:0xf
    s_nop 0
    v_add_f32_dpp v27, v27, v27 row_bcast:31 row_mask:0xc bank_mask:0xf
    s_mov_b32 exec_lo, 0
    s_mov_b32 exec_hi, 0x80000000
    ds_write_b64 v34, v[26:27] offset:2080
    s_mov_b64 exec, -1
    s_cmp_lg_u32 s2, 8
    s_cbranch_scc1 L_keep_160
    s_mov_b32 s59, 526336
    buffer_store_dwordx2 v[24:25], v46, s[16:19], s59 offen
L_keep_160:
    v_mov_b32 v28, 0
    v_mov_b32 v29, 0
    v_mov_b32 v30, 0
    v_mov_b32 v31, 0
    v_lshlrev_b32 v32, 16, v4
    v_lshlrev_b32 v33, 16, v5
    s_waitcnt lgkmcnt(0)
    s_barrier
    ds_read_b128 v[8:11], v39 offset:2080
    ds_read_b128 v[12:15], v39 offset:2096
    ds_read_b128 v[16:19], v47 offset:2112
    ds_read_b128 v[20:23], v47 offset:2128
    s_waitcnt lgkmcnt(2)
    v_pk_add_f32 v[8:9], v[8:9], v[10:11]
    v_pk_add_f32 v[12:13], v[12:13], v[14:15]
    v_pk_add_f32 v[8:9], v[8:9], v[12:13]
    v_mul_f32 v8, 0x3b000000, v8
    v_mul_f32 v9, 0x3b000000, v9
    v_fma_f32 v9, -v8, v8, v9
    v_max_f32 v9, 0, v9
    v_add_f32 v10, 0x3727c5ac, v9
    v_rsq_f32 v10, v10
    s_waitcnt lgkmcnt(0)
    v_mul_f32 v11, v8, v10
    v_fma_f32 v16, v16, v10, -v11
    v_fma_f32 v17, v17, v10, -v11
    v_fma_f32 v18, v18, v10, -v11
    v_fma_f32 v19, v19, v10, -v11
    v_fma_f32 v20, v20, v10, -v11
    v_fma_f32 v21, v21, v10, -v11
    v_fma_f32 v22, v22, v10, -v11
    v_fma_f32 v23, v23, v10, -v11
    v_cvt_pk_bf16_f32 v16, v16, v17
    v_and_b32 v8, v16, v4
    v_and_b32 v9, v16, v5
    v_and_b32 v10, v16, v32
    v_and_b32 v11, v16, v33
    v_cvt_pk_bf16_f32 v17, v18, v19
    v_and_b32 v12, v17, v4
    v_and_b32 v13, v17, v5
    v_and_b32 v14, v17, v32
    v_and_b32 v15, v17, v33
    v_smfmac_f32_16x16x64_bf16 v[28:31], v[8:11], v[48:55], v6
    v_cvt_pk_bf16_f32 v18, v20, v21
    v_and_b32 v24, v18, v4
    v_and_b32 v25, v18, v5
    v_and_b32 v26, v18, v32
    v_and_b32 v27, v18, v33
    v_smfmac_f32_16x16x64_bf16 v[28:31], v[12:15], v[56:63], v6
    v_cvt_pk_bf16_f32 v19, v22, v23
    v_and_b32 v36, v19, v4
    v_and_b32 v37, v19, v5
    v_and_b32 v38, v19, v32
    v_and_b32 v39, v19, v33
    v_smfmac_f32_16x16x64_bf16 v[28:31], v[24:27], v[64:71], v6
    s_nop 0
    v_smfmac_f32_16x16x64_bf16 v[28:31], v[36:39], v[72:79], v6
    s_mov_b32 exec_hi, 0
    s_nop 6
    ds_write_b128 v40, v[28:31] offset:0
    s_waitcnt lgkmcnt(0)
    s_barrier
    ds_read_b32 v12, v41 offset:0
    ds_read_b32 v13, v41 offset:512
    ds_read_b32 v14, v41 offset:1024
    ds_read_b32 v15, v41 offset:1536
    s_waitcnt lgkmcnt(0)
    v_add_f32 v12, v12, v13
    v_add_f32 v14, v14, v15
    v_add_f32 v12, v12, v14
    v_bfi_b32 v12, s87, v35, v12
    s_cmp_eq_u32 s53, 0
    s_cbranch_scc1 L_slow_161
    buffer_store_dword v12, v41, s[16:19], s26 offen
L_pub_162:
    s_mov_b32 exec_hi, -1
L_join_164:
    buffer_load_dwordx4 v[8:11], v44, s[16:19], s27 offen offset:0 sc1
    buffer_load_dwordx4 v[12:15], v44, s[16:19], s27 offen offset:16 sc1
    s_branch L_page_165
L_retry_144:
    s_mov_b32 s57, 524288
L_rloop_145:
    s_mov_b64 exec, vcc
    buffer_load_dword v33, off, s[16:19], s63 sc1
    s_waitcnt vmcnt(0)
    v_cmp_ne_u32 vcc, s59, v33
    s_cbranch_vccz L_rdone_146
    s_sub_u32 s57, s57, 1
    s_cmp_lg_u32 s57, 0
    s_cbranch_scc1 L_rloop_145
L_rdone_146:
    s_mov_b64 exec, -1
    s_branch L_ok_147
L_retry_148:
    s_mov_b32 s57, 524288
L_rloop_149:
    s_mov_b64 exec, vcc
    s_add_u32 s60, s61, 0
    buffer_load_dwordx4 v[8:11], v45, s[16:19], s60 offen sc1
    s_add_u32 s60, s61, 4096
    buffer_load_dwordx4 v[12:15], v45, s[16:19], s60 offen sc1
    s_add_u32 s60, s61, 8192
    buffer_load_dwordx4 v[16:19], v45, s[16:19], s60 offen sc1
    s_add_u32 s60, s61, 12288
    buffer_load_dwordx4 v[20:23], v45, s[16:19], s60 offen sc1
    s_waitcnt vmcnt(3)
    v_xor_b32 v8, s48, v8
    v_xor_b32 v9, s49, v9
    v_xor_b32 v10, s50, v10
    v_xor_b32 v11, s51, v11
    v_or3_b32 v33, v8, v9, v10
    v_or_b32 v33, v33, v11
    s_waitcnt vmcnt(2)
    v_xor_b32 v12, s48, v12
    v_xor_b32 v13, s49, v13
    v_xor_b32 v14, s50, v14
    v_xor_b32 v15, s51, v15
    v_or3_b32 v33, v33, v12, v13
    v_or3_b32 v33, v33, v14, v15
    s_waitcnt vmcnt(1)
    v_xor_b32 v16, s48, v16
    v_xor_b32 v17, s49, v17
    v_xor_b32 v18, s50, v18
    v_xor_b32 v19, s51, v19
    v_or3_b32 v33, v33, v16, v17
    v_or3_b32 v33, v33, v18, v19
    s_waitcnt vmcnt(0)
    v_xor_b32 v20, s48, v20
    v_xor_b32 v21, s49, v21
    v_xor_b32 v22, s50, v22
    v_xor_b32 v23, s51, v23
    v_or3_b32 v33, v33, v20, v21
    v_or3_b32 v33, v33, v22, v23
    v_and_b32 v33, 0xff, v33
    v_cmp_ne_u32 vcc, 0, v33
    s_cbranch_vccz L_rdone_150
    s_sub_u32 s57, s57, 1
    s_cmp_lg_u32 s57, 0
    s_cbranch_scc1 L_rloop_149
L_rdone_150:
    s_mov_b64 exec, -1
    s_branch L_ok_151
L_tiny_152:
L_mx_154:
    s_cmp_eq_u64 s[48:49], 0
    s_cbranch_scc1 L_mxe_156
    s_ff1_i32_b64 s57, s[48:49]
    s_bitset0_b64 s[48:49], s57
    v_readlane_b32 s5, v36, s57
    s_nop 0
    s_lshl_b32 s5, s5, 16
    v_mov_b32 v8, s5
    v_lshlrev_b32 v9, 1, v0
    v_mov_b32 v12, 0
    s_mov_b32 s5, 0
L_mxf_155:
    buffer_load_ushort v13, v9, s[32:35], s5 offen
    buffer_load_ushort v14, v9, s[36:39], s5 offen
    buffer_load_ushort v15, v9, s[40:43], s5 offen
    s_waitcnt vmcnt(0)
    v_lshlrev_b32 v13, 16, v13
    v_lshlrev_b32 v14, 16, v14
    v_lshlrev_b32 v15, 16, v15
    v_fma_f32 v10, v8, v13, v14
    v_mul_f32 v11, v10, v10
    v_mul_f32 v11, 0xbdd2d3e8, v11
    v_add_f32 v11, 0xc0135761, v11
    v_mul_f32 v11, v10, v11
    v_exp_f32 v11, v11
    v_mul_f32 v10, v10, v15
    v_add_f32 v11, 1.0, v11
    v_rcp_f32 v11, v11
    s_add_u32 s5, s5, 128
    s_cmp_lt_u32 s5, 2752
    v_fmac_f32 v12, v10, v11
    s_cbranch_scc1 L_mxf_155
    s_nop 0
    v_add_f32_dpp v12, v12, v12 quad_perm:[1,0,3,2] row_mask:0xf bank_mask:0xf
    s_nop 1
    v_add_f32_dpp v12, v12, v12 quad_perm:[2,3,0,1] row_mask:0xf bank_mask:0xf
    s_nop 1
    v_add_f32_dpp v12, v12, v12 row_half_mirror row_mask:0xf bank_mask:0xf
    s_nop 1
    v_add_f32_dpp v12, v12, v12 row_mirror row_mask:0xf bank_mask:0xf
    s_nop 1
    v_add_f32_dpp v12, v12, v12 row_bcast:15 row_mask:0xa bank_mask:0xf
    s_nop 1
    v_add_f32_dpp v12, v12, v12 row_bcast:31 row_mask:0xc bank_mask:0xf
    v_add_f32 v12, s55, v12
    s_nop 0
    v_readlane_b32 s5, v12, 63
    s_mov_b32 m0, s57
    s_nop 3
    v_writelane_b32 v28, s5, m0
    s_branch L_mx_154
L_mxe_156:
L_mx_157:
    s_cmp_eq_u64 s[50:51], 0
    s_cbranch_scc1 L_mxe_159
    s_ff1_i32_b64 s57, s[50:51]
    s_bitset0_b64 s[50:51], s57
    v_readlane_b32 s5, v36, s57
    s_nop 0
    s_and_b32 s5, s5, 0xffff0000
    v_mov_b32 v8, s5
    v_lshlrev_b32 v9, 1, v0
    v_mov_b32 v12, 0
    s_mov_b32 s5, 0
L_mxf_158:
    buffer_load_ushort v13, v9, s[32:35], s5 offen
    buffer_load_ushort v14, v9, s[36:39], s5 offen
    buffer_load_ushort v15, v9, s[40:43], s5 offen
    s_waitcnt vmcnt(0)
    v_lshlrev_b32 v13, 16, v13
    v_lshlrev_b32 v14, 16, v14
    v_lshlrev_b32 v15, 16, v15
    v_fma_f32 v10, v8, v13, v14
    v_mul_f32 v11, v10, v10
    v_mul_f32 v11, 0xbdd2d3e8, v11
    v_add_f32 v11, 0xc0135761, v11
    v_mul_f32 v11, v10, v11
    v_exp_f32 v11, v11
    v_mul_f32 v10, v10, v15
    v_add_f32 v11, 1.0, v11
    v_rcp_f32 v11, v11
    s_add_u32 s5, s5, 128
    s_cmp_lt_u32 s5, 2752
    v_fmac_f32 v12, v10, v11
    s_cbranch_scc1 L_mxf_158
    s_nop 0
    v_add_f32_dpp v12, v12, v12 quad_perm:[1,0,3,2] row_mask:0xf bank_mask:0xf
    s_nop 1
    v_add_f32_dpp v12, v12, v12 quad_perm:[2,3,0,1] row_mask:0xf bank_mask:0xf
    s_nop 1
    v_add_f32_dpp v12, v12, v12 row_half_mirror row_mask:0xf bank_mask:0xf
    s_nop 1
    v_add_f32_dpp v12, v12, v12 row_mirror row_mask:0xf bank_mask:0xf
    s_nop 1
    v_add_f32_dpp v12, v12, v12 row_bcast:15 row_mask:0xa bank_mask:0xf
    s_nop 1
    v_add_f32_dpp v12, v12, v12 row_bcast:31 row_mask:0xc bank_mask:0xf
    v_add_f32 v12, s55, v12
    s_nop 0
    v_readlane_b32 s5, v12, 63
    s_mov_b32 m0, s57
    s_nop 3
    v_writelane_b32 v29, s5, m0
    s_branch L_mx_157
L_mxe_159:
    s_branch L_mixed_153
L_slow_161:
    buffer_store_dword v12, v41, s[16:19], s26 offen sc1
    s_branch L_pub_162
.p2align 12
L_page_165:
    s_waitcnt vmcnt(1)
    v_xor_b32 v8, s28, v8
    v_xor_b32 v9, s29, v9
    v_xor_b32 v10, s30, v10
    v_xor_b32 v11, s31, v11
    v_or3_b32 v25, v8, v9, v10
    v_or_b32 v25, v25, v11
    s_waitcnt vmcnt(0)
    v_xor_b32 v12, s28, v12
    v_xor_b32 v13, s29, v13
    v_xor_b32 v14, s30, v14
    v_xor_b32 v15, s31, v15
    v_or3_b32 v25, v25, v12, v13
    v_or3_b32 v25, v25, v14, v15
    v_and_b32 v25, 0xff, v25
    v_cmp_ne_u32 vcc, 0, v25
    s_cbranch_vccnz L_retry_166
L_ok_169:
    v_add_f32_dpp v8, v8, v8 row_ror:4 row_mask:0xf bank_mask:0xf
    v_add_f32_dpp v9, v9, v9 row_ror:4 row_mask:0xf bank_mask:0xf
    v_add_f32_dpp v10, v10, v10 row_ror:4 row_mask:0xf bank_mask:0xf
    v_add_f32_dpp v11, v11, v11 row_ror:4 row_mask:0xf bank_mask:0xf
    v_add_f32_dpp v12, v12, v12 row_ror:4 row_mask:0xf bank_mask:0xf
    v_add_f32_dpp v13, v13, v13 row_ror:4 row_mask:0xf bank_mask:0xf
    v_add_f32_dpp v14, v14, v14 row_ror:4 row_mask:0xf bank_mask:0xf
    v_add_f32_dpp v15, v15, v15 row_ror:4 row_mask:0xf bank_mask:0xf
    v_add_f32_dpp v8, v8, v8 row_ror:8 row_mask:0xf bank_mask:0xf
    v_add_f32_dpp v9, v9, v9 row_ror:8 row_mask:0xf bank_mask:0xf
    v_add_f32_dpp v10, v10, v10 row_ror:8 row_mask:0xf bank_mask:0xf
    v_add_f32_dpp v11, v11, v11 row_ror:8 row_mask:0xf bank_mask:0xf
    v_add_f32_dpp v12, v12, v12 row_ror:8 row_mask:0xf bank_mask:0xf
    v_add_f32_dpp v13, v13, v13 row_ror:8 row_mask:0xf bank_mask:0xf
    v_add_f32_dpp v14, v14, v14 row_ror:8 row_mask:0xf bank_mask:0xf
    v_add_f32_dpp v15, v15, v15 row_ror:8 row_mask:0xf bank_mask:0xf
    v_cvt_pk_bf16_f32 v36, v8, v9
    v_cvt_pk_bf16_f32 v37, v10, v11
    v_cvt_pk_bf16_f32 v38, v12, v13
    v_cvt_pk_bf16_f32 v39, v14, v15
    v_cndmask_b32_e64 v8, 0, v36, s[76:77]
    v_cndmask_b32_e64 v9, 0, v37, s[76:77]
    v_cndmask_b32_e64 v10, 0, v38, s[76:77]
    v_cndmask_b32_e64 v11, 0, v39, s[76:77]
    v_cndmask_b32_e64 v12, 0, v36, s[78:79]
    v_cndmask_b32_e64 v13, 0, v37, s[78:79]
    v_cndmask_b32_e64 v14, 0, v38, s[78:79]
    v_cndmask_b32_e64 v15, 0, v39, s[78:79]
    v_mfma_f32_16x16x32_bf16 v[24:27], a[184:187], v[8:11], 0
    v_cndmask_b32_e64 v16, 0, v36, s[80:81]
    v_cndmask_b32_e64 v17, 0, v37, s[80:81]
    v_cndmask_b32_e64 v18, 0, v38, s[80:81]
    v_cndmask_b32_e64 v19, 0, v39, s[80:81]
    v_mfma_f32_16x16x32_bf16 v[24:27], a[188:191], v[12:15], v[24:27]
    v_cndmask_b32_e64 v20, 0, v36, s[82:83]
    v_cndmask_b32_e64 v21, 0, v37, s[82:83]
    v_cndmask_b32_e64 v22, 0, v38, s[82:83]
    v_cndmask_b32_e64 v23, 0, v39, s[82:83]
    v_mfma_f32_16x16x32_bf16 v[24:27], a[192:195], v[16:19], v[24:27]
    s_nop 0
    v_mfma_f32_16x16x32_bf16 v[24:27], a[196:199], v[20:23], v[24:27]
    v_mfma_f32_16x16x32_bf16 v[28:31], a[200:203], v[8:11], 0
    v_mfma_f32_16x16x32_bf16 v[28:31], a[204:207], v[12:15], v[28:31]
    v_mfma_f32_16x16x32_bf16 v[28:31], a[208:211], v[16:19], v[28:31]
    v_mfma_f32_16x16x32_bf16 v[28:31], a[212:215], v[20:23], v[28:31]
    v_mfma_f32_16x16x32_bf16 v[32:35], a[216:219], v[8:11], 0
    s_nop 2
    v_mov_b32_dpp v24, v24 quad_perm:[0,0,0,0] row_mask:0xf bank_mask:0xf
    v_mov_b32_dpp v26, v26 quad_perm:[2,2,2,2] row_mask:0xf bank_mask:0xf
    v_mfma_f32_16x16x32_bf16 v[32:35], a[220:223], v[12:15], v[32:35]
    v_add_f32_dpp v24, v25, v24 quad_perm:[1,1,1,1] row_mask:0xf bank_mask:0xf
    v_add_f32_dpp v26, v27, v26 quad_perm:[3,3,3,3] row_mask:0xf bank_mask:0xf
    v_mfma_f32_16x16x32_bf16 v[32:35], a[224:227], v[16:19], v[32:35]
    v_add_f32 v24, v24, v26
    s_add_u32 s48, s90, 3
    v_mfma_f32_16x16x32_bf16 v[32:35], a[228:231], v[20:23], v[32:35]
    v_cndmask_b32_e64 v36, v36, v24, s[68:69]
    s_and_b32 s48, s48, 0xff
    v_mfma_f32_16x16x32_bf16 v[24:27], a[232:235], v[8:11], 0
    v_mov_b32_dpp v28, v28 quad_perm:[0,0,0,0] row_mask:0xf bank_mask:0xf
    v_mov_b32_dpp v30, v30 quad_perm:[2,2,2,2] row_mask:0xf bank_mask:0xf
    v_mfma_f32_16x16x32_bf16 v[24:27], a[236:239], v[12:15], v[24:27]
    v_add_f32_dpp v28, v29, v28 quad_perm:[1,1,1,1] row_mask:0xf bank_mask:0xf
    v_add_f32_dpp v30, v31, v30 quad_perm:[3,3,3,3] row_mask:0xf bank_mask:0xf
    v_mfma_f32_16x16x32_bf16 v[24:27], a[240:243], v[16:19], v[24:27]
    v_add_f32 v28, v28, v30
    s_add_u32 s49, s90, 56
    v_mfma_f32_16x16x32_bf16 v[24:27], a[244:247], v[20:23], v[24:27]
    v_cndmask_b32_e64 v36, v36, v28, s[70:71]
    s_and_b32 s49, s49, 0xff
    v_mfma_f32_16x16x32_bf16 v[28:31], a[248:251], v[8:11], 0
    v_mov_b32_dpp v32, v32 quad_perm:[0,0,0,0] row_mask:0xf bank_mask:0xf
    v_mov_b32_dpp v34, v34 quad_perm:[2,2,2,2] row_mask:0xf bank_mask:0xf
    v_mfma_f32_16x16x32_bf16 v[28:31], a[252:255], v[12:15], v[28:31]
    v_add_f32_dpp v32, v33, v32 quad_perm:[1,1,1,1] row_mask:0xf bank_mask:0xf
    v_add_f32_dpp v34, v35, v34 quad_perm:[3,3,3,3] row_mask:0xf bank_mask:0xf
    v_mfma_f32_16x16x32_bf16 v[28:31], a[0:3], v[16:19], v[28:31]
    v_add_f32 v32, v32, v34
    s_add_u32 s50, s90, 109
    v_mfma_f32_16x16x32_bf16 v[28:31], a[4:7], v[20:23], v[28:31]
    v_cndmask_b32_e64 v36, v36, v32, s[72:73]
    s_and_b32 s50, s50, 0xff
    v_mfma_f32_16x16x32_bf16 v[32:35], a[8:11], v[8:11], 0
    v_mov_b32_dpp v24, v24 quad_perm:[0,0,0,0] row_mask:0xf bank_mask:0xf
    v_mov_b32_dpp v26, v26 quad_perm:[2,2,2,2] row_mask:0xf bank_mask:0xf
    v_mfma_f32_16x16x32_bf16 v[32:35], a[12:15], v[12:15], v[32:35]
    v_add_f32_dpp v24, v25, v24 quad_perm:[1,1,1,1] row_mask:0xf bank_mask:0xf
    v_add_f32_dpp v26, v27, v26 quad_perm:[3,3,3,3] row_mask:0xf bank_mask:0xf
    v_mfma_f32_16x16x32_bf16 v[32:35], a[16:19], v[16:19], v[32:35]
    v_add_f32 v24, v24, v26
    ds_read_b128 a[0:3], v3 offset:0
    v_mfma_f32_16x16x32_bf16 v[32:35], a[20:23], v[20:23], v[32:35]
    v_cndmask_b32_e64 v36, v36, v24, s[74:75]
    ds_read_b128 a[4:7], v3 offset:1024
    v_mfma_f32_16x16x32_bf16 v[24:27], a[24:27], v[8:11], 0
    v_mov_b32_dpp v28, v28 quad_perm:[0,0,0,0] row_mask:0xf bank_mask:0xf
    v_mov_b32_dpp v30, v30 quad_perm:[2,2,2,2] row_mask:0xf bank_mask:0xf
    v_mfma_f32_16x16x32_bf16 v[24:27], a[28:31], v[12:15], v[24:27]
    v_add_f32_dpp v28, v29, v28 quad_perm:[1,1,1,1] row_mask:0xf bank_mask:0xf
    v_add_f32_dpp v30, v31, v30 quad_perm:[3,3,3,3] row_mask:0xf bank_mask:0xf
    v_mfma_f32_16x16x32_bf16 v[24:27], a[32:35], v[16:19], v[24:27]
    v_add_f32 v28, v28, v30
    ds_read_b128 a[8:11], v3 offset:2048
    v_mfma_f32_16x16x32_bf16 v[24:27], a[36:39], v[20:23], v[24:27]
    v_cndmask_b32_e64 v37, v37, v28, s[68:69]
    ds_read_b128 a[12:15], v3 offset:3072
    v_mfma_f32_16x16x32_bf16 v[28:31], a[40:43], v[8:11], 0
    v_mov_b32_dpp v32, v32 quad_perm:[0,0,0,0] row_mask:0xf bank_mask:0xf
    v_mov_b32_dpp v34, v34 quad_perm:[2,2,2,2] row_mask:0xf bank_mask:0xf
    v_mfma_f32_16x16x32_bf16 v[28:31], a[44:47], v[12:15], v[28:31]
    v_add_f32_dpp v32, v33, v32 quad_perm:[1,1,1,1] row_mask:0xf bank_mask:0xf
    v_add_f32_dpp v34, v35, v34 quad_perm:[3,3,3,3] row_mask:0xf bank_mask:0xf
    v_mfma_f32_16x16x32_bf16 v[28:31], a[48:51], v[16:19], v[28:31]
    v_add_f32 v32, v32, v34
    ds_read_b128 a[16:19], v3 offset:4096
    v_mfma_f32_16x16x32_bf16 v[28:31], a[52:55], v[20:23], v[28:31]
    v_cndmask_b32_e64 v37, v37, v32, s[70:71]
    ds_read_b128 a[20:23], v3 offset:5120
    v_mfma_f32_16x16x32_bf16 v[32:35], a[56:59], v[8:11], 0
    v_mov_b32_dpp v24, v24 quad_perm:[0,0,0,0] row_mask:0xf bank_mask:0xf
    v_mov_b32_dpp v26, v26 quad_perm:[2,2,2,2] row_mask:0xf bank_mask:0xf
    v_mfma_f32_16x16x32_bf16 v[32:35], a[60:63], v[12:15], v[32:35]
    v_add_f32_dpp v24, v25, v24 quad_perm:[1,1,1,1] row_mask:0xf bank_mask:0xf
    v_add_f32_dpp v26, v27, v26 quad_perm:[3,3,3,3] row_mask:0xf bank_mask:0xf
    v_mfma_f32_16x16x32_bf16 v[32:35], a[64:67], v[16:19], v[32:35]
    v_add_f32 v24, v24, v26
    ds_read_b128 a[24:27], v3 offset:6144
    v_mfma_f32_16x16x32_bf16 v[32:35], a[68:71], v[20:23], v[32:35]
    v_cndmask_b32_e64 v37, v37, v24, s[72:73]
    ds_read_b128 a[28:31], v3 offset:7168
    v_mfma_f32_16x16x32_bf16 v[24:27], a[72:75], v[8:11], 0
    v_mov_b32_dpp v28, v28 quad_perm:[0,0,0,0] row_mask:0xf bank_mask:0xf
    v_mov_b32_dpp v30, v30 quad_perm:[2,2,2,2] row_mask:0xf bank_mask:0xf
    v_mfma_f32_16x16x32_bf16 v[24:27], a[76:79], v[12:15], v[24:27]
    v_add_f32_dpp v28, v29, v28 quad_perm:[1,1,1,1] row_mask:0xf bank_mask:0xf
    v_add_f32_dpp v30, v31, v30 quad_perm:[3,3,3,3] row_mask:0xf bank_mask:0xf
    v_mfma_f32_16x16x32_bf16 v[24:27], a[80:83], v[16:19], v[24:27]
    v_add_f32 v28, v28, v30
    ds_read_b128 a[32:35], v3 offset:8192
    v_mfma_f32_16x16x32_bf16 v[24:27], a[84:87], v[20:23], v[24:27]
    v_cndmask_b32_e64 v37, v37, v28, s[74:75]
    ds_read_b128 a[36:39], v3 offset:9216
    v_mfma_f32_16x16x32_bf16 v[28:31], a[88:91], v[8:11], 0
    v_mov_b32_dpp v32, v32 quad_perm:[0,0,0,0] row_mask:0xf bank_mask:0xf
    v_mov_b32_dpp v34, v34 quad_perm:[2,2,2,2] row_mask:0xf bank_mask:0xf
    v_mfma_f32_16x16x32_bf16 v[28:31], a[92:95], v[12:15], v[28:31]
    v_add_f32_dpp v32, v33, v32 quad_perm:[1,1,1,1] row_mask:0xf bank_mask:0xf
    v_add_f32_dpp v34, v35, v34 quad_perm:[3,3,3,3] row_mask:0xf bank_mask:0xf
    v_mfma_f32_16x16x32_bf16 v[28:31], a[96:99], v[16:19], v[28:31]
    v_add_f32 v32, v32, v34
    ds_read_b128 a[40:43], v3 offset:10240
    v_mfma_f32_16x16x32_bf16 v[28:31], a[100:103], v[20:23], v[28:31]
    v_cndmask_b32_e64 v38, v38, v32, s[68:69]
    ds_read_b128 a[44:47], v3 offset:11264
    v_mfma_f32_16x16x32_bf16 v[32:35], a[104:107], v[8:11], 0
    v_mov_b32_dpp v24, v24 quad_perm:[0,0,0,0] row_mask:0xf bank_mask:0xf
    v_mov_b32_dpp v26, v26 quad_perm:[2,2,2,2] row_mask:0xf bank_mask:0xf
    v_mfma_f32_16x16x32_bf16 v[32:35], a[108:111], v[12:15], v[32:35]
    v_add_f32_dpp v24, v25, v24 quad_perm:[1,1,1,1] row_mask:0xf bank_mask:0xf
    v_add_f32_dpp v26, v27, v26 quad_perm:[3,3,3,3] row_mask:0xf bank_mask:0xf
    v_mfma_f32_16x16x32_bf16 v[32:35], a[112:115], v[16:19], v[32:35]
    v_add_f32 v24, v24, v26
    ds_read_b128 a[48:51], v3 offset:12288
    v_mfma_f32_16x16x32_bf16 v[32:35], a[116:119], v[20:23], v[32:35]
    v_cndmask_b32_e64 v38, v38, v24, s[70:71]
    ds_read_b128 a[52:55], v3 offset:13312
    v_mfma_f32_16x16x32_bf16 v[24:27], a[120:123], v[8:11], 0
    v_mov_b32_dpp v28, v28 quad_perm:[0,0,0,0] row_mask:0xf bank_mask:0xf
    v_mov_b32_dpp v30, v30 quad_perm:[2,2,2,2] row_mask:0xf bank_mask:0xf
    v_mfma_f32_16x16x32_bf16 v[24:27], a[124:127], v[12:15], v[24:27]
    v_add_f32_dpp v28, v29, v28 quad_perm:[1,1,1,1] row_mask:0xf bank_mask:0xf
    v_add_f32_dpp v30, v31, v30 quad_perm:[3,3,3,3] row_mask:0xf bank_mask:0xf
    v_mfma_f32_16x16x32_bf16 v[24:27], a[128:131], v[16:19], v[24:27]
    v_add_f32 v28, v28, v30
    ds_read_b128 a[56:59], v3 offset:14336
    v_mfma_f32_16x16x32_bf16 v[24:27], a[132:135], v[20:23], v[24:27]
    v_cndmask_b32_e64 v38, v38, v28, s[72:73]
    ds_read_b128 a[60:63], v3 offset:15360
    v_mfma_f32_16x16x32_bf16 v[28:31], a[136:139], v[8:11], 0
    v_mov_b32_dpp v32, v32 quad_perm:[0,0,0,0] row_mask:0xf bank_mask:0xf
    v_mov_b32_dpp v34, v34 quad_perm:[2,2,2,2] row_mask:0xf bank_mask:0xf
    v_mfma_f32_16x16x32_bf16 v[28:31], a[140:143], v[12:15], v[28:31]
    v_add_f32_dpp v32, v33, v32 quad_perm:[1,1,1,1] row_mask:0xf bank_mask:0xf
    v_add_f32_dpp v34, v35, v34 quad_perm:[3,3,3,3] row_mask:0xf bank_mask:0xf
    v_mfma_f32_16x16x32_bf16 v[28:31], a[144:147], v[16:19], v[28:31]
    v_add_f32 v32, v32, v34
    ds_read_b128 a[64:67], v3 offset:16384
    v_mfma_f32_16x16x32_bf16 v[28:31], a[148:151], v[20:23], v[28:31]
    v_cndmask_b32_e64 v38, v38, v32, s[74:75]
    ds_read_b128 a[68:71], v3 offset:17408
    v_mfma_f32_16x16x32_bf16 v[32:35], a[152:155], v[8:11], 0
    v_mov_b32_dpp v24, v24 quad_perm:[0,0,0,0] row_mask:0xf bank_mask:0xf
    v_mov_b32_dpp v26, v26 quad_perm:[2,2,2,2] row_mask:0xf bank_mask:0xf
    v_mfma_f32_16x16x32_bf16 v[32:35], a[156:159], v[12:15], v[32:35]
    v_add_f32_dpp v24, v25, v24 quad_perm:[1,1,1,1] row_mask:0xf bank_mask:0xf
    v_add_f32_dpp v26, v27, v26 quad_perm:[3,3,3,3] row_mask:0xf bank_mask:0xf
    v_mfma_f32_16x16x32_bf16 v[32:35], a[160:163], v[16:19], v[32:35]
    v_add_f32 v24, v24, v26
    ds_read_b128 a[72:75], v3 offset:18432
    v_mfma_f32_16x16x32_bf16 v[32:35], a[164:167], v[20:23], v[32:35]
    v_cndmask_b32_e64 v39, v39, v24, s[68:69]
    ds_read_b128 a[76:79], v3 offset:19456
    v_mfma_f32_16x16x32_bf16 v[24:27], a[168:171], v[8:11], 0
    v_mov_b32_dpp v28, v28 quad_perm:[0,0,0,0] row_mask:0xf bank_mask:0xf
    v_mov_b32_dpp v30, v30 quad_perm:[2,2,2,2] row_mask:0xf bank_mask:0xf
    v_mfma_f32_16x16x32_bf16 v[24:27], a[172:175], v[12:15], v[24:27]
    v_add_f32_dpp v28, v29, v28 quad_perm:[1,1,1,1] row_mask:0xf bank_mask:0xf
    v_add_f32_dpp v30, v31, v30 quad_perm:[3,3,3,3] row_mask:0xf bank_mask:0xf
    v_mfma_f32_16x16x32_bf16 v[24:27], a[176:179], v[16:19], v[24:27]
    v_add_f32 v28, v28, v30
    s_add_u32 s51, s90, 162
    v_mfma_f32_16x16x32_bf16 v[24:27], a[180:183], v[20:23], v[24:27]
    v_cndmask_b32_e64 v39, v39, v28, s[70:71]
    s_and_b32 s51, s51, 0xff
    v_mov_b32_dpp v32, v32 quad_perm:[0,0,0,0] row_mask:0xf bank_mask:0xf
    v_mov_b32_dpp v34, v34 quad_perm:[2,2,2,2] row_mask:0xf bank_mask:0xf
    s_nop 0
    v_add_f32_dpp v32, v33, v32 quad_perm:[1,1,1,1] row_mask:0xf bank_mask:0xf
    v_add_f32_dpp v34, v35, v34 quad_perm:[3,3,3,3] row_mask:0xf bank_mask:0xf
    v_add_f32 v32, v32, v34
    v_cndmask_b32_e64 v39, v39, v32, s[72:73]
    v_mov_b32_dpp v24, v24 quad_perm:[0,0,0,0] row_mask:0xf bank_mask:0xf
    v_mov_b32_dpp v26, v26 quad_perm:[2,2,2,2] row_mask:0xf bank_mask:0xf
    s_nop 0
    v_add_f32_dpp v24, v25, v24 quad_perm:[1,1,1,1] row_mask:0xf bank_mask:0xf
    v_add_f32_dpp v26, v27, v26 quad_perm:[3,3,3,3] row_mask:0xf bank_mask:0xf
    v_add_f32 v24, v24, v26
    v_cndmask_b32_e64 v39, v39, v24, s[74:75]
    v_max3_f32 v16, v36, v37, v38
    v_max_f32 v16, v16, v39
    v_mov_b32 v24, 0
    v_mov_b32 v25, 0
    v_max_f32_dpp v16, v16, v16 quad_perm:[1,0,3,2] row_mask:0xf bank_mask:0xf
    v_mov_b32 v26, 0
    v_mov_b32 v27, 0
    v_max_f32_dpp v16, v16, v16 quad_perm:[2,3,0,1] row_mask:0xf bank_mask:0xf
    v_mov_b32 v28, 0
    v_mov_b32 v29, 0
    v_max_f32_dpp v16, v16, v16 row_half_mirror row_mask:0xf bank_mask:0xf
    v_mov_b32 v30, 0
    v_mov_b32 v31, 0
    v_max_f32_dpp v16, v16, v16 row_mirror row_mask:0xf bank_mask:0xf
    v_mov_b32 v17, 0x3e0293ee
    s_nop 0
    v_max_f32_dpp v16, v16, v16 row_bcast:15 row_mask:0xa bank_mask:0xf
    s_nop 1
    v_max_f32_dpp v16, v16, v16 row_bcast:31 row_mask:0xc bank_mask:0xf
    v_mul_f32 v16, 0x3e0293ee, v16
    s_nop 0
    v_readlane_b32 s61, v16, 63
    s_nop 1
    v_fma_f32 v36, v36, v17, -s61
    v_fma_f32 v37, v37, v17, -s61
    v_fma_f32 v38, v38, v17, -s61
    v_fma_f32 v39, v39, v17, -s61
    v_exp_f32 v36, v36
    v_exp_f32 v37, v37
    v_exp_f32 v38, v38
    v_exp_f32 v39, v39
    v_cvt_pk_bf16_f32 v8, v36, v36
    v_cvt_pk_bf16_f32 v9, v36, v36
    v_cvt_pk_bf16_f32 v10, v37, v37
    v_cvt_pk_bf16_f32 v11, v37, v37
    v_cvt_pk_bf16_f32 v12, v38, v38
    v_cvt_pk_bf16_f32 v13, v38, v38
    v_cvt_pk_bf16_f32 v14, v39, v39
    v_cvt_pk_bf16_f32 v15, v39, v39
    v_mov_b32_dpp v8, v8 row_shr:4 row_mask:0xf bank_mask:0xa
    v_mov_b32_dpp v9, v9 row_shl:4 row_mask:0xf bank_mask:0x5
    v_mov_b32_dpp v10, v10 row_shr:4 row_mask:0xf bank_mask:0xa
    v_mov_b32_dpp v11, v11 row_shl:4 row_mask:0xf bank_mask:0x5
    v_mov_b32_dpp v12, v12 row_shr:4 row_mask:0xf bank_mask:0xa
    v_mov_b32_dpp v13, v13 row_shl:4 row_mask:0xf bank_mask:0x5
    v_mov_b32_dpp v14, v14 row_shr:4 row_mask:0xf bank_mask:0xa
    v_mov_b32_dpp v15, v15 row_shl:4 row_mask:0xf bank_mask:0x5
    v_add_f32 v7, v36, v37
    v_add_f32 v38, v38, v39
    v_permlane32_swap_b32 v8, v9
    v_permlane32_swap_b32 v10, v11
    v_permlane32_swap_b32 v12, v13
    v_permlane32_swap_b32 v14, v15
    v_add_f32 v7, v7, v38
    s_waitcnt lgkmcnt(0)
    v_and_b32_dpp v16, v8, v4 quad_perm:[0,0,0,0] row_mask:0xf bank_mask:0xf
    v_and_b32_dpp v17, v8, v5 quad_perm:[0,0,0,0] row_mask:0xf bank_mask:0xf
    v_and_b32_dpp v18, v9, v4 quad_perm:[0,0,0,0] row_mask:0xf bank_mask:0xf
    v_and_b32_dpp v19, v9, v5 quad_perm:[0,0,0,0] row_mask:0xf bank_mask:0xf
    v_and_b32_dpp v20, v8, v4 quad_perm:[1,1,1,1] row_mask:0xf bank_mask:0xf
    v_and_b32_dpp v21, v8, v5 quad_perm:[1,1,1,1] row_mask:0xf bank_mask:0xf
    v_smfmac_f32_16x16x64_bf16 v[24:27], v[16:19], a[0:7], v6
    v_and_b32_dpp v22, v9, v4 quad_perm:[1,1,1,1] row_mask:0xf bank_mask:0xf
    v_and_b32_dpp v23, v9, v5 quad_perm:[1,1,1,1] row_mask:0xf bank_mask:0xf
    v_smfmac_f32_16x16x64_bf16 v[28:31], v[16:19], a[8:15], v6
    v_add_f32_dpp v7, v7, v7 quad_perm:[1,0,3,2] row_mask:0xf bank_mask:0xf
    v_and_b32_dpp v16, v8, v4 quad_perm:[2,2,2,2] row_mask:0xf bank_mask:0xf
    v_and_b32_dpp v17, v8, v5 quad_perm:[2,2,2,2] row_mask:0xf bank_mask:0xf
    v_smfmac_f32_16x16x64_bf16 v[24:27], v[20:23], a[16:23], v6
    v_and_b32_dpp v18, v9, v4 quad_perm:[2,2,2,2] row_mask:0xf bank_mask:0xf
    v_and_b32_dpp v19, v9, v5 quad_perm:[2,2,2,2] row_mask:0xf bank_mask:0xf
    v_smfmac_f32_16x16x64_bf16 v[28:31], v[20:23], a[24:31], v6
    v_add_f32_dpp v7, v7, v7 quad_perm:[2,3,0,1] row_mask:0xf bank_mask:0xf
    v_and_b32_dpp v20, v8, v4 quad_perm:[3,3,3,3] row_mask:0xf bank_mask:0xf
    v_and_b32_dpp v21, v8, v5 quad_perm:[3,3,3,3] row_mask:0xf bank_mask:0xf
    v_smfmac_f32_16x16x64_bf16 v[24:27], v[16:19], a[32:39], v6
    v_and_b32_dpp v22, v9, v4 quad_perm:[3,3,3,3] row_mask:0xf bank_mask:0xf
    v_and_b32_dpp v23, v9, v5 quad_perm:[3,3,3,3] row_mask:0xf bank_mask:0xf
    v_smfmac_f32_16x16x64_bf16 v[28:31], v[16:19], a[40:47], v6
    v_add_f32_dpp v7, v7, v7 row_half_mirror row_mask:0xf bank_mask:0xf
    v_and_b32_dpp v16, v10, v4 quad_perm:[0,0,0,0] row_mask:0xf bank_mask:0xf
    v_and_b32_dpp v17, v10, v5 quad_perm:[0,0,0,0] row_mask:0xf bank_mask:0xf
    v_smfmac_f32_16x16x64_bf16 v[24:27], v[20:23], a[48:55], v6
    v_and_b32_dpp v18, v11, v4 quad_perm:[0,0,0,0] row_mask:0xf bank_mask:0xf
    v_and_b32_dpp v19, v11, v5 quad_perm:[0,0,0,0] row_mask:0xf bank_mask:0xf
    v_smfmac_f32_16x16x64_bf16 v[28:31], v[20:23], a[56:63], v6
    v_add_f32_dpp v7, v7, v7 row_mirror row_mask:0xf bank_mask:0xf
    v_and_b32_dpp v20, v10, v4 quad_perm:[1,1,1,1] row_mask:0xf bank_mask:0xf
    v_and_b32_dpp v21, v10, v5 quad_perm:[1,1,1,1] row_mask:0xf bank_mask:0xf
    v_smfmac_f32_16x16x64_bf16 v[24:27], v[16:19], a[64:71], v6
    v_and_b32_dpp v22, v11, v4 quad_perm:[1,1,1,1] row_mask:0xf bank_mask:0xf
    v_and_b32_dpp v23, v11, v5 quad_perm:[1,1,1,1] row_mask:0xf bank_mask:0xf
    v_smfmac_f32_16x16x64_bf16 v[28:31], v[16:19], a[72:79], v6
    v_add_f32_dpp v7, v7, v7 row_bcast:15 row_mask:0xa bank_mask:0xf
    v_and_b32_dpp v16, v10, v4 quad_perm:[2,2,2,2] row_mask:0xf bank_mask:0xf
    v_and_b32_dpp v17, v10, v5 quad_perm:[2,2,2,2] row_mask:0xf bank_mask:0xf
    v_smfmac_f32_16x16x64_bf16 v[24:27], v[20:23], v[80:87], v6
    v_and_b32_dpp v18, v11, v4 quad_perm:[2,2,2,2] row_mask:0xf bank_mask:0xf
    v_and_b32_dpp v19, v11, v5 quad_perm:[2,2,2,2] row_mask:0xf bank_mask:0xf
    v_smfmac_f32_16x16x64_bf16 v[28:31], v[20:23], v[88:95], v6
    v_add_f32_dpp v7, v7, v7 row_bcast:31 row_mask:0xc bank_mask:0xf
    v_and_b32_dpp v20, v10, v4 quad_perm:[3,3,3,3] row_mask:0xf bank_mask:0xf
    v_and_b32_dpp v21, v10, v5 quad_perm:[3,3,3,3] row_mask:0xf bank_mask:0xf
    v_smfmac_f32_16x16x64_bf16 v[24:27], v[16:19], v[96:103], v6
    v_and_b32_dpp v22, v11, v4 quad_perm:[3,3,3,3] row_mask:0xf bank_mask:0xf
    v_and_b32_dpp v23, v11, v5 quad_perm:[3,3,3,3] row_mask:0xf bank_mask:0xf
    v_smfmac_f32_16x16x64_bf16 v[28:31], v[16:19], v[104:111], v6
    v_readlane_b32 s62, v7, 63
    v_and_b32_dpp v16, v12, v4 quad_perm:[0,0,0,0] row_mask:0xf bank_mask:0xf
    v_and_b32_dpp v17, v12, v5 quad_perm:[0,0,0,0] row_mask:0xf bank_mask:0xf
    v_smfmac_f32_16x16x64_bf16 v[24:27], v[20:23], v[112:119], v6
    v_and_b32_dpp v18, v13, v4 quad_perm:[0,0,0,0] row_mask:0xf bank_mask:0xf
    v_and_b32_dpp v19, v13, v5 quad_perm:[0,0,0,0] row_mask:0xf bank_mask:0xf
    v_smfmac_f32_16x16x64_bf16 v[28:31], v[20:23], v[120:127], v6
    s_add_u32 s59, s24, 0
    v_and_b32_dpp v20, v12, v4 quad_perm:[1,1,1,1] row_mask:0xf bank_mask:0xf
    v_and_b32_dpp v21, v12, v5 quad_perm:[1,1,1,1] row_mask:0xf bank_mask:0xf
    v_smfmac_f32_16x16x64_bf16 v[24:27], v[16:19], v[128:135], v6
    v_and_b32_dpp v22, v13, v4 quad_perm:[1,1,1,1] row_mask:0xf bank_mask:0xf
    v_and_b32_dpp v23, v13, v5 quad_perm:[1,1,1,1] row_mask:0xf bank_mask:0xf
    v_smfmac_f32_16x16x64_bf16 v[28:31], v[16:19], v[136:143], v6
    s_add_u32 s60, s25, 0
    v_and_b32_dpp v16, v12, v4 quad_perm:[2,2,2,2] row_mask:0xf bank_mask:0xf
    v_and_b32_dpp v17, v12, v5 quad_perm:[2,2,2,2] row_mask:0xf bank_mask:0xf
    v_smfmac_f32_16x16x64_bf16 v[24:27], v[20:23], v[144:151], v6
    v_and_b32_dpp v18, v13, v4 quad_perm:[2,2,2,2] row_mask:0xf bank_mask:0xf
    v_and_b32_dpp v19, v13, v5 quad_perm:[2,2,2,2] row_mask:0xf bank_mask:0xf
    v_smfmac_f32_16x16x64_bf16 v[28:31], v[20:23], v[152:159], v6
    v_add3_u32 v35, v43, s90, 3
    v_and_b32_dpp v20, v12, v4 quad_perm:[3,3,3,3] row_mask:0xf bank_mask:0xf
    v_and_b32_dpp v21, v12, v5 quad_perm:[3,3,3,3] row_mask:0xf bank_mask:0xf
    v_smfmac_f32_16x16x64_bf16 v[24:27], v[16:19], v[160:167], v6
    v_and_b32_dpp v22, v13, v4 quad_perm:[3,3,3,3] row_mask:0xf bank_mask:0xf
    v_and_b32_dpp v23, v13, v5 quad_perm:[3,3,3,3] row_mask:0xf bank_mask:0xf
    v_smfmac_f32_16x16x64_bf16 v[28:31], v[16:19], v[168:175], v6
    v_mov_b32 v38, s61
    v_and_b32_dpp v16, v14, v4 quad_perm:[0,0,0,0] row_mask:0xf bank_mask:0xf
    v_and_b32_dpp v17, v14, v5 quad_perm:[0,0,0,0] row_mask:0xf bank_mask:0xf
    v_smfmac_f32_16x16x64_bf16 v[24:27], v[20:23], v[176:183], v6
    v_and_b32_dpp v18, v15, v4 quad_perm:[0,0,0,0] row_mask:0xf bank_mask:0xf
    v_and_b32_dpp v19, v15, v5 quad_perm:[0,0,0,0] row_mask:0xf bank_mask:0xf
    v_smfmac_f32_16x16x64_bf16 v[28:31], v[20:23], v[184:191], v6
    v_mov_b32 v39, s62
    v_and_b32_dpp v20, v14, v4 quad_perm:[1,1,1,1] row_mask:0xf bank_mask:0xf
    v_and_b32_dpp v21, v14, v5 quad_perm:[1,1,1,1] row_mask:0xf bank_mask:0xf
    v_smfmac_f32_16x16x64_bf16 v[24:27], v[16:19], v[192:199], v6
    v_and_b32_dpp v22, v15, v4 quad_perm:[1,1,1,1] row_mask:0xf bank_mask:0xf
    v_and_b32_dpp v23, v15, v5 quad_perm:[1,1,1,1] row_mask:0xf bank_mask:0xf
    v_smfmac_f32_16x16x64_bf16 v[28:31], v[16:19], v[200:207], v6
    v_lshlrev_b32_e64 v7, 3, s3
    v_and_b32_dpp v16, v14, v4 quad_perm:[2,2,2,2] row_mask:0xf bank_mask:0xf
    v_and_b32_dpp v17, v14, v5 quad_perm:[2,2,2,2] row_mask:0xf bank_mask:0xf
    v_smfmac_f32_16x16x64_bf16 v[24:27], v[20:23], v[208:215], v6
    v_and_b32_dpp v18, v15, v4 quad_perm:[2,2,2,2] row_mask:0xf bank_mask:0xf
    v_and_b32_dpp v19, v15, v5 quad_perm:[2,2,2,2] row_mask:0xf bank_mask:0xf
    v_smfmac_f32_16x16x64_bf16 v[28:31], v[20:23], v[216:223], v6
    s_mov_b64 exec, 1
    ds_write_b64 v7, v[38:39] offset:2048
    s_mov_b64 exec, -1
    v_and_b32_dpp v20, v14, v4 quad_perm:[3,3,3,3] row_mask:0xf bank_mask:0xf
    v_and_b32_dpp v21, v14, v5 quad_perm:[3,3,3,3] row_mask:0xf bank_mask:0xf
    v_smfmac_f32_16x16x64_bf16 v[24:27], v[16:19], v[224:231], v6
    v_and_b32_dpp v22, v15, v4 quad_perm:[3,3,3,3] row_mask:0xf bank_mask:0xf
    v_and_b32_dpp v23, v15, v5 quad_perm:[3,3,3,3] row_mask:0xf bank_mask:0xf
    v_smfmac_f32_16x16x64_bf16 v[28:31], v[16:19], v[232:239], v6
    v_mov_b32 v7, 0
    v_smfmac_f32_16x16x64_bf16 v[24:27], v[20:23], v[240:247], v6
    v_smfmac_f32_16x16x64_bf16 v[28:31], v[20:23], v[248:255], v6
    s_nop 7
    v_cndmask_b32_e64 v24, v24, v28, s[64:65]
    v_cndmask_b32_e64 v25, v25, v29, s[64:65]
    v_cndmask_b32_e64 v26, v26, v30, s[64:65]
    v_cndmask_b32_e64 v27, v27, v31, s[64:65]
    s_nop 0
    v_permlane32_swap_b32 v24, v26
    v_permlane32_swap_b32 v25, v27
    v_add_f32 v24, v24, v26
    v_add_f32 v25, v25, v27
    ds_write_b64 v40, v[24:25] offset:0
    s_waitcnt lgkmcnt(0)
    s_barrier
    ds_read_b128 v[8:11], v7 offset:2048
    ds_read_b128 v[12:15], v7 offset:2064
    ds_read_b32 v16, v41 offset:0
    ds_read_b32 v17, v41 offset:512
    ds_read_b32 v18, v41 offset:1024
    ds_read_b32 v19, v41 offset:1536
    s_waitcnt lgkmcnt(4)
    v_max3_f32 v22, v8, v10, v12
    v_max_f32 v22, v22, v14
    v_sub_f32 v8, v8, v22
    v_sub_f32 v10, v10, v22
    v_sub_f32 v12, v12, v22
    v_sub_f32 v14, v14, v22
    v_exp_f32 v8, v8
    v_exp_f32 v10, v10
    v_exp_f32 v12, v12
    v_exp_f32 v14, v14
    v_lshlrev_b32 v21, 8, v22
    v_cndmask_b32_e64 v22, v22, v21, s[72:73]
    s_waitcnt lgkmcnt(0)
    v_cndmask_b32_e64 v16, v16, v9, s[64:65]
    v_cndmask_b32_e64 v17, v17, v11, s[64:65]
    v_cndmask_b32_e64 v18, v18, v13, s[64:65]
    v_cndmask_b32_e64 v19, v19, v15, s[64:65]
    v_mul_f32 v23, v8, v16
    v_fmac_f32 v23, v10, v17
    v_fmac_f32 v23, v12, v18
    v_fmac_f32 v23, v14, v19
    v_cndmask_b32_e64 v23, v23, v22, s[66:67]
    v_bfi_b32 v23, s87, v35, v23
    s_mov_b32 exec_hi, s56
    s_cmp_eq_u32 s53, 0
    s_cbranch_scc1 L_slow_170
    buffer_store_dword v23, v42, s[16:19], s59 offen
L_pub_171:
    s_mov_b32 exec_hi, -1
    s_cmp_lg_u32 s1, 0
    s_cbranch_scc1 L_odd_197
    buffer_load_dwordx4 v[24:27], v46, s[16:19], s60 offen offset:512 sc1
    buffer_load_dwordx4 v[8:11], v45, s[16:19], s60 offen offset:0 sc1
    buffer_load_dwordx4 v[12:15], v45, s[16:19], s60 offen offset:1280 sc1
    buffer_load_dwordx4 v[16:19], v45, s[16:19], s60 offen offset:2560 sc1
    buffer_load_dwordx4 v[20:23], v45, s[16:19], s60 offen offset:3840 sc1
    s_branch L_page_172
L_retry_166:
    s_mov_b32 s57, 524288
L_rloop_167:
    s_mov_b64 exec, vcc
    buffer_load_dwordx4 v[8:11], v44, s[16:19], s27 offen offset:0 sc1
    buffer_load_dwordx4 v[12:15], v44, s[16:19], s27 offen offset:16 sc1
    s_waitcnt vmcnt(1)
    v_xor_b32 v8, s28, v8
    v_xor_b32 v9, s29, v9
    v_xor_b32 v10, s30, v10
    v_xor_b32 v11, s31, v11
    v_or3_b32 v25, v8, v9, v10
    v_or_b32 v25, v25, v11
    s_waitcnt vmcnt(0)
    v_xor_b32 v12, s28, v12
    v_xor_b32 v13, s29, v13
    v_xor_b32 v14, s30, v14
    v_xor_b32 v15, s31, v15
    v_or3_b32 v25, v25, v12, v13
    v_or3_b32 v25, v25, v14, v15
    v_and_b32 v25, 0xff, v25
    v_cmp_ne_u32 vcc, 0, v25
    s_cbranch_vccz L_rdone_168
    s_sub_u32 s57, s57, 1
    s_cmp_lg_u32 s57, 0
    s_cbranch_scc1 L_rloop_167
L_rdone_168:
    s_mov_b64 exec, -1
    s_branch L_ok_169
L_slow_170:
    buffer_store_dword v23, v42, s[16:19], s59 offen sc1
    s_branch L_pub_171
.p2align 12
L_page_172:
    v_and_b32 v30, 48, v0
    v_lshl_add_u32 v32, s3, 8, v30
    v_lshl_add_u32 v33, s3, 7, v30
    v_lshlrev_b32 v34, 2, v0
    s_add_u32 s59, s26, 49152
    s_waitcnt vmcnt(4)
    v_xor_b32 v24, s48, v24
    v_xor_b32 v25, s49, v25
    v_xor_b32 v26, s50, v26
    v_xor_b32 v27, s51, v27
    v_or3_b32 v28, v24, v25, v26
    v_or_b32 v28, v28, v27
    s_waitcnt vmcnt(3)
    v_xor_b32 v8, s48, v8
    v_xor_b32 v9, s49, v9
    v_xor_b32 v10, s50, v10
    v_xor_b32 v11, s51, v11
    v_or3_b32 v28, v28, v8, v9
    v_or3_b32 v28, v28, v10, v11
    s_waitcnt vmcnt(2)
    v_xor_b32 v12, s48, v12
    v_xor_b32 v13, s49, v13
    v_xor_b32 v14, s50, v14
    v_xor_b32 v15, s51, v15
    v_or3_b32 v28, v28, v12, v13
    v_or3_b32 v28, v28, v14, v15
    s_waitcnt vmcnt(1)
    v_xor_b32 v16, s48, v16
    v_xor_b32 v17, s49, v17
    v_xor_b32 v18, s50, v18
    v_xor_b32 v19, s51, v19
    v_or3_b32 v28, v28, v16, v17
    v_or3_b32 v28, v28, v18, v19
    s_waitcnt vmcnt(0)
    v_xor_b32 v20, s48, v20
    v_xor_b32 v21, s49, v21
    v_xor_b32 v22, s50, v22
    v_xor_b32 v23, s51, v23
    v_or3_b32 v28, v28, v20, v21
    v_or3_b32 v28, v28, v22, v23
    v_and_b32 v28, 0xff, v28
    v_cmp_ne_u32 vcc, 0, v28
    s_cbranch_vccnz L_retry_173
L_ok_176:
    v_lshrrev_b32 v26, 8, v26
    v_or_b32 v24, v24, v26
    s_nop 1
    v_max_f32_dpp v28, v24, v24 quad_perm:[1,0,3,2] row_mask:0xf bank_mask:0xf
    s_nop 1
    v_max_f32_dpp v28, v28, v28 quad_perm:[2,3,0,1] row_mask:0xf bank_mask:0xf
    s_nop 1
    v_max_f32_dpp v28, v28, v28 row_half_mirror row_mask:0xf bank_mask:0xf
    v_sub_f32 v24, v24, v28
    v_exp_f32 v24, v24
    s_nop 0
    v_mul_f32 v25, v24, v25
    v_mul_f32_dpp v36, v24, v8 row_newbcast:0 row_mask:0xf bank_mask:0xf
    v_mul_f32_dpp v37, v24, v9 row_newbcast:0 row_mask:0xf bank_mask:0xf
    v_mul_f32_dpp v38, v24, v10 row_newbcast:0 row_mask:0xf bank_mask:0xf
    v_mul_f32_dpp v39, v24, v11 row_newbcast:0 row_mask:0xf bank_mask:0xf
    v_add_f32_dpp v25, v25, v25 quad_perm:[1,0,3,2] row_mask:0xf bank_mask:0xf
    v_fmac_f32_dpp v36, v24, v12 row_newbcast:2 row_mask:0xf bank_mask:0xf
    v_fmac_f32_dpp v37, v24, v13 row_newbcast:2 row_mask:0xf bank_mask:0xf
    v_fmac_f32_dpp v38, v24, v14 row_newbcast:2 row_mask:0xf bank_mask:0xf
    v_fmac_f32_dpp v39, v24, v15 row_newbcast:2 row_mask:0xf bank_mask:0xf
    v_add_f32_dpp v25, v25, v25 quad_perm:[2,3,0,1] row_mask:0xf bank_mask:0xf
    v_fmac_f32_dpp v36, v24, v16 row_newbcast:4 row_mask:0xf bank_mask:0xf
    v_fmac_f32_dpp v37, v24, v17 row_newbcast:4 row_mask:0xf bank_mask:0xf
    v_fmac_f32_dpp v38, v24, v18 row_newbcast:4 row_mask:0xf bank_mask:0xf
    v_fmac_f32_dpp v39, v24, v19 row_newbcast:4 row_mask:0xf bank_mask:0xf
    v_add_f32_dpp v25, v25, v25 row_half_mirror row_mask:0xf bank_mask:0xf
    v_fmac_f32_dpp v36, v24, v20 row_newbcast:6 row_mask:0xf bank_mask:0xf
    v_fmac_f32_dpp v37, v24, v21 row_newbcast:6 row_mask:0xf bank_mask:0xf
    v_fmac_f32_dpp v38, v24, v22 row_newbcast:6 row_mask:0xf bank_mask:0xf
    v_fmac_f32_dpp v39, v24, v23 row_newbcast:6 row_mask:0xf bank_mask:0xf
    v_rcp_f32 v25, v25
    v_permlane32_swap_b32 v36, v38
    v_permlane32_swap_b32 v37, v39
    v_add_f32 v36, v36, v38
    v_add_f32 v37, v37, v39
    v_mul_f32 v36, v36, v25
    v_mul_f32 v37, v37, v25
    v_cvt_pk_bf16_f32 v36, v36, v37
    ds_write_b32 v47, v36 offset:2624
    ds_read_b128 v[8:11], v32 offset:2624
    ds_read_b128 v[12:15], v32 offset:2688
    ds_read_b128 v[16:19], v32 offset:2752
    ds_read_b128 v[20:23], v32 offset:2816
    s_waitcnt lgkmcnt(3)
    v_mfma_f32_16x16x32_bf16 v[24:27], v[48:51], v[8:11], 0
    v_mfma_f32_16x16x32_bf16 v[28:31], v[64:67], v[8:11], 0
    s_waitcnt lgkmcnt(2)
    v_mfma_f32_16x16x32_bf16 v[24:27], v[52:55], v[12:15], v[24:27]
    v_mfma_f32_16x16x32_bf16 v[28:31], v[68:71], v[12:15], v[28:31]
    s_waitcnt lgkmcnt(1)
    v_mfma_f32_16x16x32_bf16 v[24:27], v[56:59], v[16:19], v[24:27]
    v_mfma_f32_16x16x32_bf16 v[28:31], v[72:75], v[16:19], v[28:31]
    s_waitcnt lgkmcnt(0)
    v_mfma_f32_16x16x32_bf16 v[24:27], v[60:63], v[20:23], v[24:27]
    v_mfma_f32_16x16x32_bf16 v[28:31], v[76:79], v[20:23], v[28:31]
    s_mov_b32 exec_lo, 0x00010001
    s_mov_b32 exec_hi, 0x00010001
    s_nop 4
    ds_write_b128 v33, v[24:27] offset:2112
    ds_write_b128 v33, v[28:31] offset:2176
    s_mov_b64 exec, -1
    s_xor_b32 s57, s86, 1799596467
    s_waitcnt lgkmcnt(0)
    s_barrier
    v_mov_b32 v31, s57
    s_cmp_lg_u32 s3, 0
    s_cbranch_scc1 L_w0_177
    s_mov_b32 exec_hi, 0
    ds_read_b32 v10, v34 offset:2112
    ds_read_b32 v11, v34 offset:2240
    ds_read_b32 v12, v34 offset:2368
    ds_read_b32 v13, v34 offset:2496
    s_waitcnt lgkmcnt(0)
    v_add_f32 v10, v10, v11
    v_add_f32 v12, v12, v13
    v_add_f32 v10, v10, v12
    v_bfi_b32 v10, s87, v35, v10
    buffer_store_dword v10, v34, s[16:19], s59 offen sc1
    s_cmp_eq_u32 s53, 0
    s_cbranch_scc1 L_slow_178
    buffer_store_dword v31, v34, s[16:19], s63 offen
L_pub_179:
    s_mov_b32 exec_hi, -1
L_w0_177:
    s_branch L_join_198
L_odd_197:
    s_sub_u32 s59, s2, 8
    s_cmp_gt_u32 s59, 1
    s_cbranch_scc1 L_done
    s_sub_u32 s62, 9, s2
    s_lshl_b32 s59, s62, 11
    s_add_u32 s59, s59, 524288
    buffer_load_dwordx2 v[24:25], v46, s[16:19], s59 offen sc1
    s_lshl_b32 s61, s62, 15
    s_add_u32 s61, s61, 475136
    s_lshl_b32 s59, s62, 1
    s_add_u32 s90, s90, s59
    s_add_u32 s48, s90, 1
    s_and_b32 s48, s48, 0xff
    s_add_u32 s49, s90, 54
    s_and_b32 s49, s49, 0xff
    s_add_u32 s50, s90, 107
    s_and_b32 s50, s50, 0xff
    s_add_u32 s51, s90, 160
    s_and_b32 s51, s51, 0xff
    s_xor_b32 s59, s86, 1799596467
    buffer_load_dword v33, off, s[16:19], s63 sc1
    s_branch L_page_180
L_retry_173:
    s_mov_b32 s57, 524288
L_rloop_174:
    s_mov_b64 exec, vcc
    buffer_load_dwordx4 v[24:27], v46, s[16:19], s60 offen offset:512 sc1
    buffer_load_dwordx4 v[8:11], v45, s[16:19], s60 offen offset:0 sc1
    buffer_load_dwordx4 v[12:15], v45, s[16:19], s60 offen offset:1280 sc1
    buffer_load_dwordx4 v[16:19], v45, s[16:19], s60 offen offset:2560 sc1
    buffer_load_dwordx4 v[20:23], v45, s[16:19], s60 offen offset:3840 sc1
    s_waitcnt vmcnt(4)
    v_xor_b32 v24, s48, v24
    v_xor_b32 v25, s49, v25
    v_xor_b32 v26, s50, v26
    v_xor_b32 v27, s51, v27
    v_or3_b32 v28, v24, v25, v26
    v_or_b32 v28, v28, v27
    s_waitcnt vmcnt(3)
    v_xor_b32 v8, s48, v8
    v_xor_b32 v9, s49, v9
    v_xor_b32 v10, s50, v10
    v_xor_b32 v11, s51, v11
    v_or3_b32 v28, v28, v8, v9
    v_or3_b32 v28, v28, v10, v11
    s_waitcnt vmcnt(2)
    v_xor_b32 v12, s48, v12
    v_xor_b32 v13, s49, v13
    v_xor_b32 v14, s50, v14
    v_xor_b32 v15, s51, v15
    v_or3_b32 v28, v28, v12, v13
    v_or3_b32 v28, v28, v14, v15
    s_waitcnt vmcnt(1)
    v_xor_b32 v16, s48, v16
    v_xor_b32 v17, s49, v17
    v_xor_b32 v18, s50, v18
    v_xor_b32 v19, s51, v19
    v_or3_b32 v28, v28, v16, v17
    v_or3_b32 v28, v28, v18, v19
    s_waitcnt vmcnt(0)
    v_xor_b32 v20, s48, v20
    v_xor_b32 v21, s49, v21
    v_xor_b32 v22, s50, v22
    v_xor_b32 v23, s51, v23
    v_or3_b32 v28, v28, v20, v21
    v_or3_b32 v28, v28, v22, v23
    v_and_b32 v28, 0xff, v28
    v_cmp_ne_u32 vcc, 0, v28
    s_cbranch_vccz L_rdone_175
    s_sub_u32 s57, s57, 1
    s_cmp_lg_u32 s57, 0
    s_cbranch_scc1 L_rloop_174
L_rdone_175:
    s_mov_b64 exec, -1
    s_branch L_ok_176
L_slow_178:
    buffer_store_dword v31, v34, s[16:19], s63 offen sc1
    s_branch L_pub_179
.p2align 12
L_page_180:
    s_waitcnt vmcnt(0)
    v_cmp_ne_u32 vcc, s59, v33
    s_cbranch_vccnz L_retry_181
L_ok_184:
    s_add_u32 s60, s61, 0
    buffer_load_dwordx4 v[8:11], v45, s[16:19], s60 offen sc1
    s_add_u32 s60, s61, 4096
    buffer_load_dwordx4 v[12:15], v45, s[16:19], s60 offen sc1
    s_add_u32 s60, s61, 8192
    buffer_load_dwordx4 v[16:19], v45, s[16:19], s60 offen sc1
    s_add_u32 s60, s61, 12288
    buffer_load_dwordx4 v[20:23], v45, s[16:19], s60 offen sc1
    v_lshlrev_b32_e64 v34, 3, s3
    v_mov_b32 v39, 0
    v_mov_b32 v38, 0x3f800054
    s_waitcnt vmcnt(3)
    v_xor_b32 v8, s48, v8
    v_xor_b32 v9, s49, v9
    v_xor_b32 v10, s50, v10
    v_xor_b32 v11, s51, v11
    v_or3_b32 v33, v8, v9, v10
    v_or_b32 v33, v33, v11
    s_waitcnt vmcnt(2)
    v_xor_b32 v12, s48, v12
    v_xor_b32 v13, s49, v13
    v_xor_b32 v14, s50, v14
    v_xor_b32 v15, s51, v15
    v_or3_b32 v33, v33, v12, v13
    v_or3_b32 v33, v33, v14, v15
    s_waitcnt vmcnt(1)
    v_xor_b32 v16, s48, v16
    v_xor_b32 v17, s49, v17
    v_xor_b32 v18, s50, v18
    v_xor_b32 v19, s51, v19
    v_or3_b32 v33, v33, v16, v17
    v_or3_b32 v33, v33, v18, v19
    s_waitcnt vmcnt(0)
    v_xor_b32 v20, s48, v20
    v_xor_b32 v21, s49, v21
    v_xor_b32 v22, s50, v22
    v_xor_b32 v23, s51, v23
    v_or3_b32 v33, v33, v20, v21
    v_or3_b32 v33, v33, v22, v23
    v_and_b32 v33, 0xff, v33
    v_cmp_ne_u32 vcc, 0, v33
    s_cbranch_vccnz L_retry_185
L_ok_188:
    v_pk_add_f32 v[8:9], v[8:9], v[12:13]
    v_pk_add_f32 v[16:17], v[16:17], v[20:21]
    v_pk_add_f32 v[10:11], v[10:11], v[14:15]
    v_pk_add_f32 v[18:19], v[18:19], v[22:23]
    v_add_f32 v8, v8, v16
    v_add_f32 v9, v9, v17
    v_add_f32 v10, v10, v18
    v_add_f32 v11, v11, v19
    s_nop 0
    v_permlane32_swap_b32 v8, v10
    v_permlane32_swap_b32 v9, v11
    v_add_f32 v8, v8, v10
    v_add_f32 v9, v9, v11
    v_add_f32 v24, v24, v8
    v_add_f32 v25, v25, v9
    v_add_f32 v26, v24, v25
    v_mul_f32 v27, v24, v24
    v_fmac_f32 v27, v25, v25
    v_add_f32_dpp v26, v26, v26 quad_perm:[1,0,3,2] row_mask:0xf bank_mask:0xf
    s_nop 0
    v_add_f32_dpp v27, v27, v27 quad_perm:[1,0,3,2] row_mask:0xf bank_mask:0xf
    v_add_f32_dpp v26, v26, v26 quad_perm:[2,3,0,1] row_mask:0xf bank_mask:0xf
    s_nop 0
    v_add_f32_dpp v27, v27, v27 quad_perm:[2,3,0,1] row_mask:0xf bank_mask:0xf
    v_add_f32_dpp v26, v26, v26 row_half_mirror row_mask:0xf bank_mask:0xf
    s_nop 0
    v_add_f32_dpp v27, v27, v27 row_half_mirror row_mask:0xf bank_mask:0xf
    v_add_f32_dpp v26, v26, v26 row_mirror row_mask:0xf bank_mask:0xf
    s_nop 0
    v_add_f32_dpp v27, v27, v27 row_mirror row_mask:0xf bank_mask:0xf
    v_add_f32_dpp v26, v26, v26 row_bcast:15 row_mask:0xa bank_mask:0xf
    s_nop 0
    v_add_f32_dpp v27, v27, v27 row_bcast:15 row_mask:0xa bank_mask:0xf
    v_add_f32_dpp v26, v26, v26 row_bcast:31 row_mask:0xc bank_mask:0xf
    s_nop 0
    v_add_f32_dpp v27, v27, v27 row_bcast:31 row_mask:0xc bank_mask:0xf
    s_mov_b32 exec_lo, 0
    s_mov_b32 exec_hi, 0x80000000
    ds_write_b64 v34, v[26:27] offset:2048
    s_mov_b64 exec, -1
    s_movk_i32 s59, 0xfff
    s_mov_b32 s60, 31744
    s_waitcnt lgkmcnt(0)
    s_barrier
    ds_read_b128 v[8:11], v39 offset:2048
    ds_read_b128 v[12:15], v39 offset:2064
    s_waitcnt lgkmcnt(0)
    v_pk_add_f32 v[8:9], v[8:9], v[10:11]
    v_pk_add_f32 v[12:13], v[12:13], v[14:15]
    v_pk_add_f32 v[8:9], v[8:9], v[12:13]
    v_mul_f32 v8, 0x3b000000, v8
    v_mul_f32 v9, 0x3b000000, v9
    v_fma_f32 v9, -v8, v8, v9
    v_max_f32 v9, 0, v9
    v_fmaak_f32 v10, v9, v38, 0x2edbe6ff
    v_rsq_f32 v10, v10
    v_sub_f32 v26, v24, v8
    v_sub_f32 v27, v25, v8
    v_mul_f32 v26, v26, v10
    v_mul_f32 v27, v27, v10
    v_cvt_pk_bf16_f32 v36, v26, v27
    v_and_b32 v16, 0x7fff, v36
    v_bfe_u32 v17, v36, 16, 15
    v_bfe_u32 v18, v36, 15, 1
    v_lshrrev_b32 v19, 31, v36
    v_subrev_u32 v20, 12800, v16
    v_subrev_u32 v21, 12800, v17
    v_med3_i32 v20, v20, 0, s59
    v_med3_i32 v21, v21, 0, s59
    v_lshl_add_u32 v20, v18, 12, v20
    v_lshl_add_u32 v21, v19, 12, v21
    v_lshrrev_b32 v22, 11, v20
    v_lshlrev_b32 v20, 2, v20
    v_lshrrev_b32 v23, 11, v21
    v_lshlrev_b32 v21, 2, v21
    v_mad_u32_u24 v20, v22, s60, v20
    ds_read_b32 v28, v20 offset:24576
    v_mad_u32_u24 v21, v23, s60, v21
    ds_read_b32 v29, v21 offset:24576
    s_mov_b32 s59, 12800
    v_add_u32 v16, -1, v16
    v_add_u32 v17, -1, v17
    v_cmp_gt_u32 s[48:49], s59, v16
    v_cmp_gt_u32 s[50:51], s59, v17
    s_nop 0
    s_or_b64 vcc, s[48:49], s[50:51]
    s_waitcnt lgkmcnt(0)
    s_cbranch_vccnz L_tiny_189
L_mixed_190:
    v_add_f32 v24, v24, v28
    v_add_f32 v25, v25, v29
    v_lshrrev_b32 v37, 1, v46
    s_lshl_b32 s59, s62, 10
    v_cvt_pk_bf16_f32 v24, v24, v25
    buffer_store_dword v24, v37, s[44:47], s59 offen
    s_sub_u32 s59, s2, 8
    s_or_b32 s59, s59, s3
    s_cmp_lg_u32 s59, 0
    s_cbranch_scc1 L_done
    v_mov_b32 v8, s86
    s_mov_b32 s59, 580608
    s_mov_b64 exec, 1
    buffer_store_dword v8, off, s[16:19], s59 sc1
    s_mov_b64 exec, -1
L_join_198:
L_done:
L_end:
    s_endpgm
L_retry_181:
    s_mov_b32 s57, 524288
L_rloop_182:
    s_mov_b64 exec, vcc
    buffer_load_dword v33, off, s[16:19], s63 sc1
    s_waitcnt vmcnt(0)
    v_cmp_ne_u32 vcc, s59, v33
    s_cbranch_vccz L_rdone_183
    s_sub_u32 s57, s57, 1
    s_cmp_lg_u32 s57, 0
    s_cbranch_scc1 L_rloop_182
L_rdone_183:
    s_mov_b64 exec, -1
    s_branch L_ok_184
L_retry_185:
    s_mov_b32 s57, 524288
L_rloop_186:
    s_mov_b64 exec, vcc
    s_add_u32 s60, s61, 0
    buffer_load_dwordx4 v[8:11], v45, s[16:19], s60 offen sc1
    s_add_u32 s60, s61, 4096
    buffer_load_dwordx4 v[12:15], v45, s[16:19], s60 offen sc1
    s_add_u32 s60, s61, 8192
    buffer_load_dwordx4 v[16:19], v45, s[16:19], s60 offen sc1
    s_add_u32 s60, s61, 12288
    buffer_load_dwordx4 v[20:23], v45, s[16:19], s60 offen sc1
    s_waitcnt vmcnt(3)
    v_xor_b32 v8, s48, v8
    v_xor_b32 v9, s49, v9
    v_xor_b32 v10, s50, v10
    v_xor_b32 v11, s51, v11
    v_or3_b32 v33, v8, v9, v10
    v_or_b32 v33, v33, v11
    s_waitcnt vmcnt(2)
    v_xor_b32 v12, s48, v12
    v_xor_b32 v13, s49, v13
    v_xor_b32 v14, s50, v14
    v_xor_b32 v15, s51, v15
    v_or3_b32 v33, v33, v12, v13
    v_or3_b32 v33, v33, v14, v15
    s_waitcnt vmcnt(1)
    v_xor_b32 v16, s48, v16
    v_xor_b32 v17, s49, v17
    v_xor_b32 v18, s50, v18
    v_xor_b32 v19, s51, v19
    v_or3_b32 v33, v33, v16, v17
    v_or3_b32 v33, v33, v18, v19
    s_waitcnt vmcnt(0)
    v_xor_b32 v20, s48, v20
    v_xor_b32 v21, s49, v21
    v_xor_b32 v22, s50, v22
    v_xor_b32 v23, s51, v23
    v_or3_b32 v33, v33, v20, v21
    v_or3_b32 v33, v33, v22, v23
    v_and_b32 v33, 0xff, v33
    v_cmp_ne_u32 vcc, 0, v33
    s_cbranch_vccz L_rdone_187
    s_sub_u32 s57, s57, 1
    s_cmp_lg_u32 s57, 0
    s_cbranch_scc1 L_rloop_186
L_rdone_187:
    s_mov_b64 exec, -1
    s_branch L_ok_188
L_tiny_189:
L_mx_191:
    s_cmp_eq_u64 s[48:49], 0
    s_cbranch_scc1 L_mxe_193
    s_ff1_i32_b64 s57, s[48:49]
    s_bitset0_b64 s[48:49], s57
    v_readlane_b32 s5, v36, s57
    s_nop 0
    s_lshl_b32 s5, s5, 16
    v_mov_b32 v8, s5
    v_lshlrev_b32 v9, 1, v0
    v_mov_b32 v12, 0
    s_mov_b32 s5, 0
L_mxf_192:
    buffer_load_ushort v13, v9, s[32:35], s5 offen
    buffer_load_ushort v14, v9, s[36:39], s5 offen
    buffer_load_ushort v15, v9, s[40:43], s5 offen
    s_waitcnt vmcnt(0)
    v_lshlrev_b32 v13, 16, v13
    v_lshlrev_b32 v14, 16, v14
    v_lshlrev_b32 v15, 16, v15
    v_fma_f32 v10, v8, v13, v14
    v_mul_f32 v11, v10, v10
    v_mul_f32 v11, 0xbdd2d3e8, v11
    v_add_f32 v11, 0xc0135761, v11
    v_mul_f32 v11, v10, v11
    v_exp_f32 v11, v11
    v_mul_f32 v10, v10, v15
    v_add_f32 v11, 1.0, v11
    v_rcp_f32 v11, v11
    s_add_u32 s5, s5, 128
    s_cmp_lt_u32 s5, 2752
    v_fmac_f32 v12, v10, v11
    s_cbranch_scc1 L_mxf_192
    s_nop 0
    v_add_f32_dpp v12, v12, v12 quad_perm:[1,0,3,2] row_mask:0xf bank_mask:0xf
    s_nop 1
    v_add_f32_dpp v12, v12, v12 quad_perm:[2,3,0,1] row_mask:0xf bank_mask:0xf
    s_nop 1
    v_add_f32_dpp v12, v12, v12 row_half_mirror row_mask:0xf bank_mask:0xf
    s_nop 1
    v_add_f32_dpp v12, v12, v12 row_mirror row_mask:0xf bank_mask:0xf
    s_nop 1
    v_add_f32_dpp v12, v12, v12 row_bcast:15 row_mask:0xa bank_mask:0xf
    s_nop 1
    v_add_f32_dpp v12, v12, v12 row_bcast:31 row_mask:0xc bank_mask:0xf
    v_add_f32 v12, s55, v12
    s_nop 0
    v_readlane_b32 s5, v12, 63
    s_mov_b32 m0, s57
    s_nop 3
    v_writelane_b32 v28, s5, m0
    s_branch L_mx_191
L_mxe_193:
L_mx_194:
    s_cmp_eq_u64 s[50:51], 0
    s_cbranch_scc1 L_mxe_196
    s_ff1_i32_b64 s57, s[50:51]
    s_bitset0_b64 s[50:51], s57
    v_readlane_b32 s5, v36, s57
    s_nop 0
    s_and_b32 s5, s5, 0xffff0000
    v_mov_b32 v8, s5
    v_lshlrev_b32 v9, 1, v0
    v_mov_b32 v12, 0
    s_mov_b32 s5, 0
L_mxf_195:
    buffer_load_ushort v13, v9, s[32:35], s5 offen
    buffer_load_ushort v14, v9, s[36:39], s5 offen
    buffer_load_ushort v15, v9, s[40:43], s5 offen
    s_waitcnt vmcnt(0)
    v_lshlrev_b32 v13, 16, v13
    v_lshlrev_b32 v14, 16, v14
    v_lshlrev_b32 v15, 16, v15
    v_fma_f32 v10, v8, v13, v14
    v_mul_f32 v11, v10, v10
    v_mul_f32 v11, 0xbdd2d3e8, v11
    v_add_f32 v11, 0xc0135761, v11
    v_mul_f32 v11, v10, v11
    v_exp_f32 v11, v11
    v_mul_f32 v10, v10, v15
    v_add_f32 v11, 1.0, v11
    v_rcp_f32 v11, v11
    s_add_u32 s5, s5, 128
    s_cmp_lt_u32 s5, 2752
    v_fmac_f32 v12, v10, v11
    s_cbranch_scc1 L_mxf_195
    s_nop 0
    v_add_f32_dpp v12, v12, v12 quad_perm:[1,0,3,2] row_mask:0xf bank_mask:0xf
    s_nop 1
    v_add_f32_dpp v12, v12, v12 quad_perm:[2,3,0,1] row_mask:0xf bank_mask:0xf
    s_nop 1
    v_add_f32_dpp v12, v12, v12 row_half_mirror row_mask:0xf bank_mask:0xf
    s_nop 1
    v_add_f32_dpp v12, v12, v12 row_mirror row_mask:0xf bank_mask:0xf
    s_nop 1
    v_add_f32_dpp v12, v12, v12 row_bcast:15 row_mask:0xa bank_mask:0xf
    s_nop 1
    v_add_f32_dpp v12, v12, v12 row_bcast:31 row_mask:0xc bank_mask:0xf
    v_add_f32 v12, s55, v12
    s_nop 0
    v_readlane_b32 s5, v12, 63
    s_mov_b32 m0, s57
    s_nop 3
    v_writelane_b32 v29, s5, m0
    s_branch L_mx_194
L_mxe_196:
    s_branch L_mixed_190
L_code_end:
.section .rodata,"a"
.p2align 6
.amdhsa_kernel interleave_layers__gqa_block_cached__mixer_token_mlp__decode_kernel
  .amdhsa_next_free_vgpr 512
  .amdhsa_next_free_sgpr 102
  .amdhsa_accum_offset 256
  .amdhsa_group_segment_fixed_size 0
  .amdhsa_kernarg_size 104
  .amdhsa_user_sgpr_count 2
  .amdhsa_user_sgpr_kernarg_segment_ptr 1
  .amdhsa_system_sgpr_workgroup_id_x 1
.end_amdhsa_kernel
```
